```python
import torch

def _softmax(x, axis=-1):
    return torch.softmax(x, dim=axis)
def _gelu(x):
    return torch.nn.functional.gelu(x, approximate="tanh")
def _silu(x):
    return torch.nn.functional.silu(x)
def _sigmoid(x):
    return torch.sigmoid(x)
def _layernorm(x, axis=-1, eps=1e-5):
    m = x.mean(dim=axis, keepdim=True)
    v = x.var(dim=axis, keepdim=True, unbiased=False)
    return (x - m) / torch.sqrt(v + eps)
def _scatter_add(tgt, idx, src, axis=0):
    return tgt.clone().index_add_(axis, idx, src)
def _segment_sum(src, seg, n):
    out = torch.zeros((n,) + src.shape[1:], dtype=src.dtype)
    return out.index_add_(0, seg, src)
def _pad(x, pw):
    flat = tuple(v for pair in reversed(pw) for v in pair)
    return torch.nn.functional.pad(x, flat)

kernel_name = 'recurrent_scan__sliding_local_dilated__dense_activation_silu__prompt'

def setup_inputs():

    _w = (lambda a: (lambda t: t.to(torch.bfloat16) if t.is_floating_point() else t)(torch.as_tensor(a)))
    def _A_setup():
        B, S, D = 1, 2048, 640
        return {
            "x": _w((lambda *s: torch.randn(*s, dtype=torch.bfloat16) * 0.05)(B, S, D)),
            "wqkv": _w((lambda *s: torch.randn(*s, dtype=torch.bfloat16) * 0.2)(D, 3 * D)),
            "wo": _w((lambda *s: torch.randn(*s, dtype=torch.bfloat16) * 0.2)(D, D)),
        }
    _A_in = _A_setup()

    def _B_setup():
        B, S, D, F = 1, 2048, 640, 1536
        return {
            "x": _w((lambda *s: torch.randn(*s, dtype=torch.bfloat16) * 0.05)(B, S, D)),
            "w1": _w((lambda *s: torch.randn(*s, dtype=torch.bfloat16) * 0.8)(D, F) * (D ** -0.5)),
            "w2": _w((lambda *s: torch.randn(*s, dtype=torch.bfloat16) * 0.1)(F, D) * (F ** -0.5)),
        }
    _B_in = _B_setup()

    return {
        "A_x": _A_in["x"],
        "A_wqkv": _A_in["wqkv"],
        "A_wo": _A_in["wo"],
        "B_x": _B_in["x"],
        "B_w1": _B_in["w1"],
        "B_w2": _B_in["w2"],
    }

def reference(A_x, A_wqkv, A_wo, B_x, B_w1, B_w2):
    def _A_ref(x, wqkv, wo):
        B, S, D = x.shape
        H = 32; Dh = D // H
        W, dil = 8, 2
        qkv = (lambda x, *d: x.permute(*d))((x @ wqkv).reshape(B, S, 3, H, Dh), 2, 0, 3, 1, 4)
        q, k, v = qkv[0], qkv[1], qkv[2]
        scale = Dh ** -0.5
        pos = torch.arange(S)
        off = torch.arange(W) * dil
        idx = pos[:, None] - off[None, :]
        mask = idx >= 0
        idx_c = torch.where(mask, idx, 0).reshape(-1)
        kg = k[:, :, idx_c, :].reshape(B, H, S, W, Dh)
        vg = v[:, :, idx_c, :].reshape(B, H, S, W, Dh)
        logits = torch.einsum("bhsd,bhswd->bhsw", q, kg) * scale
        logits = torch.where(mask[None, None, :, :], logits, -1e9)
        attn = _softmax(logits, axis=-1)
        o = torch.einsum("bhsw,bhswd->bhsd", attn, vg)
        return (lambda x, *d: x.permute(*d))(o, 0, 2, 1, 3).reshape(B, S, D) @ wo

    def _B_ref(x, w1, w2):
        h = torch.einsum("bsd,df->bsf", x, w1)
        h = _silu(h)
        out = torch.einsum("bsf,fd->bsd", h, w2)
        return out

    x = A_x
    xn = _layernorm(x, axis=-1)
    s = _A_ref(xn, A_wqkv, A_wo)
    g = _silu(_B_ref(xn, B_w1, B_w2))
    return x + s * g
```

```asm
; @launch grid=(256,1,1) block=(512,1,1) lds=163840
.amdgcn_target "amdgcn-amd-amdhsa--gfx950"
.text
.globl recurrent_scan__sliding_local_dilated__dense_activation_silu__prompt_kernel
.p2align 8
.type recurrent_scan__sliding_local_dilated__dense_activation_silu__prompt_kernel,@function
recurrent_scan__sliding_local_dilated__dense_activation_silu__prompt_kernel:
s_cmp_ge_u32 s2, 256
s_cbranch_scc1 p1_done
s_load_dwordx4 s[4:7], s[0:1], 0
s_load_dwordx2 s[8:9], s[0:1], 64
s_load_dwordx4 s[56:59], s[0:1], 32
s_load_dwordx2 s[60:61], s[0:1], 16
s_load_dwordx2 s[84:85], s[0:1], 56
s_load_dwordx2 s[96:97], s[0:1], 48
s_and_b32 s10, s2, 7
s_lshr_b32 s11, s2, 3
v_lshrrev_b32 v1, 6, v0
v_and_b32 v0, 63, v0
s_and_b32 s12, s10, 1
s_lshl_b32 s12, s12, 3
s_and_b32 s13, s11, 7
s_add_u32 s12, s12, s13
v_readfirstlane_b32 s14, v1
s_nop 3
s_cmp_lt_u32 s14, 2
s_cbranch_scc0 cp1
s_lshl_b32 s28, s11, 1
s_add_u32 s28, s28, s14
s_lshl_b32 s28, s28, 10
s_cmp_lt_u32 s28, KERNEL_BYTES
s_cbranch_scc0 cp1
s_getpc_b64 s[30:31]
cp1_pc:
s_sub_u32 s30, s30, cp1_pc-recurrent_scan__sliding_local_dilated__dense_activation_silu__prompt_kernel
s_subb_u32 s31, s31, 0
s_add_u32 s30, s30, s28
s_addc_u32 s31, s31, 0
v_lshlrev_b32 v228, 4, v0
v_add_co_u32 v228, vcc, s30, v228
v_mov_b32 v229, s31
s_nop 0
v_addc_co_u32 v229, vcc, 0, v229, vcc
global_load_dwordx4 v[232:235], v[228:229], off
cp1:
s_and_b32 s13, s10, 6
s_bfe_u32 s15, s11, 0x10003
s_add_u32 s13, s13, s15
s_lshr_b32 s15, s11, 4
s_lshl_b32 s15, s15, 3
s_add_u32 s13, s13, s15
v_and_b32 v1, 15, v0
v_lshrrev_b32 v2, 4, v0
v_lshrrev_b32 v3, 3, v0
v_and_b32 v4, 7, v0
v_xor_b32 v4, v4, v3
v_lshlrev_b32 v4, 4, v4
s_mov_b32 s87, 0xffff0000
s_and_b32 s15, s14, 3
s_lshr_b32 s16, s14, 2
s_lshl_b32 s19, s14, 2
s_add_u32 s19, s19, 0x40000
s_lshl_b32 s17, s12, 7
s_lshl_b32 s18, s15, 5
s_add_u32 s17, s17, s18
s_add_u32 s17, s17, s16
v_lshlrev_b32 v5, 1, v3
v_add_u32 v5, s17, v5
v_mul_u32_u24 v10, 1280, v5
v_add_u32 v10, v10, v4
v_add_u32 v11, 20480, v10
s_lshl_b32 s34, s14, 11
s_add_u32 s35, s34, 1024
v_and_b32 v6, 7, v1
v_xor_b32 v6, v6, v2
v_lshlrev_b32 v6, 4, v6
v_lshl_add_u32 v6, v1, 7, v6
v_xor_b32 v7, 64, v6
v_bfe_u32 v8, v0, 2, 2
v_and_b32 v9, 3, v0
v_lshrrev_b32 v30, 1, v2
v_lshlrev_b32 v30, 4, v30
v_and_b32 v31, 1, v2
v_lshl_add_u32 v30, v31, 2, v30
v_add_u32 v30, v30, v8
s_lshr_b32 s28, s11, 3
s_mul_i32 s28, s28, 2
s_add_u32 s28, s28, s12
s_and_b32 s28, s28, 7
s_add_u32 s54, s28, 2
s_mov_b32 s55, 0
s_waitcnt lgkmcnt(0)
s_mov_b32 s20, s4
s_and_b32 s21, s5, 0xffff
s_mov_b32 s22, 2621440
s_mov_b32 s23, 0x20000
s_lshl_b32 s48, s55, 7
s_mov_b32 m0, s34
s_nop 0
buffer_load_dwordx4 v10, s[20:23], s48 offen  lds
s_mov_b32 m0, s35
s_nop 0
buffer_load_dwordx4 v11, s[20:23], s48 offen  lds
s_cmp_ge_u32 s13, 8
s_cbranch_scc1 p1_ffn
s_mul_i32 s18, s13, 160
s_bfe_u32 s29, 0x0, s19
s_bfe_u32 s30, 0x76543210, s19
s_lshl_b32 s31, s30, 6
v_add_u32 v32, s31, v0
v_mul_u32_u24 v33, 6554, v32
v_lshrrev_b32 v33, 16, v33
v_mul_u32_u24 v34, 10, v33
v_sub_u32 v34, v32, v34
v_and_b32 v35, 0xfffffff3, v33
v_and_b32 v32, 4, v33
v_lshl_or_b32 v35, v32, 1, v35
v_bfe_u32 v32, v33, 3, 1
v_lshl_or_b32 v35, v32, 2, v35
v_mul_u32_u24 v35, 3840, v35
v_lshl_add_u32 v35, v34, 4, v35
s_mul_i32 s31, s29, 1280
s_add_u32 s31, s31, s18
v_add_u32 v12, s31, v35
s_mul_i32 s31, s29, 30720
s_lshl_b32 s33, s30, 10
s_add_u32 s31, s31, s33
s_add_u32 s36, s31, 55296
s_mul_i32 s49, s55, 245760
s_mov_b32 s24, s6
s_and_b32 s25, s7, 0xffff
s_mov_b32 s26, 2457600
s_mov_b32 s27, 0x20000
s_add_u32 m0, s36, 0
s_nop 0
buffer_load_dwordx4 v12, s[24:27], s49 offen  lds
s_bfe_u32 s29, 0x11111100, s19
s_bfe_u32 s30, 0x54321098, s19
s_lshl_b32 s31, s30, 6
v_add_u32 v32, s31, v0
v_mul_u32_u24 v33, 6554, v32
v_lshrrev_b32 v33, 16, v33
v_mul_u32_u24 v34, 10, v33
v_sub_u32 v34, v32, v34
v_and_b32 v35, 0xfffffff3, v33
v_and_b32 v32, 4, v33
v_lshl_or_b32 v35, v32, 1, v35
v_bfe_u32 v32, v33, 3, 1
v_lshl_or_b32 v35, v32, 2, v35
v_mul_u32_u24 v35, 3840, v35
v_lshl_add_u32 v35, v34, 4, v35
s_mul_i32 s31, s29, 1280
s_add_u32 s31, s31, s18
v_add_u32 v13, s31, v35
s_mul_i32 s31, s29, 30720
s_lshl_b32 s33, s30, 10
s_add_u32 s31, s31, s33
s_add_u32 s37, s31, 55296
s_add_u32 m0, s37, 0
s_nop 0
buffer_load_dwordx4 v13, s[24:27], s49 offen  lds
s_bfe_u32 s29, 0x22221111, s19
s_bfe_u32 s30, 0x32109876, s19
s_lshl_b32 s31, s30, 6
v_add_u32 v32, s31, v0
v_mul_u32_u24 v33, 6554, v32
v_lshrrev_b32 v33, 16, v33
v_mul_u32_u24 v34, 10, v33
v_sub_u32 v34, v32, v34
v_and_b32 v35, 0xfffffff3, v33
v_and_b32 v32, 4, v33
v_lshl_or_b32 v35, v32, 1, v35
v_bfe_u32 v32, v33, 3, 1
v_lshl_or_b32 v35, v32, 2, v35
v_mul_u32_u24 v35, 3840, v35
v_lshl_add_u32 v35, v34, 4, v35
s_mul_i32 s31, s29, 1280
s_add_u32 s31, s31, s18
v_add_u32 v14, s31, v35
s_mul_i32 s31, s29, 30720
s_lshl_b32 s33, s30, 10
s_add_u32 s31, s31, s33
s_add_u32 s38, s31, 55296
s_add_u32 m0, s38, 0
s_nop 0
buffer_load_dwordx4 v14, s[24:27], s49 offen  lds
s_bfe_u32 s29, 0x22222222, s19
s_bfe_u32 s30, 0x99987654, s19
s_lshl_b32 s31, s30, 6
v_add_u32 v32, s31, v0
v_mul_u32_u24 v33, 6554, v32
v_lshrrev_b32 v33, 16, v33
v_mul_u32_u24 v34, 10, v33
v_sub_u32 v34, v32, v34
v_and_b32 v35, 0xfffffff3, v33
v_and_b32 v32, 4, v33
v_lshl_or_b32 v35, v32, 1, v35
v_bfe_u32 v32, v33, 3, 1
v_lshl_or_b32 v35, v32, 2, v35
v_mul_u32_u24 v35, 3840, v35
v_lshl_add_u32 v35, v34, 4, v35
s_mul_i32 s31, s29, 1280
s_add_u32 s31, s31, s18
v_add_u32 v15, s31, v35
s_mul_i32 s31, s29, 30720
s_lshl_b32 s33, s30, 10
s_add_u32 s31, s31, s33
s_add_u32 s39, s31, 55296
s_sub_u32 s28, s14, 6
s_lshl_b32 s29, s12, 7
s_sub_u32 s29, s29, 16
s_add_u32 s29, s29, s28
v_lshlrev_b32 v32, 1, v3
v_add_u32 v32, s29, v32
v_max_i32 v32, 0, v32
v_mul_u32_u24 v32, 1280, v32
v_add_u32 v32, v32, v4
s_lshl_b32 s29, s28, 10
s_add_u32 s29, s29, 16384
s_cmp_ge_u32 s14, 6
s_cselect_b32 s39, s29, s39
s_cselect_b64 vcc, -1, 0
s_mov_b32 s33, 10240
s_cselect_b32 s33, 18432, s33
v_cndmask_b32 v15, v15, v32, vcc
s_add_u32 s52, s39, s33
s_add_u32 s53, s52, s33
s_cmp_ge_u32 s14, 6
s_cselect_b32 s40, s20, s24
s_cselect_b32 s41, s21, s25
s_cselect_b32 s42, s22, s26
s_mov_b32 s43, 0x20000
s_mov_b32 s44, 245760
s_cselect_b32 s44, 128, s44
s_cmp_eq_u32 s14, 6
s_cselect_b32 s46, 0xffffff00, -1
s_mov_b32 s47, -1
s_mul_i32 s45, s55, s44
s_mov_b32 m0, s39
s_nop 0
s_mov_b64 exec, s[46:47]
buffer_load_dwordx4 v15, s[40:43], s45 offen  lds
s_mov_b64 exec, -1
s_mov_b32 s55, 1
s_lshl_b32 s48, s55, 7
s_mul_i32 s49, s55, 245760
s_mul_i32 s45, s55, s44
s_cmp_eq_u32 s14, 6
s_cbranch_scc0 q_noones
v_mov_b32 v36, 0x3f803f80
v_mov_b32 v37, v36
v_mov_b32 v38, v36
v_mov_b32 v39, v36
v_lshlrev_b32 v40, 4, v0
s_mov_b64 exec, 0xff
ds_write_b128 v40, v[36:39] offset:16384
ds_write_b128 v40, v[36:39] offset:34816
ds_write_b128 v40, v[36:39] offset:53248
s_mov_b64 exec, -1
q_noones:
s_add_u32 m0, s34, 18432
s_nop 0
buffer_load_dwordx4 v10, s[20:23], s48 offen  lds
s_lshl_b32 s28, s16, 13
v_add_u32 v16, s28, v6
v_add_u32 v17, s28, v7
v_add_u32 v18, 16384, v6
v_add_u32 v19, 16384, v7
s_lshl_b32 s29, s15, 11
v_add_u32 v20, s29, v16
v_add_u32 v21, s29, v17
v_mul_u32_u24 v32, 160, v30
v_mul_u32_u24 v33, 40, v9
v_add_u32 v32, v32, v33
s_bfe_u32 s64, 0xea62c840, s19
s_bfe_u32 s72, 0x22102100, s19
s_bfe_u32 s76, 0x40122340, s19
s_mul_i32 s31, s72, 30720
s_lshl_b32 s33, s76, 3
s_add_u32 s31, s31, s33
s_add_u32 s31, s31, 55296
v_add_u32 v22, s31, v32
s_bfe_u32 s65, 0xcb73d951, s19
s_bfe_u32 s73, 0x22102110, s19
s_bfe_u32 s77, 0x21233401, s19
s_mul_i32 s31, s73, 30720
s_lshl_b32 s33, s77, 3
s_add_u32 s31, s31, s33
s_add_u32 s31, s31, 55296
v_add_u32 v23, s31, v32
s_bfe_u32 s66, 0xd840ea62, s19
s_bfe_u32 s74, 0x21002210, s19
s_bfe_u32 s78, 0x33404012, s19
s_mul_i32 s31, s74, 30720
s_lshl_b32 s33, s78, 3
s_add_u32 s31, s31, s33
s_add_u32 s31, s31, 55296
v_add_u32 v24, s31, v32
s_add_u32 m0, s35, 18432
s_nop 0
buffer_load_dwordx4 v11, s[20:23], s48 offen  lds
s_bfe_u32 s67, 0xe951cb73, s19
s_bfe_u32 s75, 0x21102210, s19
s_bfe_u32 s79, 0x44012123, s19
s_mul_i32 s31, s75, 30720
s_lshl_b32 s33, s79, 3
s_add_u32 s31, s31, s33
s_add_u32 s31, s31, 55296
v_add_u32 v25, s31, v32
v_lshlrev_b32 v224, 3, v0
v_lshlrev_b32 v225, 4, v2
v_lshlrev_b32 v222, 4, v0
s_mul_i32 s17, s16, 10240
s_mul_i32 s31, s72, 23040
s_lshl_b32 s33, s76, 9
s_add_u32 s31, s31, s33
s_add_u32 s33, s31, s17
v_add_u32 v188, s33, v224
s_add_u32 s33, s31, 20480
s_cmp_lt_u32 s64, 5
s_cselect_b32 s33, 69120, s33
v_add_u32 v192, s33, v224
s_lshl_b32 s33, s64, 6
s_add_u32 s33, s33, 97536
v_add_u32 v215, s33, v225
v_mov_b32 v220, v215
s_add_u32 m0, s36, 10240
s_nop 0
buffer_load_dwordx4 v12, s[24:27], s49 offen  lds
s_mul_i32 s31, s73, 23040
s_lshl_b32 s33, s77, 9
s_add_u32 s31, s31, s33
s_add_u32 s33, s31, s17
v_add_u32 v189, s33, v224
s_add_u32 s33, s31, 20480
s_cmp_lt_u32 s65, 5
s_cselect_b32 s33, 69120, s33
v_add_u32 v193, s33, v224
s_lshl_b32 s33, s65, 6
s_add_u32 s33, s33, 97536
v_add_u32 v216, s33, v225
v_mov_b32 v221, v216
s_mul_i32 s31, s74, 23040
s_lshl_b32 s33, s78, 9
s_add_u32 s31, s31, s33
s_add_u32 s33, s31, s17
v_add_u32 v190, s33, v224
s_lshl_b32 s33, s66, 6
s_add_u32 s33, s33, 97536
v_add_u32 v217, s33, v225
s_mul_i32 s31, s75, 23040
s_lshl_b32 s33, s79, 9
s_add_u32 s31, s31, s33
s_add_u32 s33, s31, s17
v_add_u32 v191, s33, v224
s_lshl_b32 s33, s67, 6
s_add_u32 s33, s33, 97536
v_add_u32 v218, s33, v225
s_add_u32 m0, s37, 10240
s_nop 0
buffer_load_dwordx4 v13, s[24:27], s49 offen  lds
v_lshlrev_b32 v226, 3, v1
s_lshl_b32 s28, s14, 7
s_add_u32 s28, s28, 96256
v_add_u32 v219, s28, v226
s_lshl_b32 s28, s16, 9
s_add_u32 s28, s28, 96256
v_add_u32 v213, s28, v226
v_add_u32 v214, 97280, v226
s_mul_i32 s68, s14, 2560
s_lshl_b32 s30, s16, 6
s_add_u32 s30, s30, 20544
s_sub_u32 s30, s30, s68
s_cmp_eq_u32 s15, 0
s_cselect_b32 s69, s30, 0xfffff680
v_add_u32 v200, s68, v224
v_mov_b32 v226, s69
v_add_u32 v196, 23040, v200
v_cmp_gt_u32 s[28:29], 4, v1
v_cmp_gt_u32 s[30:31], 8, v1
v_add_u32 v195, 0xffffffe0, v196
v_add_u32 v194, 0xffffffc0, v196
v_cndmask_b32 v227, 0, v226, s[28:29]
v_add_u32 v195, v195, v227
v_cndmask_b32 v227, 0, v226, s[30:31]
v_add_u32 v194, v194, v227
v_lshl_add_u32 v227, v9, 2, v8
v_lshl_add_u32 v227, v2, 4, v227
v_lshlrev_b32 v227, 3, v227
s_add_u32 s28, s68, 46080
v_add_u32 v199, s28, v227
s_add_u32 m0, s38, 10240
s_nop 0
buffer_load_dwordx4 v14, s[24:27], s49 offen  lds
v_cmp_gt_u32 s[28:29], 1, v9
v_cmp_gt_u32 s[30:31], 2, v9
v_add_u32 v198, 0xffffffe0, v199
v_add_u32 v197, 0xffffffc0, v199
v_cndmask_b32 v227, 0, v226, s[28:29]
v_add_u32 v198, v198, v227
v_cndmask_b32 v227, 0, v226, s[30:31]
v_add_u32 v197, v197, v227
v_and_b32 v225, 3, v1
v_mov_b32 v227, 0xf149f2ca
v_cmp_gt_u32 s[30:31], 1, v225
v_cmp_gt_u32 s[32:33], 2, v225
v_cmp_gt_u32 vcc, 3, v225
v_mov_b32 v201, v227
v_mov_b32 v209, 0
v_cndmask_b32 v202, v227, 0, s[30:31]
v_cndmask_b32 v210, 0, v227, s[30:31]
v_cndmask_b32 v203, v227, 0, s[32:33]
v_cndmask_b32 v211, 0, v227, s[32:33]
v_cndmask_b32 v204, v227, 0, vcc
v_cndmask_b32 v212, 0, v227, vcc
v_mov_b32 v205, 0
v_mov_b32 v206, 0
v_mov_b32 v207, 0
v_mov_b32 v208, 0
s_or_b32 s28, s12, s15
s_cmp_eq_u32 s28, 0
s_cbranch_scc0 q_nostart
s_mov_b32 exec_lo, 0x00ff00ff
s_mov_b32 exec_hi, 0x00ff00ff
v_mov_b32 v201, v227
v_mov_b32 v202, v227
v_mov_b32 v203, v227
v_mov_b32 v204, v227
s_mov_b32 exec_lo, 0x000f000f
s_mov_b32 exec_hi, 0x000f000f
v_mov_b32 v205, v227
v_mov_b32 v206, v227
v_mov_b32 v207, v227
v_mov_b32 v208, v227
s_mov_b64 exec, -1
q_nostart:
s_mov_b32 m0, s52
s_nop 0
s_mov_b64 exec, s[46:47]
buffer_load_dwordx4 v15, s[40:43], s45 offen  lds
s_mov_b64 exec, -1
s_mov_b32 s55, s54
s_lshl_b32 s48, s55, 7
s_mul_i32 s49, s55, 245760
s_mul_i32 s45, s55, s44
s_lshl_b32 s28, s12, 3
s_add_u32 s28, s28, s14
s_mul_i32 s28, s28, 69632
s_lshr_b32 s29, s13, 1
s_mul_i32 s29, s29, 5
s_add_u32 s29, s29, 48
s_lshl_b32 s29, s29, 10
s_add_u32 s28, s28, s29
s_and_b32 s29, s13, 1
s_lshl_b32 s70, s29, 11
s_add_u32 s70, s70, s28
s_lshl_b32 s71, s29, 9
s_add_u32 s71, s71, s28
s_add_u32 s71, s71, 4096
s_mov_b32 s80, s8
s_and_b32 s81, s9, 0xffff
s_mov_b32 s82, 8912896
s_mov_b32 s83, 0x20000
s_or_b32 s28, s2, s14
s_cmp_eq_u32 s28, 0
s_cbranch_scc0 nn2
s_memrealtime s[32:33]
s_mov_b32 s28, s84
s_and_b32 s29, s85, 0xffff
s_mov_b32 s30, 256
s_mov_b32 s31, 0x20000
s_waitcnt lgkmcnt(0)
s_or_b32 s32, s32, 1
v_mov_b32 v252, s32
v_mov_b32 v255, 0
s_mov_b64 exec, 1
buffer_store_dword v252, v255, s[28:31], 0 offen sc1
s_mov_b64 exec, -1
nn2:
v_mov_b32 v26, 0
v_mov_b32 v27, 0
s_cmp_eq_u32 s15, 3
s_cbranch_scc1 q_pathB
s_waitcnt vmcnt(6) lgkmcnt(0)
s_barrier
ds_read_b64_tr_b16 v[132:133], v22 offset:0
ds_read_b64_tr_b16 v[134:135], v22 offset:1280
ds_read_b128 v[108:111], v16 offset:0
ds_read_b64_tr_b16 v[136:137], v23 offset:0
ds_read_b64_tr_b16 v[138:139], v23 offset:1280
ds_read_b128 v[112:115], v16 offset:2048
ds_read_b64_tr_b16 v[140:141], v24 offset:0
ds_read_b64_tr_b16 v[142:143], v24 offset:1280
ds_read_b128 v[116:119], v16 offset:4096
ds_read_b64_tr_b16 v[144:145], v25 offset:0
ds_read_b64_tr_b16 v[146:147], v25 offset:1280
ds_read_b128 v[120:123], v16 offset:6144
ds_read_b128 v[124:127], v18 offset:0
ds_read_b128 v[128:131], v20 offset:0
ds_read_b64_tr_b16 v[172:173], v22 offset:5120
s_add_u32 m0, s34, 36864
s_waitcnt lgkmcnt(12)
v_mfma_f32_16x16x32_bf16 v[36:39], v[132:135], v[108:111], 0
ds_read_b64_tr_b16 v[174:175], v22 offset:6400
buffer_load_dwordx4 v10, s[20:23], s48 offen  lds
s_waitcnt lgkmcnt(11)
v_mfma_f32_16x16x32_bf16 v[40:43], v[136:139], v[108:111], 0
ds_read_b128 v[148:151], v17 offset:0
ds_read_b64_tr_b16 v[176:177], v23 offset:5120
s_add_u32 m0, s35, 36864
s_waitcnt lgkmcnt(10)
v_mfma_f32_16x16x32_bf16 v[44:47], v[140:143], v[108:111], 0
buffer_load_dwordx4 v11, s[20:23], s48 offen  lds
ds_read_b64_tr_b16 v[178:179], v23 offset:6400
s_waitcnt lgkmcnt(8)
v_mfma_f32_16x16x32_bf16 v[48:51], v[144:147], v[108:111], 0
ds_read_b128 v[152:155], v17 offset:2048
s_waitcnt lgkmcnt(6)
v_lshlrev_b32 v30, 16, v128
v_and_b32 v31, s87, v128
s_add_u32 m0, s36, 20480
v_mfma_f32_16x16x32_bf16 v[52:55], v[132:135], v[112:115], 0
buffer_load_dwordx4 v12, s[24:27], s49 offen  lds
v_add_f32 v26, v26, v30
v_fmac_f32 v27, v30, v30
v_mfma_f32_16x16x32_bf16 v[56:59], v[136:139], v[112:115], 0
ds_read_b64_tr_b16 v[180:181], v24 offset:5120
v_add_f32 v26, v26, v31
v_fmac_f32 v27, v31, v31
v_mfma_f32_16x16x32_bf16 v[60:63], v[140:143], v[112:115], 0
ds_read_b64_tr_b16 v[182:183], v24 offset:6400
v_lshlrev_b32 v32, 16, v129
v_and_b32 v33, s87, v129
s_add_u32 m0, s37, 20480
v_mfma_f32_16x16x32_bf16 v[64:67], v[144:147], v[112:115], 0
buffer_load_dwordx4 v13, s[24:27], s49 offen  lds
v_add_f32 v26, v26, v32
v_fmac_f32 v27, v32, v32
v_mfma_f32_16x16x32_bf16 v[68:71], v[132:135], v[116:119], 0
ds_read_b128 v[156:159], v17 offset:4096
v_add_f32 v26, v26, v33
v_fmac_f32 v27, v33, v33
v_mfma_f32_16x16x32_bf16 v[72:75], v[136:139], v[116:119], 0
ds_read_b64_tr_b16 v[184:185], v25 offset:5120
v_lshlrev_b32 v30, 16, v130
v_and_b32 v31, s87, v130
s_add_u32 m0, s38, 20480
v_mfma_f32_16x16x32_bf16 v[76:79], v[140:143], v[116:119], 0
buffer_load_dwordx4 v14, s[24:27], s49 offen  lds
v_add_f32 v26, v26, v30
v_fmac_f32 v27, v30, v30
v_mfma_f32_16x16x32_bf16 v[80:83], v[144:147], v[116:119], 0
ds_read_b64_tr_b16 v[186:187], v25 offset:6400
v_add_f32 v26, v26, v31
v_fmac_f32 v27, v31, v31
v_mfma_f32_16x16x32_bf16 v[84:87], v[132:135], v[120:123], 0
ds_read_b128 v[160:163], v17 offset:6144
v_lshlrev_b32 v32, 16, v131
s_mov_b32 m0, s53
v_mfma_f32_16x16x32_bf16 v[88:91], v[136:139], v[120:123], 0
s_mov_b64 exec, s[46:47]
buffer_load_dwordx4 v15, s[40:43], s45 offen  lds
s_mov_b64 exec, -1
s_add_u32 s55, s55, 1
s_cmp_eq_u32 s55, 10
s_cselect_b32 s55, 2, s55
s_lshl_b32 s48, s55, 7
s_mul_i32 s49, s55, 245760
s_mul_i32 s45, s55, s44
v_and_b32 v33, s87, v131
v_mfma_f32_16x16x32_bf16 v[92:95], v[140:143], v[120:123], 0
ds_read_b128 v[164:167], v19 offset:0
v_add_f32 v26, v26, v32
v_mfma_f32_16x16x32_bf16 v[96:99], v[144:147], v[120:123], 0
ds_read_b128 v[168:171], v21 offset:0
v_fmac_f32 v27, v32, v32
v_mfma_f32_16x16x32_bf16 v[100:103], v[132:135], v[124:127], 0
v_add_f32 v26, v26, v33
v_mfma_f32_16x16x32_bf16 v[104:107], v[136:139], v[124:127], 0
v_fmac_f32 v27, v33, v33
s_waitcnt vmcnt(6)
s_barrier
s_add_u32 m0, s34, 0
s_waitcnt lgkmcnt(11)
v_mfma_f32_16x16x32_bf16 v[36:39], v[172:175], v[148:151], v[36:39]
ds_read_b64_tr_b16 v[132:133], v22 offset:10240
buffer_load_dwordx4 v10, s[20:23], s48 offen  lds
s_waitcnt lgkmcnt(10)
v_mfma_f32_16x16x32_bf16 v[40:43], v[176:179], v[148:151], v[40:43]
ds_read_b64_tr_b16 v[134:135], v22 offset:11520
s_waitcnt lgkmcnt(2)
v_lshlrev_b32 v30, 16, v168
v_and_b32 v31, s87, v168
v_mfma_f32_16x16x32_bf16 v[44:47], v[180:183], v[148:151], v[44:47]
ds_read_b128 v[108:111], v16 offset:18432
v_add_f32 v26, v26, v30
v_fmac_f32 v27, v30, v30
v_mfma_f32_16x16x32_bf16 v[48:51], v[184:187], v[148:151], v[48:51]
ds_read_b64_tr_b16 v[136:137], v23 offset:10240
v_add_f32 v26, v26, v31
v_fmac_f32 v27, v31, v31
v_mfma_f32_16x16x32_bf16 v[52:55], v[172:175], v[152:155], v[52:55]
ds_read_b64_tr_b16 v[138:139], v23 offset:11520
v_lshlrev_b32 v32, 16, v169
v_and_b32 v33, s87, v169
s_add_u32 m0, s35, 0
v_mfma_f32_16x16x32_bf16 v[56:59], v[176:179], v[152:155], v[56:59]
buffer_load_dwordx4 v11, s[20:23], s48 offen  lds
v_add_f32 v26, v26, v32
v_fmac_f32 v27, v32, v32
v_mfma_f32_16x16x32_bf16 v[60:63], v[180:183], v[152:155], v[60:63]
ds_read_b128 v[112:115], v16 offset:20480
v_add_f32 v26, v26, v33
v_fmac_f32 v27, v33, v33
v_mfma_f32_16x16x32_bf16 v[64:67], v[184:187], v[152:155], v[64:67]
ds_read_b64_tr_b16 v[140:141], v24 offset:10240
v_lshlrev_b32 v30, 16, v170
v_and_b32 v31, s87, v170
v_mfma_f32_16x16x32_bf16 v[68:71], v[172:175], v[156:159], v[68:71]
ds_read_b64_tr_b16 v[142:143], v24 offset:11520
v_add_f32 v26, v26, v30
v_mfma_f32_16x16x32_bf16 v[72:75], v[176:179], v[156:159], v[72:75]
ds_read_b128 v[116:119], v16 offset:22528
v_fmac_f32 v27, v30, v30
v_mfma_f32_16x16x32_bf16 v[76:79], v[180:183], v[156:159], v[76:79]
ds_read_b64_tr_b16 v[144:145], v25 offset:10240
v_add_f32 v26, v26, v31
s_add_u32 m0, s36, 0
v_mfma_f32_16x16x32_bf16 v[80:83], v[184:187], v[156:159], v[80:83]
buffer_load_dwordx4 v12, s[24:27], s49 offen  lds
v_fmac_f32 v27, v31, v31
v_mfma_f32_16x16x32_bf16 v[84:87], v[172:175], v[160:163], v[84:87]
ds_read_b64_tr_b16 v[146:147], v25 offset:11520
v_lshlrev_b32 v32, 16, v171
v_mfma_f32_16x16x32_bf16 v[88:91], v[176:179], v[160:163], v[88:91]
ds_read_b128 v[120:123], v16 offset:24576
v_and_b32 v33, s87, v171
v_mfma_f32_16x16x32_bf16 v[92:95], v[180:183], v[160:163], v[92:95]
ds_read_b128 v[124:127], v18 offset:18432
v_add_f32 v26, v26, v32
v_mfma_f32_16x16x32_bf16 v[96:99], v[184:187], v[160:163], v[96:99]
ds_read_b128 v[128:131], v20 offset:18432
v_fmac_f32 v27, v32, v32
v_mfma_f32_16x16x32_bf16 v[100:103], v[172:175], v[164:167], v[100:103]
v_add_f32 v26, v26, v33
v_mfma_f32_16x16x32_bf16 v[104:107], v[176:179], v[164:167], v[104:107]
v_fmac_f32 v27, v33, v33
ds_read_b64_tr_b16 v[172:173], v22 offset:15360
s_waitcnt lgkmcnt(12)
v_mfma_f32_16x16x32_bf16 v[36:39], v[132:135], v[108:111], v[36:39]
ds_read_b64_tr_b16 v[174:175], v22 offset:16640
s_waitcnt lgkmcnt(2)
v_lshlrev_b32 v30, 16, v128
v_and_b32 v31, s87, v128
s_add_u32 m0, s37, 0
v_mfma_f32_16x16x32_bf16 v[40:43], v[136:139], v[108:111], v[40:43]
buffer_load_dwordx4 v13, s[24:27], s49 offen  lds
v_add_f32 v26, v26, v30
v_fmac_f32 v27, v30, v30
v_mfma_f32_16x16x32_bf16 v[44:47], v[140:143], v[108:111], v[44:47]
ds_read_b128 v[148:151], v17 offset:18432
v_add_f32 v26, v26, v31
v_fmac_f32 v27, v31, v31
v_mfma_f32_16x16x32_bf16 v[48:51], v[144:147], v[108:111], v[48:51]
ds_read_b64_tr_b16 v[176:177], v23 offset:15360
v_lshlrev_b32 v32, 16, v129
v_and_b32 v33, s87, v129
v_mfma_f32_16x16x32_bf16 v[52:55], v[132:135], v[112:115], v[52:55]
ds_read_b64_tr_b16 v[178:179], v23 offset:16640
v_add_f32 v26, v26, v32
v_fmac_f32 v27, v32, v32
v_mfma_f32_16x16x32_bf16 v[56:59], v[136:139], v[112:115], v[56:59]
ds_read_b128 v[152:155], v17 offset:20480
v_add_f32 v26, v26, v33
v_fmac_f32 v27, v33, v33
s_add_u32 m0, s38, 0
v_mfma_f32_16x16x32_bf16 v[60:63], v[140:143], v[112:115], v[60:63]
buffer_load_dwordx4 v14, s[24:27], s49 offen  lds
v_lshlrev_b32 v30, 16, v130
v_mfma_f32_16x16x32_bf16 v[64:67], v[144:147], v[112:115], v[64:67]
ds_read_b64_tr_b16 v[180:181], v24 offset:15360
v_and_b32 v31, s87, v130
v_mfma_f32_16x16x32_bf16 v[68:71], v[132:135], v[116:119], v[68:71]
ds_read_b64_tr_b16 v[182:183], v24 offset:16640
v_add_f32 v26, v26, v30
v_mfma_f32_16x16x32_bf16 v[72:75], v[136:139], v[116:119], v[72:75]
ds_read_b128 v[156:159], v17 offset:22528
v_fmac_f32 v27, v30, v30
v_mfma_f32_16x16x32_bf16 v[76:79], v[140:143], v[116:119], v[76:79]
ds_read_b64_tr_b16 v[184:185], v25 offset:15360
v_add_f32 v26, v26, v31
s_mov_b32 m0, s39
v_mfma_f32_16x16x32_bf16 v[80:83], v[144:147], v[116:119], v[80:83]
s_mov_b64 exec, s[46:47]
buffer_load_dwordx4 v15, s[40:43], s45 offen  lds
s_mov_b64 exec, -1
s_add_u32 s55, s55, 1
s_cmp_eq_u32 s55, 10
s_cselect_b32 s55, 2, s55
s_lshl_b32 s48, s55, 7
s_mul_i32 s49, s55, 245760
s_mul_i32 s45, s55, s44
v_fmac_f32 v27, v31, v31
v_mfma_f32_16x16x32_bf16 v[84:87], v[132:135], v[120:123], v[84:87]
ds_read_b64_tr_b16 v[186:187], v25 offset:16640
v_lshlrev_b32 v32, 16, v131
v_mfma_f32_16x16x32_bf16 v[88:91], v[136:139], v[120:123], v[88:91]
ds_read_b128 v[160:163], v17 offset:24576
v_and_b32 v33, s87, v131
v_mfma_f32_16x16x32_bf16 v[92:95], v[140:143], v[120:123], v[92:95]
ds_read_b128 v[164:167], v19 offset:18432
v_add_f32 v26, v26, v32
v_mfma_f32_16x16x32_bf16 v[96:99], v[144:147], v[120:123], v[96:99]
ds_read_b128 v[168:171], v21 offset:18432
v_fmac_f32 v27, v32, v32
v_mfma_f32_16x16x32_bf16 v[100:103], v[132:135], v[124:127], v[100:103]
v_add_f32 v26, v26, v33
v_mfma_f32_16x16x32_bf16 v[104:107], v[136:139], v[124:127], v[104:107]
v_fmac_f32 v27, v33, v33
s_waitcnt vmcnt(6)
s_barrier
s_add_u32 m0, s34, 18432
s_waitcnt lgkmcnt(11)
v_mfma_f32_16x16x32_bf16 v[36:39], v[172:175], v[148:151], v[36:39]
ds_read_b64_tr_b16 v[132:133], v22 offset:20480
buffer_load_dwordx4 v10, s[20:23], s48 offen  lds
s_waitcnt lgkmcnt(10)
v_mfma_f32_16x16x32_bf16 v[40:43], v[176:179], v[148:151], v[40:43]
ds_read_b64_tr_b16 v[134:135], v22 offset:21760
s_waitcnt lgkmcnt(2)
v_lshlrev_b32 v30, 16, v168
v_and_b32 v31, s87, v168
v_mfma_f32_16x16x32_bf16 v[44:47], v[180:183], v[148:151], v[44:47]
ds_read_b128 v[108:111], v16 offset:36864
v_add_f32 v26, v26, v30
v_fmac_f32 v27, v30, v30
v_mfma_f32_16x16x32_bf16 v[48:51], v[184:187], v[148:151], v[48:51]
ds_read_b64_tr_b16 v[136:137], v23 offset:20480
v_add_f32 v26, v26, v31
v_fmac_f32 v27, v31, v31
v_mfma_f32_16x16x32_bf16 v[52:55], v[172:175], v[152:155], v[52:55]
ds_read_b64_tr_b16 v[138:139], v23 offset:21760
v_lshlrev_b32 v32, 16, v169
v_and_b32 v33, s87, v169
s_add_u32 m0, s35, 18432
v_mfma_f32_16x16x32_bf16 v[56:59], v[176:179], v[152:155], v[56:59]
buffer_load_dwordx4 v11, s[20:23], s48 offen  lds
v_add_f32 v26, v26, v32
v_fmac_f32 v27, v32, v32
v_mfma_f32_16x16x32_bf16 v[60:63], v[180:183], v[152:155], v[60:63]
ds_read_b128 v[112:115], v16 offset:38912
v_add_f32 v26, v26, v33
v_fmac_f32 v27, v33, v33
v_mfma_f32_16x16x32_bf16 v[64:67], v[184:187], v[152:155], v[64:67]
ds_read_b64_tr_b16 v[140:141], v24 offset:20480
v_lshlrev_b32 v30, 16, v170
v_and_b32 v31, s87, v170
v_mfma_f32_16x16x32_bf16 v[68:71], v[172:175], v[156:159], v[68:71]
ds_read_b64_tr_b16 v[142:143], v24 offset:21760
v_add_f32 v26, v26, v30
v_mfma_f32_16x16x32_bf16 v[72:75], v[176:179], v[156:159], v[72:75]
ds_read_b128 v[116:119], v16 offset:40960
v_fmac_f32 v27, v30, v30
v_mfma_f32_16x16x32_bf16 v[76:79], v[180:183], v[156:159], v[76:79]
ds_read_b64_tr_b16 v[144:145], v25 offset:20480
v_add_f32 v26, v26, v31
s_add_u32 m0, s36, 10240
v_mfma_f32_16x16x32_bf16 v[80:83], v[184:187], v[156:159], v[80:83]
buffer_load_dwordx4 v12, s[24:27], s49 offen  lds
v_fmac_f32 v27, v31, v31
v_mfma_f32_16x16x32_bf16 v[84:87], v[172:175], v[160:163], v[84:87]
ds_read_b64_tr_b16 v[146:147], v25 offset:21760
v_lshlrev_b32 v32, 16, v171
v_mfma_f32_16x16x32_bf16 v[88:91], v[176:179], v[160:163], v[88:91]
ds_read_b128 v[120:123], v16 offset:43008
v_and_b32 v33, s87, v171
v_mfma_f32_16x16x32_bf16 v[92:95], v[180:183], v[160:163], v[92:95]
ds_read_b128 v[124:127], v18 offset:36864
v_add_f32 v26, v26, v32
v_mfma_f32_16x16x32_bf16 v[96:99], v[184:187], v[160:163], v[96:99]
ds_read_b128 v[128:131], v20 offset:36864
v_fmac_f32 v27, v32, v32
v_mfma_f32_16x16x32_bf16 v[100:103], v[172:175], v[164:167], v[100:103]
v_add_f32 v26, v26, v33
v_mfma_f32_16x16x32_bf16 v[104:107], v[176:179], v[164:167], v[104:107]
v_fmac_f32 v27, v33, v33
ds_read_b64_tr_b16 v[172:173], v22 offset:25600
s_waitcnt lgkmcnt(12)
v_mfma_f32_16x16x32_bf16 v[36:39], v[132:135], v[108:111], v[36:39]
ds_read_b64_tr_b16 v[174:175], v22 offset:26880
s_waitcnt lgkmcnt(2)
v_lshlrev_b32 v30, 16, v128
v_and_b32 v31, s87, v128
s_add_u32 m0, s37, 10240
v_mfma_f32_16x16x32_bf16 v[40:43], v[136:139], v[108:111], v[40:43]
buffer_load_dwordx4 v13, s[24:27], s49 offen  lds
v_add_f32 v26, v26, v30
v_fmac_f32 v27, v30, v30
v_mfma_f32_16x16x32_bf16 v[44:47], v[140:143], v[108:111], v[44:47]
ds_read_b128 v[148:151], v17 offset:36864
v_add_f32 v26, v26, v31
v_fmac_f32 v27, v31, v31
v_mfma_f32_16x16x32_bf16 v[48:51], v[144:147], v[108:111], v[48:51]
ds_read_b64_tr_b16 v[176:177], v23 offset:25600
v_lshlrev_b32 v32, 16, v129
v_and_b32 v33, s87, v129
v_mfma_f32_16x16x32_bf16 v[52:55], v[132:135], v[112:115], v[52:55]
ds_read_b64_tr_b16 v[178:179], v23 offset:26880
v_add_f32 v26, v26, v32
v_fmac_f32 v27, v32, v32
v_mfma_f32_16x16x32_bf16 v[56:59], v[136:139], v[112:115], v[56:59]
ds_read_b128 v[152:155], v17 offset:38912
v_add_f32 v26, v26, v33
v_fmac_f32 v27, v33, v33
s_add_u32 m0, s38, 10240
v_mfma_f32_16x16x32_bf16 v[60:63], v[140:143], v[112:115], v[60:63]
buffer_load_dwordx4 v14, s[24:27], s49 offen  lds
v_lshlrev_b32 v30, 16, v130
v_mfma_f32_16x16x32_bf16 v[64:67], v[144:147], v[112:115], v[64:67]
ds_read_b64_tr_b16 v[180:181], v24 offset:25600
v_and_b32 v31, s87, v130
v_mfma_f32_16x16x32_bf16 v[68:71], v[132:135], v[116:119], v[68:71]
ds_read_b64_tr_b16 v[182:183], v24 offset:26880
v_add_f32 v26, v26, v30
v_mfma_f32_16x16x32_bf16 v[72:75], v[136:139], v[116:119], v[72:75]
ds_read_b128 v[156:159], v17 offset:40960
v_fmac_f32 v27, v30, v30
v_mfma_f32_16x16x32_bf16 v[76:79], v[140:143], v[116:119], v[76:79]
ds_read_b64_tr_b16 v[184:185], v25 offset:25600
v_add_f32 v26, v26, v31
s_mov_b32 m0, s52
v_mfma_f32_16x16x32_bf16 v[80:83], v[144:147], v[116:119], v[80:83]
s_mov_b64 exec, s[46:47]
buffer_load_dwordx4 v15, s[40:43], s45 offen  lds
s_mov_b64 exec, -1
s_add_u32 s55, s55, 1
s_cmp_eq_u32 s55, 10
s_cselect_b32 s55, 2, s55
s_lshl_b32 s48, s55, 7
s_mul_i32 s49, s55, 245760
s_mul_i32 s45, s55, s44
v_fmac_f32 v27, v31, v31
v_mfma_f32_16x16x32_bf16 v[84:87], v[132:135], v[120:123], v[84:87]
ds_read_b64_tr_b16 v[186:187], v25 offset:26880
v_lshlrev_b32 v32, 16, v131
v_mfma_f32_16x16x32_bf16 v[88:91], v[136:139], v[120:123], v[88:91]
ds_read_b128 v[160:163], v17 offset:43008
v_and_b32 v33, s87, v131
v_mfma_f32_16x16x32_bf16 v[92:95], v[140:143], v[120:123], v[92:95]
ds_read_b128 v[164:167], v19 offset:36864
v_add_f32 v26, v26, v32
v_mfma_f32_16x16x32_bf16 v[96:99], v[144:147], v[120:123], v[96:99]
ds_read_b128 v[168:171], v21 offset:36864
v_fmac_f32 v27, v32, v32
v_mfma_f32_16x16x32_bf16 v[100:103], v[132:135], v[124:127], v[100:103]
v_add_f32 v26, v26, v33
v_mfma_f32_16x16x32_bf16 v[104:107], v[136:139], v[124:127], v[104:107]
v_fmac_f32 v27, v33, v33
s_waitcnt vmcnt(6)
s_barrier
s_add_u32 m0, s34, 36864
s_waitcnt lgkmcnt(11)
v_mfma_f32_16x16x32_bf16 v[36:39], v[172:175], v[148:151], v[36:39]
ds_read_b64_tr_b16 v[132:133], v22 offset:0
buffer_load_dwordx4 v10, s[20:23], s48 offen  lds
s_waitcnt lgkmcnt(10)
v_mfma_f32_16x16x32_bf16 v[40:43], v[176:179], v[148:151], v[40:43]
ds_read_b64_tr_b16 v[134:135], v22 offset:1280
s_waitcnt lgkmcnt(2)
v_lshlrev_b32 v30, 16, v168
v_and_b32 v31, s87, v168
v_mfma_f32_16x16x32_bf16 v[44:47], v[180:183], v[148:151], v[44:47]
ds_read_b128 v[108:111], v16 offset:0
v_add_f32 v26, v26, v30
v_fmac_f32 v27, v30, v30
v_mfma_f32_16x16x32_bf16 v[48:51], v[184:187], v[148:151], v[48:51]
ds_read_b64_tr_b16 v[136:137], v23 offset:0
v_add_f32 v26, v26, v31
v_fmac_f32 v27, v31, v31
v_mfma_f32_16x16x32_bf16 v[52:55], v[172:175], v[152:155], v[52:55]
ds_read_b64_tr_b16 v[138:139], v23 offset:1280
v_lshlrev_b32 v32, 16, v169
v_and_b32 v33, s87, v169
s_add_u32 m0, s35, 36864
v_mfma_f32_16x16x32_bf16 v[56:59], v[176:179], v[152:155], v[56:59]
buffer_load_dwordx4 v11, s[20:23], s48 offen  lds
v_add_f32 v26, v26, v32
v_fmac_f32 v27, v32, v32
v_mfma_f32_16x16x32_bf16 v[60:63], v[180:183], v[152:155], v[60:63]
ds_read_b128 v[112:115], v16 offset:2048
v_add_f32 v26, v26, v33
v_fmac_f32 v27, v33, v33
v_mfma_f32_16x16x32_bf16 v[64:67], v[184:187], v[152:155], v[64:67]
ds_read_b64_tr_b16 v[140:141], v24 offset:0
v_lshlrev_b32 v30, 16, v170
v_and_b32 v31, s87, v170
v_mfma_f32_16x16x32_bf16 v[68:71], v[172:175], v[156:159], v[68:71]
ds_read_b64_tr_b16 v[142:143], v24 offset:1280
v_add_f32 v26, v26, v30
v_mfma_f32_16x16x32_bf16 v[72:75], v[176:179], v[156:159], v[72:75]
ds_read_b128 v[116:119], v16 offset:4096
v_fmac_f32 v27, v30, v30
v_mfma_f32_16x16x32_bf16 v[76:79], v[180:183], v[156:159], v[76:79]
ds_read_b64_tr_b16 v[144:145], v25 offset:0
v_add_f32 v26, v26, v31
s_add_u32 m0, s36, 20480
v_mfma_f32_16x16x32_bf16 v[80:83], v[184:187], v[156:159], v[80:83]
buffer_load_dwordx4 v12, s[24:27], s49 offen  lds
v_fmac_f32 v27, v31, v31
v_mfma_f32_16x16x32_bf16 v[84:87], v[172:175], v[160:163], v[84:87]
ds_read_b64_tr_b16 v[146:147], v25 offset:1280
v_lshlrev_b32 v32, 16, v171
v_mfma_f32_16x16x32_bf16 v[88:91], v[176:179], v[160:163], v[88:91]
ds_read_b128 v[120:123], v16 offset:6144
v_and_b32 v33, s87, v171
v_mfma_f32_16x16x32_bf16 v[92:95], v[180:183], v[160:163], v[92:95]
ds_read_b128 v[124:127], v18 offset:0
v_add_f32 v26, v26, v32
v_mfma_f32_16x16x32_bf16 v[96:99], v[184:187], v[160:163], v[96:99]
ds_read_b128 v[128:131], v20 offset:0
v_fmac_f32 v27, v32, v32
v_mfma_f32_16x16x32_bf16 v[100:103], v[172:175], v[164:167], v[100:103]
v_add_f32 v26, v26, v33
v_mfma_f32_16x16x32_bf16 v[104:107], v[176:179], v[164:167], v[104:107]
v_fmac_f32 v27, v33, v33
ds_read_b64_tr_b16 v[172:173], v22 offset:5120
s_waitcnt lgkmcnt(12)
v_mfma_f32_16x16x32_bf16 v[36:39], v[132:135], v[108:111], v[36:39]
ds_read_b64_tr_b16 v[174:175], v22 offset:6400
s_waitcnt lgkmcnt(2)
v_lshlrev_b32 v30, 16, v128
v_and_b32 v31, s87, v128
s_add_u32 m0, s37, 20480
v_mfma_f32_16x16x32_bf16 v[40:43], v[136:139], v[108:111], v[40:43]
buffer_load_dwordx4 v13, s[24:27], s49 offen  lds
v_add_f32 v26, v26, v30
v_fmac_f32 v27, v30, v30
v_mfma_f32_16x16x32_bf16 v[44:47], v[140:143], v[108:111], v[44:47]
ds_read_b128 v[148:151], v17 offset:0
v_add_f32 v26, v26, v31
v_fmac_f32 v27, v31, v31
v_mfma_f32_16x16x32_bf16 v[48:51], v[144:147], v[108:111], v[48:51]
ds_read_b64_tr_b16 v[176:177], v23 offset:5120
v_lshlrev_b32 v32, 16, v129
v_and_b32 v33, s87, v129
v_mfma_f32_16x16x32_bf16 v[52:55], v[132:135], v[112:115], v[52:55]
ds_read_b64_tr_b16 v[178:179], v23 offset:6400
v_add_f32 v26, v26, v32
v_fmac_f32 v27, v32, v32
v_mfma_f32_16x16x32_bf16 v[56:59], v[136:139], v[112:115], v[56:59]
ds_read_b128 v[152:155], v17 offset:2048
v_add_f32 v26, v26, v33
v_fmac_f32 v27, v33, v33
s_add_u32 m0, s38, 20480
v_mfma_f32_16x16x32_bf16 v[60:63], v[140:143], v[112:115], v[60:63]
buffer_load_dwordx4 v14, s[24:27], s49 offen  lds
v_lshlrev_b32 v30, 16, v130
v_mfma_f32_16x16x32_bf16 v[64:67], v[144:147], v[112:115], v[64:67]
ds_read_b64_tr_b16 v[180:181], v24 offset:5120
v_and_b32 v31, s87, v130
v_mfma_f32_16x16x32_bf16 v[68:71], v[132:135], v[116:119], v[68:71]
ds_read_b64_tr_b16 v[182:183], v24 offset:6400
v_add_f32 v26, v26, v30
v_mfma_f32_16x16x32_bf16 v[72:75], v[136:139], v[116:119], v[72:75]
ds_read_b128 v[156:159], v17 offset:4096
v_fmac_f32 v27, v30, v30
v_mfma_f32_16x16x32_bf16 v[76:79], v[140:143], v[116:119], v[76:79]
ds_read_b64_tr_b16 v[184:185], v25 offset:5120
v_add_f32 v26, v26, v31
s_mov_b32 m0, s53
v_mfma_f32_16x16x32_bf16 v[80:83], v[144:147], v[116:119], v[80:83]
s_mov_b64 exec, s[46:47]
buffer_load_dwordx4 v15, s[40:43], s45 offen  lds
s_mov_b64 exec, -1
s_add_u32 s55, s55, 1
s_cmp_eq_u32 s55, 10
s_cselect_b32 s55, 2, s55
s_lshl_b32 s48, s55, 7
s_mul_i32 s49, s55, 245760
s_mul_i32 s45, s55, s44
v_fmac_f32 v27, v31, v31
v_mfma_f32_16x16x32_bf16 v[84:87], v[132:135], v[120:123], v[84:87]
ds_read_b64_tr_b16 v[186:187], v25 offset:6400
v_lshlrev_b32 v32, 16, v131
v_mfma_f32_16x16x32_bf16 v[88:91], v[136:139], v[120:123], v[88:91]
ds_read_b128 v[160:163], v17 offset:6144
v_and_b32 v33, s87, v131
v_mfma_f32_16x16x32_bf16 v[92:95], v[140:143], v[120:123], v[92:95]
ds_read_b128 v[164:167], v19 offset:0
v_add_f32 v26, v26, v32
v_mfma_f32_16x16x32_bf16 v[96:99], v[144:147], v[120:123], v[96:99]
ds_read_b128 v[168:171], v21 offset:0
v_fmac_f32 v27, v32, v32
v_mfma_f32_16x16x32_bf16 v[100:103], v[132:135], v[124:127], v[100:103]
v_add_f32 v26, v26, v33
v_mfma_f32_16x16x32_bf16 v[104:107], v[136:139], v[124:127], v[104:107]
v_fmac_f32 v27, v33, v33
s_waitcnt vmcnt(6)
s_barrier
s_add_u32 m0, s34, 0
s_waitcnt lgkmcnt(11)
v_mfma_f32_16x16x32_bf16 v[36:39], v[172:175], v[148:151], v[36:39]
ds_read_b64_tr_b16 v[132:133], v22 offset:10240
buffer_load_dwordx4 v10, s[20:23], s48 offen  lds
s_waitcnt lgkmcnt(10)
v_mfma_f32_16x16x32_bf16 v[40:43], v[176:179], v[148:151], v[40:43]
ds_read_b64_tr_b16 v[134:135], v22 offset:11520
s_waitcnt lgkmcnt(2)
v_lshlrev_b32 v30, 16, v168
v_and_b32 v31, s87, v168
v_mfma_f32_16x16x32_bf16 v[44:47], v[180:183], v[148:151], v[44:47]
ds_read_b128 v[108:111], v16 offset:18432
v_add_f32 v26, v26, v30
v_fmac_f32 v27, v30, v30
v_mfma_f32_16x16x32_bf16 v[48:51], v[184:187], v[148:151], v[48:51]
ds_read_b64_tr_b16 v[136:137], v23 offset:10240
v_add_f32 v26, v26, v31
v_fmac_f32 v27, v31, v31
v_mfma_f32_16x16x32_bf16 v[52:55], v[172:175], v[152:155], v[52:55]
ds_read_b64_tr_b16 v[138:139], v23 offset:11520
v_lshlrev_b32 v32, 16, v169
v_and_b32 v33, s87, v169
s_add_u32 m0, s35, 0
v_mfma_f32_16x16x32_bf16 v[56:59], v[176:179], v[152:155], v[56:59]
buffer_load_dwordx4 v11, s[20:23], s48 offen  lds
v_add_f32 v26, v26, v32
v_fmac_f32 v27, v32, v32
v_mfma_f32_16x16x32_bf16 v[60:63], v[180:183], v[152:155], v[60:63]
ds_read_b128 v[112:115], v16 offset:20480
v_add_f32 v26, v26, v33
v_fmac_f32 v27, v33, v33
v_mfma_f32_16x16x32_bf16 v[64:67], v[184:187], v[152:155], v[64:67]
ds_read_b64_tr_b16 v[140:141], v24 offset:10240
v_lshlrev_b32 v30, 16, v170
v_and_b32 v31, s87, v170
v_mfma_f32_16x16x32_bf16 v[68:71], v[172:175], v[156:159], v[68:71]
ds_read_b64_tr_b16 v[142:143], v24 offset:11520
v_add_f32 v26, v26, v30
v_mfma_f32_16x16x32_bf16 v[72:75], v[176:179], v[156:159], v[72:75]
ds_read_b128 v[116:119], v16 offset:22528
v_fmac_f32 v27, v30, v30
v_mfma_f32_16x16x32_bf16 v[76:79], v[180:183], v[156:159], v[76:79]
ds_read_b64_tr_b16 v[144:145], v25 offset:10240
v_add_f32 v26, v26, v31
s_add_u32 m0, s36, 0
v_mfma_f32_16x16x32_bf16 v[80:83], v[184:187], v[156:159], v[80:83]
buffer_load_dwordx4 v12, s[24:27], s49 offen  lds
v_fmac_f32 v27, v31, v31
v_mfma_f32_16x16x32_bf16 v[84:87], v[172:175], v[160:163], v[84:87]
ds_read_b64_tr_b16 v[146:147], v25 offset:11520
v_lshlrev_b32 v32, 16, v171
v_mfma_f32_16x16x32_bf16 v[88:91], v[176:179], v[160:163], v[88:91]
ds_read_b128 v[120:123], v16 offset:24576
v_and_b32 v33, s87, v171
v_mfma_f32_16x16x32_bf16 v[92:95], v[180:183], v[160:163], v[92:95]
ds_read_b128 v[124:127], v18 offset:18432
v_add_f32 v26, v26, v32
v_mfma_f32_16x16x32_bf16 v[96:99], v[184:187], v[160:163], v[96:99]
ds_read_b128 v[128:131], v20 offset:18432
v_fmac_f32 v27, v32, v32
v_mfma_f32_16x16x32_bf16 v[100:103], v[172:175], v[164:167], v[100:103]
v_add_f32 v26, v26, v33
v_mfma_f32_16x16x32_bf16 v[104:107], v[176:179], v[164:167], v[104:107]
v_fmac_f32 v27, v33, v33
ds_read_b64_tr_b16 v[172:173], v22 offset:15360
s_waitcnt lgkmcnt(12)
v_mfma_f32_16x16x32_bf16 v[36:39], v[132:135], v[108:111], v[36:39]
ds_read_b64_tr_b16 v[174:175], v22 offset:16640
s_waitcnt lgkmcnt(2)
v_lshlrev_b32 v30, 16, v128
v_and_b32 v31, s87, v128
s_add_u32 m0, s37, 0
v_mfma_f32_16x16x32_bf16 v[40:43], v[136:139], v[108:111], v[40:43]
buffer_load_dwordx4 v13, s[24:27], s49 offen  lds
v_add_f32 v26, v26, v30
v_fmac_f32 v27, v30, v30
v_mfma_f32_16x16x32_bf16 v[44:47], v[140:143], v[108:111], v[44:47]
ds_read_b128 v[148:151], v17 offset:18432
v_add_f32 v26, v26, v31
v_fmac_f32 v27, v31, v31
v_mfma_f32_16x16x32_bf16 v[48:51], v[144:147], v[108:111], v[48:51]
ds_read_b64_tr_b16 v[176:177], v23 offset:15360
v_lshlrev_b32 v32, 16, v129
v_and_b32 v33, s87, v129
v_mfma_f32_16x16x32_bf16 v[52:55], v[132:135], v[112:115], v[52:55]
ds_read_b64_tr_b16 v[178:179], v23 offset:16640
v_add_f32 v26, v26, v32
v_fmac_f32 v27, v32, v32
v_mfma_f32_16x16x32_bf16 v[56:59], v[136:139], v[112:115], v[56:59]
ds_read_b128 v[152:155], v17 offset:20480
v_add_f32 v26, v26, v33
v_fmac_f32 v27, v33, v33
s_add_u32 m0, s38, 0
v_mfma_f32_16x16x32_bf16 v[60:63], v[140:143], v[112:115], v[60:63]
buffer_load_dwordx4 v14, s[24:27], s49 offen  lds
v_lshlrev_b32 v30, 16, v130
v_mfma_f32_16x16x32_bf16 v[64:67], v[144:147], v[112:115], v[64:67]
ds_read_b64_tr_b16 v[180:181], v24 offset:15360
v_and_b32 v31, s87, v130
v_mfma_f32_16x16x32_bf16 v[68:71], v[132:135], v[116:119], v[68:71]
ds_read_b64_tr_b16 v[182:183], v24 offset:16640
v_add_f32 v26, v26, v30
v_mfma_f32_16x16x32_bf16 v[72:75], v[136:139], v[116:119], v[72:75]
ds_read_b128 v[156:159], v17 offset:22528
v_fmac_f32 v27, v30, v30
v_mfma_f32_16x16x32_bf16 v[76:79], v[140:143], v[116:119], v[76:79]
ds_read_b64_tr_b16 v[184:185], v25 offset:15360
v_add_f32 v26, v26, v31
s_mov_b32 m0, s39
v_mfma_f32_16x16x32_bf16 v[80:83], v[144:147], v[116:119], v[80:83]
s_mov_b64 exec, s[46:47]
buffer_load_dwordx4 v15, s[40:43], s45 offen  lds
s_mov_b64 exec, -1
s_add_u32 s55, s55, 1
s_cmp_eq_u32 s55, 10
s_cselect_b32 s55, 2, s55
s_lshl_b32 s48, s55, 7
s_mul_i32 s49, s55, 245760
s_mul_i32 s45, s55, s44
v_fmac_f32 v27, v31, v31
v_mfma_f32_16x16x32_bf16 v[84:87], v[132:135], v[120:123], v[84:87]
ds_read_b64_tr_b16 v[186:187], v25 offset:16640
v_lshlrev_b32 v32, 16, v131
v_mfma_f32_16x16x32_bf16 v[88:91], v[136:139], v[120:123], v[88:91]
ds_read_b128 v[160:163], v17 offset:24576
v_and_b32 v33, s87, v131
v_mfma_f32_16x16x32_bf16 v[92:95], v[140:143], v[120:123], v[92:95]
ds_read_b128 v[164:167], v19 offset:18432
v_add_f32 v26, v26, v32
v_mfma_f32_16x16x32_bf16 v[96:99], v[144:147], v[120:123], v[96:99]
ds_read_b128 v[168:171], v21 offset:18432
v_fmac_f32 v27, v32, v32
v_mfma_f32_16x16x32_bf16 v[100:103], v[132:135], v[124:127], v[100:103]
v_add_f32 v26, v26, v33
v_mfma_f32_16x16x32_bf16 v[104:107], v[136:139], v[124:127], v[104:107]
v_fmac_f32 v27, v33, v33
s_waitcnt vmcnt(6)
s_barrier
s_add_u32 m0, s34, 18432
s_waitcnt lgkmcnt(11)
v_mfma_f32_16x16x32_bf16 v[36:39], v[172:175], v[148:151], v[36:39]
ds_read_b64_tr_b16 v[132:133], v22 offset:20480
buffer_load_dwordx4 v10, s[20:23], s48 offen  lds
s_waitcnt lgkmcnt(10)
v_mfma_f32_16x16x32_bf16 v[40:43], v[176:179], v[148:151], v[40:43]
ds_read_b64_tr_b16 v[134:135], v22 offset:21760
s_waitcnt lgkmcnt(2)
v_lshlrev_b32 v30, 16, v168
v_and_b32 v31, s87, v168
v_mfma_f32_16x16x32_bf16 v[44:47], v[180:183], v[148:151], v[44:47]
ds_read_b128 v[108:111], v16 offset:36864
v_add_f32 v26, v26, v30
v_fmac_f32 v27, v30, v30
v_mfma_f32_16x16x32_bf16 v[48:51], v[184:187], v[148:151], v[48:51]
ds_read_b64_tr_b16 v[136:137], v23 offset:20480
v_add_f32 v26, v26, v31
v_fmac_f32 v27, v31, v31
v_mfma_f32_16x16x32_bf16 v[52:55], v[172:175], v[152:155], v[52:55]
ds_read_b64_tr_b16 v[138:139], v23 offset:21760
v_lshlrev_b32 v32, 16, v169
v_and_b32 v33, s87, v169
s_add_u32 m0, s35, 18432
v_mfma_f32_16x16x32_bf16 v[56:59], v[176:179], v[152:155], v[56:59]
buffer_load_dwordx4 v11, s[20:23], s48 offen  lds
v_add_f32 v26, v26, v32
v_fmac_f32 v27, v32, v32
v_mfma_f32_16x16x32_bf16 v[60:63], v[180:183], v[152:155], v[60:63]
ds_read_b128 v[112:115], v16 offset:38912
v_add_f32 v26, v26, v33
v_fmac_f32 v27, v33, v33
v_mfma_f32_16x16x32_bf16 v[64:67], v[184:187], v[152:155], v[64:67]
ds_read_b64_tr_b16 v[140:141], v24 offset:20480
v_lshlrev_b32 v30, 16, v170
v_and_b32 v31, s87, v170
v_mfma_f32_16x16x32_bf16 v[68:71], v[172:175], v[156:159], v[68:71]
ds_read_b64_tr_b16 v[142:143], v24 offset:21760
v_add_f32 v26, v26, v30
v_mfma_f32_16x16x32_bf16 v[72:75], v[176:179], v[156:159], v[72:75]
ds_read_b128 v[116:119], v16 offset:40960
v_fmac_f32 v27, v30, v30
v_mfma_f32_16x16x32_bf16 v[76:79], v[180:183], v[156:159], v[76:79]
ds_read_b64_tr_b16 v[144:145], v25 offset:20480
v_add_f32 v26, v26, v31
s_add_u32 m0, s36, 10240
v_mfma_f32_16x16x32_bf16 v[80:83], v[184:187], v[156:159], v[80:83]
buffer_load_dwordx4 v12, s[24:27], s49 offen  lds
v_fmac_f32 v27, v31, v31
v_mfma_f32_16x16x32_bf16 v[84:87], v[172:175], v[160:163], v[84:87]
ds_read_b64_tr_b16 v[146:147], v25 offset:21760
v_lshlrev_b32 v32, 16, v171
v_mfma_f32_16x16x32_bf16 v[88:91], v[176:179], v[160:163], v[88:91]
ds_read_b128 v[120:123], v16 offset:43008
v_and_b32 v33, s87, v171
v_mfma_f32_16x16x32_bf16 v[92:95], v[180:183], v[160:163], v[92:95]
ds_read_b128 v[124:127], v18 offset:36864
v_add_f32 v26, v26, v32
v_mfma_f32_16x16x32_bf16 v[96:99], v[184:187], v[160:163], v[96:99]
ds_read_b128 v[128:131], v20 offset:36864
v_fmac_f32 v27, v32, v32
v_mfma_f32_16x16x32_bf16 v[100:103], v[172:175], v[164:167], v[100:103]
v_add_f32 v26, v26, v33
v_mfma_f32_16x16x32_bf16 v[104:107], v[176:179], v[164:167], v[104:107]
v_fmac_f32 v27, v33, v33
ds_read_b64_tr_b16 v[172:173], v22 offset:25600
s_waitcnt lgkmcnt(12)
v_mfma_f32_16x16x32_bf16 v[36:39], v[132:135], v[108:111], v[36:39]
ds_read_b64_tr_b16 v[174:175], v22 offset:26880
s_waitcnt lgkmcnt(2)
v_lshlrev_b32 v30, 16, v128
v_and_b32 v31, s87, v128
s_add_u32 m0, s37, 10240
v_mfma_f32_16x16x32_bf16 v[40:43], v[136:139], v[108:111], v[40:43]
buffer_load_dwordx4 v13, s[24:27], s49 offen  lds
v_add_f32 v26, v26, v30
v_fmac_f32 v27, v30, v30
v_mfma_f32_16x16x32_bf16 v[44:47], v[140:143], v[108:111], v[44:47]
ds_read_b128 v[148:151], v17 offset:36864
v_add_f32 v26, v26, v31
v_fmac_f32 v27, v31, v31
v_mfma_f32_16x16x32_bf16 v[48:51], v[144:147], v[108:111], v[48:51]
ds_read_b64_tr_b16 v[176:177], v23 offset:25600
v_lshlrev_b32 v32, 16, v129
v_and_b32 v33, s87, v129
v_mfma_f32_16x16x32_bf16 v[52:55], v[132:135], v[112:115], v[52:55]
ds_read_b64_tr_b16 v[178:179], v23 offset:26880
v_add_f32 v26, v26, v32
v_fmac_f32 v27, v32, v32
v_mfma_f32_16x16x32_bf16 v[56:59], v[136:139], v[112:115], v[56:59]
ds_read_b128 v[152:155], v17 offset:38912
v_add_f32 v26, v26, v33
v_fmac_f32 v27, v33, v33
s_add_u32 m0, s38, 10240
v_mfma_f32_16x16x32_bf16 v[60:63], v[140:143], v[112:115], v[60:63]
buffer_load_dwordx4 v14, s[24:27], s49 offen  lds
v_lshlrev_b32 v30, 16, v130
v_mfma_f32_16x16x32_bf16 v[64:67], v[144:147], v[112:115], v[64:67]
ds_read_b64_tr_b16 v[180:181], v24 offset:25600
v_and_b32 v31, s87, v130
v_mfma_f32_16x16x32_bf16 v[68:71], v[132:135], v[116:119], v[68:71]
ds_read_b64_tr_b16 v[182:183], v24 offset:26880
v_add_f32 v26, v26, v30
v_mfma_f32_16x16x32_bf16 v[72:75], v[136:139], v[116:119], v[72:75]
ds_read_b128 v[156:159], v17 offset:40960
v_fmac_f32 v27, v30, v30
v_mfma_f32_16x16x32_bf16 v[76:79], v[140:143], v[116:119], v[76:79]
ds_read_b64_tr_b16 v[184:185], v25 offset:25600
v_add_f32 v26, v26, v31
s_mov_b32 m0, s52
v_mfma_f32_16x16x32_bf16 v[80:83], v[144:147], v[116:119], v[80:83]
s_mov_b64 exec, s[46:47]
buffer_load_dwordx4 v15, s[40:43], s45 offen  lds
s_mov_b64 exec, -1
s_add_u32 s55, s55, 1
s_cmp_eq_u32 s55, 10
s_cselect_b32 s55, 2, s55
s_lshl_b32 s48, s55, 7
s_mul_i32 s49, s55, 245760
s_mul_i32 s45, s55, s44
v_fmac_f32 v27, v31, v31
v_mfma_f32_16x16x32_bf16 v[84:87], v[132:135], v[120:123], v[84:87]
ds_read_b64_tr_b16 v[186:187], v25 offset:26880
v_lshlrev_b32 v32, 16, v131
v_mfma_f32_16x16x32_bf16 v[88:91], v[136:139], v[120:123], v[88:91]
ds_read_b128 v[160:163], v17 offset:43008
v_and_b32 v33, s87, v131
v_mfma_f32_16x16x32_bf16 v[92:95], v[140:143], v[120:123], v[92:95]
ds_read_b128 v[164:167], v19 offset:36864
v_add_f32 v26, v26, v32
v_mfma_f32_16x16x32_bf16 v[96:99], v[144:147], v[120:123], v[96:99]
ds_read_b128 v[168:171], v21 offset:36864
v_fmac_f32 v27, v32, v32
v_mfma_f32_16x16x32_bf16 v[100:103], v[132:135], v[124:127], v[100:103]
v_add_f32 v26, v26, v33
v_mfma_f32_16x16x32_bf16 v[104:107], v[136:139], v[124:127], v[104:107]
v_fmac_f32 v27, v33, v33
s_waitcnt vmcnt(6)
s_barrier
s_add_u32 m0, s34, 36864
s_waitcnt lgkmcnt(11)
v_mfma_f32_16x16x32_bf16 v[36:39], v[172:175], v[148:151], v[36:39]
ds_read_b64_tr_b16 v[132:133], v22 offset:0
buffer_load_dwordx4 v10, s[20:23], s48 offen  lds
s_waitcnt lgkmcnt(10)
v_mfma_f32_16x16x32_bf16 v[40:43], v[176:179], v[148:151], v[40:43]
ds_read_b64_tr_b16 v[134:135], v22 offset:1280
s_waitcnt lgkmcnt(2)
v_lshlrev_b32 v30, 16, v168
v_and_b32 v31, s87, v168
v_mfma_f32_16x16x32_bf16 v[44:47], v[180:183], v[148:151], v[44:47]
ds_read_b128 v[108:111], v16 offset:0
v_add_f32 v26, v26, v30
v_fmac_f32 v27, v30, v30
v_mfma_f32_16x16x32_bf16 v[48:51], v[184:187], v[148:151], v[48:51]
ds_read_b64_tr_b16 v[136:137], v23 offset:0
v_add_f32 v26, v26, v31
v_fmac_f32 v27, v31, v31
v_mfma_f32_16x16x32_bf16 v[52:55], v[172:175], v[152:155], v[52:55]
ds_read_b64_tr_b16 v[138:139], v23 offset:1280
v_lshlrev_b32 v32, 16, v169
v_and_b32 v33, s87, v169
s_add_u32 m0, s35, 36864
v_mfma_f32_16x16x32_bf16 v[56:59], v[176:179], v[152:155], v[56:59]
buffer_load_dwordx4 v11, s[20:23], s48 offen  lds
v_add_f32 v26, v26, v32
v_fmac_f32 v27, v32, v32
v_mfma_f32_16x16x32_bf16 v[60:63], v[180:183], v[152:155], v[60:63]
ds_read_b128 v[112:115], v16 offset:2048
v_add_f32 v26, v26, v33
v_fmac_f32 v27, v33, v33
v_mfma_f32_16x16x32_bf16 v[64:67], v[184:187], v[152:155], v[64:67]
ds_read_b64_tr_b16 v[140:141], v24 offset:0
v_lshlrev_b32 v30, 16, v170
v_and_b32 v31, s87, v170
v_mfma_f32_16x16x32_bf16 v[68:71], v[172:175], v[156:159], v[68:71]
ds_read_b64_tr_b16 v[142:143], v24 offset:1280
v_add_f32 v26, v26, v30
v_mfma_f32_16x16x32_bf16 v[72:75], v[176:179], v[156:159], v[72:75]
ds_read_b128 v[116:119], v16 offset:4096
v_fmac_f32 v27, v30, v30
v_mfma_f32_16x16x32_bf16 v[76:79], v[180:183], v[156:159], v[76:79]
ds_read_b64_tr_b16 v[144:145], v25 offset:0
v_add_f32 v26, v26, v31
s_add_u32 m0, s36, 20480
v_mfma_f32_16x16x32_bf16 v[80:83], v[184:187], v[156:159], v[80:83]
buffer_load_dwordx4 v12, s[24:27], s49 offen  lds
v_fmac_f32 v27, v31, v31
v_mfma_f32_16x16x32_bf16 v[84:87], v[172:175], v[160:163], v[84:87]
ds_read_b64_tr_b16 v[146:147], v25 offset:1280
v_lshlrev_b32 v32, 16, v171
v_mfma_f32_16x16x32_bf16 v[88:91], v[176:179], v[160:163], v[88:91]
ds_read_b128 v[120:123], v16 offset:6144
v_and_b32 v33, s87, v171
v_mfma_f32_16x16x32_bf16 v[92:95], v[180:183], v[160:163], v[92:95]
ds_read_b128 v[124:127], v18 offset:0
v_add_f32 v26, v26, v32
v_mfma_f32_16x16x32_bf16 v[96:99], v[184:187], v[160:163], v[96:99]
ds_read_b128 v[128:131], v20 offset:0
v_fmac_f32 v27, v32, v32
v_mfma_f32_16x16x32_bf16 v[100:103], v[172:175], v[164:167], v[100:103]
v_add_f32 v26, v26, v33
v_mfma_f32_16x16x32_bf16 v[104:107], v[176:179], v[164:167], v[104:107]
v_fmac_f32 v27, v33, v33
ds_read_b64_tr_b16 v[172:173], v22 offset:5120
s_waitcnt lgkmcnt(12)
v_mfma_f32_16x16x32_bf16 v[36:39], v[132:135], v[108:111], v[36:39]
ds_read_b64_tr_b16 v[174:175], v22 offset:6400
s_waitcnt lgkmcnt(2)
v_lshlrev_b32 v30, 16, v128
v_and_b32 v31, s87, v128
s_add_u32 m0, s37, 20480
v_mfma_f32_16x16x32_bf16 v[40:43], v[136:139], v[108:111], v[40:43]
buffer_load_dwordx4 v13, s[24:27], s49 offen  lds
v_add_f32 v26, v26, v30
v_fmac_f32 v27, v30, v30
v_mfma_f32_16x16x32_bf16 v[44:47], v[140:143], v[108:111], v[44:47]
ds_read_b128 v[148:151], v17 offset:0
v_add_f32 v26, v26, v31
v_fmac_f32 v27, v31, v31
v_mfma_f32_16x16x32_bf16 v[48:51], v[144:147], v[108:111], v[48:51]
ds_read_b64_tr_b16 v[176:177], v23 offset:5120
v_lshlrev_b32 v32, 16, v129
v_and_b32 v33, s87, v129
v_mfma_f32_16x16x32_bf16 v[52:55], v[132:135], v[112:115], v[52:55]
ds_read_b64_tr_b16 v[178:179], v23 offset:6400
v_add_f32 v26, v26, v32
v_fmac_f32 v27, v32, v32
v_mfma_f32_16x16x32_bf16 v[56:59], v[136:139], v[112:115], v[56:59]
ds_read_b128 v[152:155], v17 offset:2048
v_add_f32 v26, v26, v33
v_fmac_f32 v27, v33, v33
s_add_u32 m0, s38, 20480
v_mfma_f32_16x16x32_bf16 v[60:63], v[140:143], v[112:115], v[60:63]
buffer_load_dwordx4 v14, s[24:27], s49 offen  lds
v_lshlrev_b32 v30, 16, v130
v_mfma_f32_16x16x32_bf16 v[64:67], v[144:147], v[112:115], v[64:67]
ds_read_b64_tr_b16 v[180:181], v24 offset:5120
v_and_b32 v31, s87, v130
v_mfma_f32_16x16x32_bf16 v[68:71], v[132:135], v[116:119], v[68:71]
ds_read_b64_tr_b16 v[182:183], v24 offset:6400
v_add_f32 v26, v26, v30
v_mfma_f32_16x16x32_bf16 v[72:75], v[136:139], v[116:119], v[72:75]
ds_read_b128 v[156:159], v17 offset:4096
v_fmac_f32 v27, v30, v30
v_mfma_f32_16x16x32_bf16 v[76:79], v[140:143], v[116:119], v[76:79]
ds_read_b64_tr_b16 v[184:185], v25 offset:5120
v_add_f32 v26, v26, v31
s_mov_b32 m0, s53
v_mfma_f32_16x16x32_bf16 v[80:83], v[144:147], v[116:119], v[80:83]
s_mov_b64 exec, s[46:47]
buffer_load_dwordx4 v15, s[40:43], s45 offen  lds
s_mov_b64 exec, -1
s_add_u32 s55, s55, 1
s_cmp_eq_u32 s55, 10
s_cselect_b32 s55, 2, s55
s_lshl_b32 s48, s55, 7
s_mul_i32 s49, s55, 245760
s_mul_i32 s45, s55, s44
v_fmac_f32 v27, v31, v31
v_mfma_f32_16x16x32_bf16 v[84:87], v[132:135], v[120:123], v[84:87]
ds_read_b64_tr_b16 v[186:187], v25 offset:6400
v_lshlrev_b32 v32, 16, v131
v_mfma_f32_16x16x32_bf16 v[88:91], v[136:139], v[120:123], v[88:91]
ds_read_b128 v[160:163], v17 offset:6144
v_and_b32 v33, s87, v131
v_mfma_f32_16x16x32_bf16 v[92:95], v[140:143], v[120:123], v[92:95]
ds_read_b128 v[164:167], v19 offset:0
v_add_f32 v26, v26, v32
v_mfma_f32_16x16x32_bf16 v[96:99], v[144:147], v[120:123], v[96:99]
ds_read_b128 v[168:171], v21 offset:0
v_fmac_f32 v27, v32, v32
v_mfma_f32_16x16x32_bf16 v[100:103], v[132:135], v[124:127], v[100:103]
v_add_f32 v26, v26, v33
v_mfma_f32_16x16x32_bf16 v[104:107], v[136:139], v[124:127], v[104:107]
v_fmac_f32 v27, v33, v33
s_waitcnt vmcnt(6)
s_barrier
s_add_u32 m0, s34, 0
s_waitcnt lgkmcnt(11)
v_mfma_f32_16x16x32_bf16 v[36:39], v[172:175], v[148:151], v[36:39]
ds_read_b64_tr_b16 v[132:133], v22 offset:10240
buffer_load_dwordx4 v10, s[20:23], s48 offen  lds
s_waitcnt lgkmcnt(10)
v_mfma_f32_16x16x32_bf16 v[40:43], v[176:179], v[148:151], v[40:43]
ds_read_b64_tr_b16 v[134:135], v22 offset:11520
s_waitcnt lgkmcnt(2)
v_lshlrev_b32 v30, 16, v168
v_and_b32 v31, s87, v168
v_mfma_f32_16x16x32_bf16 v[44:47], v[180:183], v[148:151], v[44:47]
ds_read_b128 v[108:111], v16 offset:18432
v_add_f32 v26, v26, v30
v_fmac_f32 v27, v30, v30
v_mfma_f32_16x16x32_bf16 v[48:51], v[184:187], v[148:151], v[48:51]
ds_read_b64_tr_b16 v[136:137], v23 offset:10240
v_add_f32 v26, v26, v31
v_fmac_f32 v27, v31, v31
v_mfma_f32_16x16x32_bf16 v[52:55], v[172:175], v[152:155], v[52:55]
ds_read_b64_tr_b16 v[138:139], v23 offset:11520
v_lshlrev_b32 v32, 16, v169
v_and_b32 v33, s87, v169
s_add_u32 m0, s35, 0
v_mfma_f32_16x16x32_bf16 v[56:59], v[176:179], v[152:155], v[56:59]
buffer_load_dwordx4 v11, s[20:23], s48 offen  lds
v_add_f32 v26, v26, v32
v_fmac_f32 v27, v32, v32
v_mfma_f32_16x16x32_bf16 v[60:63], v[180:183], v[152:155], v[60:63]
ds_read_b128 v[112:115], v16 offset:20480
v_add_f32 v26, v26, v33
v_fmac_f32 v27, v33, v33
v_mfma_f32_16x16x32_bf16 v[64:67], v[184:187], v[152:155], v[64:67]
ds_read_b64_tr_b16 v[140:141], v24 offset:10240
v_lshlrev_b32 v30, 16, v170
v_and_b32 v31, s87, v170
v_mfma_f32_16x16x32_bf16 v[68:71], v[172:175], v[156:159], v[68:71]
ds_read_b64_tr_b16 v[142:143], v24 offset:11520
v_add_f32 v26, v26, v30
v_mfma_f32_16x16x32_bf16 v[72:75], v[176:179], v[156:159], v[72:75]
ds_read_b128 v[116:119], v16 offset:22528
v_fmac_f32 v27, v30, v30
v_mfma_f32_16x16x32_bf16 v[76:79], v[180:183], v[156:159], v[76:79]
ds_read_b64_tr_b16 v[144:145], v25 offset:10240
v_add_f32 v26, v26, v31
s_add_u32 m0, s36, 0
v_mfma_f32_16x16x32_bf16 v[80:83], v[184:187], v[156:159], v[80:83]
buffer_load_dwordx4 v12, s[24:27], s49 offen  lds
v_fmac_f32 v27, v31, v31
v_mfma_f32_16x16x32_bf16 v[84:87], v[172:175], v[160:163], v[84:87]
ds_read_b64_tr_b16 v[146:147], v25 offset:11520
v_lshlrev_b32 v32, 16, v171
v_mfma_f32_16x16x32_bf16 v[88:91], v[176:179], v[160:163], v[88:91]
ds_read_b128 v[120:123], v16 offset:24576
v_and_b32 v33, s87, v171
v_mfma_f32_16x16x32_bf16 v[92:95], v[180:183], v[160:163], v[92:95]
ds_read_b128 v[124:127], v18 offset:18432
v_add_f32 v26, v26, v32
v_mfma_f32_16x16x32_bf16 v[96:99], v[184:187], v[160:163], v[96:99]
ds_read_b128 v[128:131], v20 offset:18432
v_fmac_f32 v27, v32, v32
v_mfma_f32_16x16x32_bf16 v[100:103], v[172:175], v[164:167], v[100:103]
v_add_f32 v26, v26, v33
v_mfma_f32_16x16x32_bf16 v[104:107], v[176:179], v[164:167], v[104:107]
v_fmac_f32 v27, v33, v33
ds_read_b64_tr_b16 v[172:173], v22 offset:15360
s_waitcnt lgkmcnt(12)
v_mfma_f32_16x16x32_bf16 v[36:39], v[132:135], v[108:111], v[36:39]
ds_read_b64_tr_b16 v[174:175], v22 offset:16640
s_waitcnt lgkmcnt(2)
v_lshlrev_b32 v30, 16, v128
v_and_b32 v31, s87, v128
s_add_u32 m0, s37, 0
v_mfma_f32_16x16x32_bf16 v[40:43], v[136:139], v[108:111], v[40:43]
buffer_load_dwordx4 v13, s[24:27], s49 offen  lds
v_add_f32 v26, v26, v30
v_fmac_f32 v27, v30, v30
v_mfma_f32_16x16x32_bf16 v[44:47], v[140:143], v[108:111], v[44:47]
ds_read_b128 v[148:151], v17 offset:18432
v_add_f32 v26, v26, v31
v_fmac_f32 v27, v31, v31
v_mfma_f32_16x16x32_bf16 v[48:51], v[144:147], v[108:111], v[48:51]
ds_read_b64_tr_b16 v[176:177], v23 offset:15360
v_lshlrev_b32 v32, 16, v129
v_and_b32 v33, s87, v129
v_mfma_f32_16x16x32_bf16 v[52:55], v[132:135], v[112:115], v[52:55]
ds_read_b64_tr_b16 v[178:179], v23 offset:16640
v_add_f32 v26, v26, v32
v_fmac_f32 v27, v32, v32
v_mfma_f32_16x16x32_bf16 v[56:59], v[136:139], v[112:115], v[56:59]
ds_read_b128 v[152:155], v17 offset:20480
v_add_f32 v26, v26, v33
v_fmac_f32 v27, v33, v33
s_add_u32 m0, s38, 0
v_mfma_f32_16x16x32_bf16 v[60:63], v[140:143], v[112:115], v[60:63]
buffer_load_dwordx4 v14, s[24:27], s49 offen  lds
v_lshlrev_b32 v30, 16, v130
v_mfma_f32_16x16x32_bf16 v[64:67], v[144:147], v[112:115], v[64:67]
ds_read_b64_tr_b16 v[180:181], v24 offset:15360
v_and_b32 v31, s87, v130
v_mfma_f32_16x16x32_bf16 v[68:71], v[132:135], v[116:119], v[68:71]
ds_read_b64_tr_b16 v[182:183], v24 offset:16640
v_add_f32 v26, v26, v30
v_mfma_f32_16x16x32_bf16 v[72:75], v[136:139], v[116:119], v[72:75]
ds_read_b128 v[156:159], v17 offset:22528
v_fmac_f32 v27, v30, v30
v_mfma_f32_16x16x32_bf16 v[76:79], v[140:143], v[116:119], v[76:79]
ds_read_b64_tr_b16 v[184:185], v25 offset:15360
v_add_f32 v26, v26, v31
s_mov_b32 m0, s39
v_mfma_f32_16x16x32_bf16 v[80:83], v[144:147], v[116:119], v[80:83]
s_mov_b64 exec, s[46:47]
buffer_load_dwordx4 v15, s[40:43], s45 offen  lds
s_mov_b64 exec, -1
s_add_u32 s55, s55, 1
s_cmp_eq_u32 s55, 10
s_cselect_b32 s55, 2, s55
s_lshl_b32 s48, s55, 7
s_mul_i32 s49, s55, 245760
s_mul_i32 s45, s55, s44
v_fmac_f32 v27, v31, v31
v_mfma_f32_16x16x32_bf16 v[84:87], v[132:135], v[120:123], v[84:87]
ds_read_b64_tr_b16 v[186:187], v25 offset:16640
v_lshlrev_b32 v32, 16, v131
v_mfma_f32_16x16x32_bf16 v[88:91], v[136:139], v[120:123], v[88:91]
ds_read_b128 v[160:163], v17 offset:24576
v_and_b32 v33, s87, v131
v_mfma_f32_16x16x32_bf16 v[92:95], v[140:143], v[120:123], v[92:95]
ds_read_b128 v[164:167], v19 offset:18432
v_add_f32 v26, v26, v32
v_mfma_f32_16x16x32_bf16 v[96:99], v[144:147], v[120:123], v[96:99]
ds_read_b128 v[168:171], v21 offset:18432
v_fmac_f32 v27, v32, v32
v_mfma_f32_16x16x32_bf16 v[100:103], v[132:135], v[124:127], v[100:103]
v_add_f32 v26, v26, v33
v_mfma_f32_16x16x32_bf16 v[104:107], v[136:139], v[124:127], v[104:107]
v_fmac_f32 v27, v33, v33
s_waitcnt vmcnt(6)
s_barrier
s_waitcnt lgkmcnt(11)
v_mfma_f32_16x16x32_bf16 v[36:39], v[172:175], v[148:151], v[36:39]
ds_read_b64_tr_b16 v[132:133], v22 offset:20480
s_waitcnt lgkmcnt(1)
v_lshlrev_b32 v30, 16, v168
v_and_b32 v31, s87, v168
v_mfma_f32_16x16x32_bf16 v[40:43], v[176:179], v[148:151], v[40:43]
ds_read_b64_tr_b16 v[134:135], v22 offset:21760
v_add_f32 v26, v26, v30
v_fmac_f32 v27, v30, v30
v_mfma_f32_16x16x32_bf16 v[44:47], v[180:183], v[148:151], v[44:47]
ds_read_b128 v[108:111], v16 offset:36864
v_add_f32 v26, v26, v31
v_fmac_f32 v27, v31, v31
v_mfma_f32_16x16x32_bf16 v[48:51], v[184:187], v[148:151], v[48:51]
ds_read_b64_tr_b16 v[136:137], v23 offset:20480
v_lshlrev_b32 v32, 16, v169
v_and_b32 v33, s87, v169
v_mfma_f32_16x16x32_bf16 v[52:55], v[172:175], v[152:155], v[52:55]
ds_read_b64_tr_b16 v[138:139], v23 offset:21760
v_add_f32 v26, v26, v32
v_fmac_f32 v27, v32, v32
v_mfma_f32_16x16x32_bf16 v[56:59], v[176:179], v[152:155], v[56:59]
ds_read_b128 v[112:115], v16 offset:38912
v_add_f32 v26, v26, v33
v_fmac_f32 v27, v33, v33
v_mfma_f32_16x16x32_bf16 v[60:63], v[180:183], v[152:155], v[60:63]
ds_read_b64_tr_b16 v[140:141], v24 offset:20480
v_lshlrev_b32 v30, 16, v170
v_mfma_f32_16x16x32_bf16 v[64:67], v[184:187], v[152:155], v[64:67]
ds_read_b64_tr_b16 v[142:143], v24 offset:21760
v_and_b32 v31, s87, v170
v_mfma_f32_16x16x32_bf16 v[68:71], v[172:175], v[156:159], v[68:71]
ds_read_b128 v[116:119], v16 offset:40960
v_add_f32 v26, v26, v30
v_mfma_f32_16x16x32_bf16 v[72:75], v[176:179], v[156:159], v[72:75]
ds_read_b64_tr_b16 v[144:145], v25 offset:20480
v_fmac_f32 v27, v30, v30
v_mfma_f32_16x16x32_bf16 v[76:79], v[180:183], v[156:159], v[76:79]
ds_read_b64_tr_b16 v[146:147], v25 offset:21760
v_add_f32 v26, v26, v31
v_mfma_f32_16x16x32_bf16 v[80:83], v[184:187], v[156:159], v[80:83]
ds_read_b128 v[120:123], v16 offset:43008
v_fmac_f32 v27, v31, v31
v_mfma_f32_16x16x32_bf16 v[84:87], v[172:175], v[160:163], v[84:87]
ds_read_b128 v[124:127], v18 offset:36864
v_lshlrev_b32 v32, 16, v171
v_mfma_f32_16x16x32_bf16 v[88:91], v[176:179], v[160:163], v[88:91]
ds_read_b128 v[128:131], v20 offset:36864
v_and_b32 v33, s87, v171
v_mfma_f32_16x16x32_bf16 v[92:95], v[180:183], v[160:163], v[92:95]
v_add_f32 v26, v26, v32
v_mfma_f32_16x16x32_bf16 v[96:99], v[184:187], v[160:163], v[96:99]
v_fmac_f32 v27, v32, v32
v_mfma_f32_16x16x32_bf16 v[100:103], v[172:175], v[164:167], v[100:103]
v_add_f32 v26, v26, v33
v_mfma_f32_16x16x32_bf16 v[104:107], v[176:179], v[164:167], v[104:107]
v_fmac_f32 v27, v33, v33
ds_read_b64_tr_b16 v[172:173], v22 offset:25600
s_waitcnt lgkmcnt(12)
v_mfma_f32_16x16x32_bf16 v[36:39], v[132:135], v[108:111], v[36:39]
ds_read_b64_tr_b16 v[174:175], v22 offset:26880
s_waitcnt lgkmcnt(2)
v_lshlrev_b32 v30, 16, v128
v_and_b32 v31, s87, v128
v_mfma_f32_16x16x32_bf16 v[40:43], v[136:139], v[108:111], v[40:43]
ds_read_b128 v[148:151], v17 offset:36864
v_add_f32 v26, v26, v30
v_fmac_f32 v27, v30, v30
v_mfma_f32_16x16x32_bf16 v[44:47], v[140:143], v[108:111], v[44:47]
ds_read_b64_tr_b16 v[176:177], v23 offset:25600
v_add_f32 v26, v26, v31
v_fmac_f32 v27, v31, v31
v_mfma_f32_16x16x32_bf16 v[48:51], v[144:147], v[108:111], v[48:51]
ds_read_b64_tr_b16 v[178:179], v23 offset:26880
v_lshlrev_b32 v32, 16, v129
v_and_b32 v33, s87, v129
v_mfma_f32_16x16x32_bf16 v[52:55], v[132:135], v[112:115], v[52:55]
ds_read_b128 v[152:155], v17 offset:38912
v_add_f32 v26, v26, v32
v_fmac_f32 v27, v32, v32
v_mfma_f32_16x16x32_bf16 v[56:59], v[136:139], v[112:115], v[56:59]
ds_read_b64_tr_b16 v[180:181], v24 offset:25600
v_add_f32 v26, v26, v33
v_fmac_f32 v27, v33, v33
v_mfma_f32_16x16x32_bf16 v[60:63], v[140:143], v[112:115], v[60:63]
ds_read_b64_tr_b16 v[182:183], v24 offset:26880
v_lshlrev_b32 v30, 16, v130
v_mfma_f32_16x16x32_bf16 v[64:67], v[144:147], v[112:115], v[64:67]
ds_read_b128 v[156:159], v17 offset:40960
v_and_b32 v31, s87, v130
v_mfma_f32_16x16x32_bf16 v[68:71], v[132:135], v[116:119], v[68:71]
ds_read_b64_tr_b16 v[184:185], v25 offset:25600
v_add_f32 v26, v26, v30
v_mfma_f32_16x16x32_bf16 v[72:75], v[136:139], v[116:119], v[72:75]
ds_read_b64_tr_b16 v[186:187], v25 offset:26880
v_fmac_f32 v27, v30, v30
v_mfma_f32_16x16x32_bf16 v[76:79], v[140:143], v[116:119], v[76:79]
ds_read_b128 v[160:163], v17 offset:43008
v_add_f32 v26, v26, v31
v_mfma_f32_16x16x32_bf16 v[80:83], v[144:147], v[116:119], v[80:83]
ds_read_b128 v[164:167], v19 offset:36864
v_fmac_f32 v27, v31, v31
v_mfma_f32_16x16x32_bf16 v[84:87], v[132:135], v[120:123], v[84:87]
ds_read_b128 v[168:171], v21 offset:36864
v_lshlrev_b32 v32, 16, v131
v_mfma_f32_16x16x32_bf16 v[88:91], v[136:139], v[120:123], v[88:91]
v_and_b32 v33, s87, v131
v_mfma_f32_16x16x32_bf16 v[92:95], v[140:143], v[120:123], v[92:95]
v_add_f32 v26, v26, v32
v_mfma_f32_16x16x32_bf16 v[96:99], v[144:147], v[120:123], v[96:99]
v_fmac_f32 v27, v32, v32
v_mfma_f32_16x16x32_bf16 v[100:103], v[132:135], v[124:127], v[100:103]
v_add_f32 v26, v26, v33
v_mfma_f32_16x16x32_bf16 v[104:107], v[136:139], v[124:127], v[104:107]
v_fmac_f32 v27, v33, v33
s_waitcnt vmcnt(0)
s_barrier
s_waitcnt lgkmcnt(11)
v_mfma_f32_16x16x32_bf16 v[36:39], v[172:175], v[148:151], v[36:39]
ds_read_b64_tr_b16 v[132:133], v22 offset:0
s_waitcnt lgkmcnt(1)
v_lshlrev_b32 v30, 16, v168
v_and_b32 v31, s87, v168
v_mfma_f32_16x16x32_bf16 v[40:43], v[176:179], v[148:151], v[40:43]
ds_read_b64_tr_b16 v[134:135], v22 offset:1280
v_add_f32 v26, v26, v30
v_fmac_f32 v27, v30, v30
v_mfma_f32_16x16x32_bf16 v[44:47], v[180:183], v[148:151], v[44:47]
ds_read_b128 v[108:111], v16 offset:0
v_add_f32 v26, v26, v31
v_fmac_f32 v27, v31, v31
v_mfma_f32_16x16x32_bf16 v[48:51], v[184:187], v[148:151], v[48:51]
ds_read_b64_tr_b16 v[136:137], v23 offset:0
v_lshlrev_b32 v32, 16, v169
v_and_b32 v33, s87, v169
v_mfma_f32_16x16x32_bf16 v[52:55], v[172:175], v[152:155], v[52:55]
ds_read_b64_tr_b16 v[138:139], v23 offset:1280
v_add_f32 v26, v26, v32
v_fmac_f32 v27, v32, v32
v_mfma_f32_16x16x32_bf16 v[56:59], v[176:179], v[152:155], v[56:59]
ds_read_b128 v[112:115], v16 offset:2048
v_add_f32 v26, v26, v33
v_fmac_f32 v27, v33, v33
v_mfma_f32_16x16x32_bf16 v[60:63], v[180:183], v[152:155], v[60:63]
ds_read_b64_tr_b16 v[140:141], v24 offset:0
v_lshlrev_b32 v30, 16, v170
v_mfma_f32_16x16x32_bf16 v[64:67], v[184:187], v[152:155], v[64:67]
ds_read_b64_tr_b16 v[142:143], v24 offset:1280
v_and_b32 v31, s87, v170
v_mfma_f32_16x16x32_bf16 v[68:71], v[172:175], v[156:159], v[68:71]
ds_read_b128 v[116:119], v16 offset:4096
v_add_f32 v26, v26, v30
v_mfma_f32_16x16x32_bf16 v[72:75], v[176:179], v[156:159], v[72:75]
ds_read_b64_tr_b16 v[144:145], v25 offset:0
v_fmac_f32 v27, v30, v30
v_mfma_f32_16x16x32_bf16 v[76:79], v[180:183], v[156:159], v[76:79]
ds_read_b64_tr_b16 v[146:147], v25 offset:1280
v_add_f32 v26, v26, v31
v_mfma_f32_16x16x32_bf16 v[80:83], v[184:187], v[156:159], v[80:83]
ds_read_b128 v[120:123], v16 offset:6144
v_fmac_f32 v27, v31, v31
v_mfma_f32_16x16x32_bf16 v[84:87], v[172:175], v[160:163], v[84:87]
ds_read_b128 v[124:127], v18 offset:0
v_lshlrev_b32 v32, 16, v171
v_mfma_f32_16x16x32_bf16 v[88:91], v[176:179], v[160:163], v[88:91]
ds_read_b128 v[128:131], v20 offset:0
v_and_b32 v33, s87, v171
v_mfma_f32_16x16x32_bf16 v[92:95], v[180:183], v[160:163], v[92:95]
v_add_f32 v26, v26, v32
v_mfma_f32_16x16x32_bf16 v[96:99], v[184:187], v[160:163], v[96:99]
v_fmac_f32 v27, v32, v32
v_mfma_f32_16x16x32_bf16 v[100:103], v[172:175], v[164:167], v[100:103]
v_add_f32 v26, v26, v33
v_mfma_f32_16x16x32_bf16 v[104:107], v[176:179], v[164:167], v[104:107]
v_fmac_f32 v27, v33, v33
ds_read_b128 v[168:171], v21 offset:0
s_waitcnt lgkmcnt(12)
v_mfma_f32_16x16x32_bf16 v[36:39], v[132:135], v[108:111], v[36:39]
ds_read_b64_tr_b16 v[172:173], v22 offset:5120
s_waitcnt lgkmcnt(2)
v_lshlrev_b32 v30, 16, v128
v_and_b32 v31, s87, v128
v_mfma_f32_16x16x32_bf16 v[40:43], v[136:139], v[108:111], v[40:43]
ds_read_b64_tr_b16 v[174:175], v22 offset:6400
v_add_f32 v26, v26, v30
v_fmac_f32 v27, v30, v30
v_mfma_f32_16x16x32_bf16 v[44:47], v[140:143], v[108:111], v[44:47]
ds_read_b128 v[148:151], v17 offset:0
v_add_f32 v26, v26, v31
v_fmac_f32 v27, v31, v31
v_mfma_f32_16x16x32_bf16 v[48:51], v[144:147], v[108:111], v[48:51]
ds_read_b64_tr_b16 v[176:177], v23 offset:5120
v_lshlrev_b32 v32, 16, v129
v_and_b32 v33, s87, v129
v_mfma_f32_16x16x32_bf16 v[52:55], v[132:135], v[112:115], v[52:55]
ds_read_b64_tr_b16 v[178:179], v23 offset:6400
v_add_f32 v26, v26, v32
v_fmac_f32 v27, v32, v32
v_mfma_f32_16x16x32_bf16 v[56:59], v[136:139], v[112:115], v[56:59]
ds_read_b128 v[152:155], v17 offset:2048
v_add_f32 v26, v26, v33
v_fmac_f32 v27, v33, v33
v_mfma_f32_16x16x32_bf16 v[60:63], v[140:143], v[112:115], v[60:63]
ds_read_b64_tr_b16 v[180:181], v24 offset:5120
v_lshlrev_b32 v30, 16, v130
v_and_b32 v31, s87, v130
v_add_f32 v26, v26, v30
v_mfma_f32_16x16x32_bf16 v[64:67], v[144:147], v[112:115], v[64:67]
ds_read_b64_tr_b16 v[182:183], v24 offset:6400
v_fmac_f32 v27, v30, v30
v_add_f32 v26, v26, v31
v_fmac_f32 v27, v31, v31
v_mfma_f32_16x16x32_bf16 v[68:71], v[132:135], v[116:119], v[68:71]
ds_read_b128 v[156:159], v17 offset:4096
v_lshlrev_b32 v32, 16, v131
v_and_b32 v33, s87, v131
v_add_f32 v26, v26, v32
v_mfma_f32_16x16x32_bf16 v[72:75], v[136:139], v[116:119], v[72:75]
ds_read_b64_tr_b16 v[184:185], v25 offset:5120
v_fmac_f32 v27, v32, v32
v_add_f32 v26, v26, v33
v_fmac_f32 v27, v33, v33
v_mfma_f32_16x16x32_bf16 v[76:79], v[140:143], v[116:119], v[76:79]
ds_read_b64_tr_b16 v[186:187], v25 offset:6400
s_waitcnt lgkmcnt(11)
v_lshlrev_b32 v30, 16, v168
v_and_b32 v31, s87, v168
v_add_f32 v26, v26, v30
v_mfma_f32_16x16x32_bf16 v[80:83], v[144:147], v[116:119], v[80:83]
ds_read_b128 v[160:163], v17 offset:6144
v_fmac_f32 v27, v30, v30
v_add_f32 v26, v26, v31
v_fmac_f32 v27, v31, v31
v_mfma_f32_16x16x32_bf16 v[84:87], v[132:135], v[120:123], v[84:87]
ds_read_b128 v[164:167], v19 offset:0
v_lshlrev_b32 v32, 16, v169
v_and_b32 v33, s87, v169
v_add_f32 v26, v26, v32
v_mfma_f32_16x16x32_bf16 v[88:91], v[136:139], v[120:123], v[88:91]
v_fmac_f32 v27, v32, v32
v_add_f32 v26, v26, v33
v_fmac_f32 v27, v33, v33
v_mfma_f32_16x16x32_bf16 v[92:95], v[140:143], v[120:123], v[92:95]
v_lshlrev_b32 v30, 16, v170
v_and_b32 v31, s87, v170
v_add_f32 v26, v26, v30
v_mfma_f32_16x16x32_bf16 v[96:99], v[144:147], v[120:123], v[96:99]
v_fmac_f32 v27, v30, v30
v_add_f32 v26, v26, v31
v_fmac_f32 v27, v31, v31
v_mfma_f32_16x16x32_bf16 v[100:103], v[132:135], v[124:127], v[100:103]
v_lshlrev_b32 v32, 16, v171
v_and_b32 v33, s87, v171
v_add_f32 v26, v26, v32
v_mfma_f32_16x16x32_bf16 v[104:107], v[136:139], v[124:127], v[104:107]
v_fmac_f32 v27, v32, v32
v_add_f32 v26, v26, v33
v_fmac_f32 v27, v33, v33
s_waitcnt lgkmcnt(10)
v_mfma_f32_16x16x32_bf16 v[36:39], v[172:175], v[148:151], v[36:39]
v_mov_b32 v30, v26
v_mov_b32 v31, v27
s_waitcnt lgkmcnt(8)
v_mfma_f32_16x16x32_bf16 v[40:43], v[176:179], v[148:151], v[40:43]
v_permlane32_swap_b32 v30, v26
v_permlane32_swap_b32 v31, v27
s_waitcnt lgkmcnt(5)
v_mfma_f32_16x16x32_bf16 v[44:47], v[180:183], v[148:151], v[44:47]
v_add_f32 v26, v26, v30
v_add_f32 v27, v27, v31
s_waitcnt lgkmcnt(2)
v_mfma_f32_16x16x32_bf16 v[48:51], v[184:187], v[148:151], v[48:51]
v_mov_b32 v30, v26
v_mov_b32 v31, v27
v_mfma_f32_16x16x32_bf16 v[52:55], v[172:175], v[152:155], v[52:55]
v_permlane16_swap_b32 v30, v26
v_permlane16_swap_b32 v31, v27
v_mfma_f32_16x16x32_bf16 v[56:59], v[176:179], v[152:155], v[56:59]
v_add_f32 v26, v26, v30
v_add_f32 v27, v27, v31
v_mfma_f32_16x16x32_bf16 v[60:63], v[180:183], v[152:155], v[60:63]
v_mul_f32 v26, 0x3acccccd, v26
v_mul_f32 v27, 0x3acccccd, v27
v_mfma_f32_16x16x32_bf16 v[64:67], v[184:187], v[152:155], v[64:67]
v_fma_f32 v27, -v26, v26, v27
v_max_f32 v27, 0, v27
v_mfma_f32_16x16x32_bf16 v[68:71], v[172:175], v[156:159], v[68:71]
v_cvt_pk_bf16_f32 v26, v26, v26
v_and_b32 v26, s87, v26
v_mfma_f32_16x16x32_bf16 v[72:75], v[176:179], v[156:159], v[72:75]
v_cvt_pk_bf16_f32 v27, v27, v27
v_and_b32 v27, s87, v27
v_mfma_f32_16x16x32_bf16 v[76:79], v[180:183], v[156:159], v[76:79]
v_add_f32 v27, 0x3727c5ac, v27
v_cvt_pk_bf16_f32 v27, v27, v27
v_mfma_f32_16x16x32_bf16 v[80:83], v[184:187], v[156:159], v[80:83]
v_and_b32 v27, s87, v27
v_sqrt_f32 v27, v27
s_waitcnt lgkmcnt(1)
v_mfma_f32_16x16x32_bf16 v[84:87], v[172:175], v[160:163], v[84:87]
s_nop 0
v_cvt_pk_bf16_f32 v27, v27, v27
v_mfma_f32_16x16x32_bf16 v[88:91], v[176:179], v[160:163], v[88:91]
v_and_b32 v27, s87, v27
v_mfma_f32_16x16x32_bf16 v[92:95], v[180:183], v[160:163], v[92:95]
v_rcp_f32 v30, v27
v_mfma_f32_16x16x32_bf16 v[96:99], v[184:187], v[160:163], v[96:99]
s_nop 0
s_waitcnt lgkmcnt(0)
v_mfma_f32_16x16x32_bf16 v[100:103], v[172:175], v[164:167], v[100:103]
v_mul_f32 v27, v26, v30
v_mfma_f32_16x16x32_bf16 v[104:107], v[176:179], v[164:167], v[104:107]
v_mov_b32 v26, v30
s_cmp_eq_u32 s14, 0
s_cbranch_scc0 nl3
s_mov_b32 s28, s84
s_and_b32 s29, s85, 0xffff
s_mov_b32 s30, 256
s_mov_b32 s31, 0x20000
v_mov_b32 v255, 0
buffer_load_dword v252, v255, s[28:31], 0 offen sc1
nl3:
s_cmp_eq_u32 s14, 0
s_cbranch_scc0 pl4
s_add_u32 s28, s8, 25165824
s_addc_u32 s29, s9, 0
s_and_b32 s29, s29, 0xffff
s_mov_b32 s30, 8192
s_mov_b32 s31, 0x20000
v_lshlrev_b32 v255, 2, v0
v_add_u32 v255, 4096, v255
buffer_load_dword v253, v255, s[28:31], 0 offen sc1
v_and_b32 v249, 3, v0
v_lshlrev_b32 v249, 2, v249
v_add_u32 v249, 4352, v249
buffer_load_dword v254, v249, s[28:31], 0 offen sc1
pl4:
ds_write_b64 v219, v[26:27]
s_mov_b32 exec_lo, 0x00010001
s_mov_b32 exec_hi, 0x00010001
ds_write_b128 v220, v[100:103]
ds_write_b128 v221, v[104:107]
s_mov_b64 exec, -1
s_waitcnt lgkmcnt(0)
s_barrier
ds_read_b64 v[108:109], v213 offset:0
ds_read_b64 v[110:111], v213 offset:128
ds_read_b64 v[112:113], v213 offset:256
ds_read_b64 v[114:115], v213 offset:384
ds_read_b128 v[120:123], v215
ds_read_b128 v[124:127], v216
ds_read_b128 v[128:131], v217
ds_read_b128 v[132:135], v218
ds_read_b64 v[116:117], v214
s_waitcnt lgkmcnt(0)
v_pk_mul_f32 v[140:141], v[120:121], v[108:109] op_sel:[0,1] op_sel_hi:[1,1]
v_pk_mul_f32 v[142:143], v[122:123], v[108:109] op_sel:[0,1] op_sel_hi:[1,1]
v_pk_fma_f32 v[140:141], v[36:37], v[108:109], v[140:141] op_sel_hi:[1,0,1] neg_lo:[0,0,1] neg_hi:[0,0,1]
v_pk_fma_f32 v[142:143], v[38:39], v[108:109], v[142:143] op_sel_hi:[1,0,1] neg_lo:[0,0,1] neg_hi:[0,0,1]
v_cvt_pk_bf16_f32 v144, v140, v141
v_cvt_pk_bf16_f32 v145, v142, v143
ds_write_b64 v188, v[144:145] offset:0
v_pk_mul_f32 v[148:149], v[124:125], v[108:109] op_sel:[0,1] op_sel_hi:[1,1]
v_pk_mul_f32 v[150:151], v[126:127], v[108:109] op_sel:[0,1] op_sel_hi:[1,1]
v_pk_fma_f32 v[148:149], v[40:41], v[108:109], v[148:149] op_sel_hi:[1,0,1] neg_lo:[0,0,1] neg_hi:[0,0,1]
v_pk_fma_f32 v[150:151], v[42:43], v[108:109], v[150:151] op_sel_hi:[1,0,1] neg_lo:[0,0,1] neg_hi:[0,0,1]
v_cvt_pk_bf16_f32 v152, v148, v149
v_cvt_pk_bf16_f32 v153, v150, v151
ds_write_b64 v189, v[152:153] offset:0
v_pk_mul_f32 v[140:141], v[128:129], v[108:109] op_sel:[0,1] op_sel_hi:[1,1]
v_pk_mul_f32 v[142:143], v[130:131], v[108:109] op_sel:[0,1] op_sel_hi:[1,1]
v_pk_fma_f32 v[140:141], v[44:45], v[108:109], v[140:141] op_sel_hi:[1,0,1] neg_lo:[0,0,1] neg_hi:[0,0,1]
v_pk_fma_f32 v[142:143], v[46:47], v[108:109], v[142:143] op_sel_hi:[1,0,1] neg_lo:[0,0,1] neg_hi:[0,0,1]
v_cvt_pk_bf16_f32 v144, v140, v141
v_cvt_pk_bf16_f32 v145, v142, v143
ds_write_b64 v190, v[144:145] offset:0
v_pk_mul_f32 v[148:149], v[132:133], v[108:109] op_sel:[0,1] op_sel_hi:[1,1]
v_pk_mul_f32 v[150:151], v[134:135], v[108:109] op_sel:[0,1] op_sel_hi:[1,1]
v_pk_fma_f32 v[148:149], v[48:49], v[108:109], v[148:149] op_sel_hi:[1,0,1] neg_lo:[0,0,1] neg_hi:[0,0,1]
v_pk_fma_f32 v[150:151], v[50:51], v[108:109], v[150:151] op_sel_hi:[1,0,1] neg_lo:[0,0,1] neg_hi:[0,0,1]
v_cvt_pk_bf16_f32 v152, v148, v149
v_cvt_pk_bf16_f32 v153, v150, v151
ds_write_b64 v191, v[152:153] offset:0
v_pk_mul_f32 v[140:141], v[120:121], v[110:111] op_sel:[0,1] op_sel_hi:[1,1]
v_pk_mul_f32 v[142:143], v[122:123], v[110:111] op_sel:[0,1] op_sel_hi:[1,1]
v_pk_fma_f32 v[140:141], v[52:53], v[110:111], v[140:141] op_sel_hi:[1,0,1] neg_lo:[0,0,1] neg_hi:[0,0,1]
v_pk_fma_f32 v[142:143], v[54:55], v[110:111], v[142:143] op_sel_hi:[1,0,1] neg_lo:[0,0,1] neg_hi:[0,0,1]
v_cvt_pk_bf16_f32 v144, v140, v141
v_cvt_pk_bf16_f32 v145, v142, v143
ds_write_b64 v188, v[144:145] offset:2560
v_pk_mul_f32 v[148:149], v[124:125], v[110:111] op_sel:[0,1] op_sel_hi:[1,1]
v_pk_mul_f32 v[150:151], v[126:127], v[110:111] op_sel:[0,1] op_sel_hi:[1,1]
v_pk_fma_f32 v[148:149], v[56:57], v[110:111], v[148:149] op_sel_hi:[1,0,1] neg_lo:[0,0,1] neg_hi:[0,0,1]
v_pk_fma_f32 v[150:151], v[58:59], v[110:111], v[150:151] op_sel_hi:[1,0,1] neg_lo:[0,0,1] neg_hi:[0,0,1]
v_cvt_pk_bf16_f32 v152, v148, v149
v_cvt_pk_bf16_f32 v153, v150, v151
ds_write_b64 v189, v[152:153] offset:2560
v_pk_mul_f32 v[140:141], v[128:129], v[110:111] op_sel:[0,1] op_sel_hi:[1,1]
v_pk_mul_f32 v[142:143], v[130:131], v[110:111] op_sel:[0,1] op_sel_hi:[1,1]
v_pk_fma_f32 v[140:141], v[60:61], v[110:111], v[140:141] op_sel_hi:[1,0,1] neg_lo:[0,0,1] neg_hi:[0,0,1]
v_pk_fma_f32 v[142:143], v[62:63], v[110:111], v[142:143] op_sel_hi:[1,0,1] neg_lo:[0,0,1] neg_hi:[0,0,1]
v_cvt_pk_bf16_f32 v144, v140, v141
v_cvt_pk_bf16_f32 v145, v142, v143
ds_write_b64 v190, v[144:145] offset:2560
v_pk_mul_f32 v[148:149], v[132:133], v[110:111] op_sel:[0,1] op_sel_hi:[1,1]
v_pk_mul_f32 v[150:151], v[134:135], v[110:111] op_sel:[0,1] op_sel_hi:[1,1]
v_pk_fma_f32 v[148:149], v[64:65], v[110:111], v[148:149] op_sel_hi:[1,0,1] neg_lo:[0,0,1] neg_hi:[0,0,1]
v_pk_fma_f32 v[150:151], v[66:67], v[110:111], v[150:151] op_sel_hi:[1,0,1] neg_lo:[0,0,1] neg_hi:[0,0,1]
v_cvt_pk_bf16_f32 v152, v148, v149
v_cvt_pk_bf16_f32 v153, v150, v151
ds_write_b64 v191, v[152:153] offset:2560
v_pk_mul_f32 v[140:141], v[120:121], v[112:113] op_sel:[0,1] op_sel_hi:[1,1]
v_pk_mul_f32 v[142:143], v[122:123], v[112:113] op_sel:[0,1] op_sel_hi:[1,1]
v_pk_fma_f32 v[140:141], v[68:69], v[112:113], v[140:141] op_sel_hi:[1,0,1] neg_lo:[0,0,1] neg_hi:[0,0,1]
v_pk_fma_f32 v[142:143], v[70:71], v[112:113], v[142:143] op_sel_hi:[1,0,1] neg_lo:[0,0,1] neg_hi:[0,0,1]
v_cvt_pk_bf16_f32 v144, v140, v141
v_cvt_pk_bf16_f32 v145, v142, v143
ds_write_b64 v188, v[144:145] offset:5120
v_pk_mul_f32 v[148:149], v[124:125], v[112:113] op_sel:[0,1] op_sel_hi:[1,1]
v_pk_mul_f32 v[150:151], v[126:127], v[112:113] op_sel:[0,1] op_sel_hi:[1,1]
v_pk_fma_f32 v[148:149], v[72:73], v[112:113], v[148:149] op_sel_hi:[1,0,1] neg_lo:[0,0,1] neg_hi:[0,0,1]
v_pk_fma_f32 v[150:151], v[74:75], v[112:113], v[150:151] op_sel_hi:[1,0,1] neg_lo:[0,0,1] neg_hi:[0,0,1]
v_cvt_pk_bf16_f32 v152, v148, v149
v_cvt_pk_bf16_f32 v153, v150, v151
ds_write_b64 v189, v[152:153] offset:5120
v_pk_mul_f32 v[140:141], v[128:129], v[112:113] op_sel:[0,1] op_sel_hi:[1,1]
v_pk_mul_f32 v[142:143], v[130:131], v[112:113] op_sel:[0,1] op_sel_hi:[1,1]
v_pk_fma_f32 v[140:141], v[76:77], v[112:113], v[140:141] op_sel_hi:[1,0,1] neg_lo:[0,0,1] neg_hi:[0,0,1]
v_pk_fma_f32 v[142:143], v[78:79], v[112:113], v[142:143] op_sel_hi:[1,0,1] neg_lo:[0,0,1] neg_hi:[0,0,1]
v_cvt_pk_bf16_f32 v144, v140, v141
v_cvt_pk_bf16_f32 v145, v142, v143
ds_write_b64 v190, v[144:145] offset:5120
v_pk_mul_f32 v[148:149], v[132:133], v[112:113] op_sel:[0,1] op_sel_hi:[1,1]
v_pk_mul_f32 v[150:151], v[134:135], v[112:113] op_sel:[0,1] op_sel_hi:[1,1]
v_pk_fma_f32 v[148:149], v[80:81], v[112:113], v[148:149] op_sel_hi:[1,0,1] neg_lo:[0,0,1] neg_hi:[0,0,1]
v_pk_fma_f32 v[150:151], v[82:83], v[112:113], v[150:151] op_sel_hi:[1,0,1] neg_lo:[0,0,1] neg_hi:[0,0,1]
v_cvt_pk_bf16_f32 v152, v148, v149
v_cvt_pk_bf16_f32 v153, v150, v151
ds_write_b64 v191, v[152:153] offset:5120
v_pk_mul_f32 v[140:141], v[120:121], v[114:115] op_sel:[0,1] op_sel_hi:[1,1]
v_pk_mul_f32 v[142:143], v[122:123], v[114:115] op_sel:[0,1] op_sel_hi:[1,1]
v_pk_fma_f32 v[140:141], v[84:85], v[114:115], v[140:141] op_sel_hi:[1,0,1] neg_lo:[0,0,1] neg_hi:[0,0,1]
v_pk_fma_f32 v[142:143], v[86:87], v[114:115], v[142:143] op_sel_hi:[1,0,1] neg_lo:[0,0,1] neg_hi:[0,0,1]
v_cvt_pk_bf16_f32 v144, v140, v141
v_cvt_pk_bf16_f32 v145, v142, v143
ds_write_b64 v188, v[144:145] offset:7680
v_pk_mul_f32 v[148:149], v[124:125], v[114:115] op_sel:[0,1] op_sel_hi:[1,1]
v_pk_mul_f32 v[150:151], v[126:127], v[114:115] op_sel:[0,1] op_sel_hi:[1,1]
v_pk_fma_f32 v[148:149], v[88:89], v[114:115], v[148:149] op_sel_hi:[1,0,1] neg_lo:[0,0,1] neg_hi:[0,0,1]
v_pk_fma_f32 v[150:151], v[90:91], v[114:115], v[150:151] op_sel_hi:[1,0,1] neg_lo:[0,0,1] neg_hi:[0,0,1]
v_cvt_pk_bf16_f32 v152, v148, v149
v_cvt_pk_bf16_f32 v153, v150, v151
ds_write_b64 v189, v[152:153] offset:7680
v_pk_mul_f32 v[140:141], v[128:129], v[114:115] op_sel:[0,1] op_sel_hi:[1,1]
v_pk_mul_f32 v[142:143], v[130:131], v[114:115] op_sel:[0,1] op_sel_hi:[1,1]
v_pk_fma_f32 v[140:141], v[92:93], v[114:115], v[140:141] op_sel_hi:[1,0,1] neg_lo:[0,0,1] neg_hi:[0,0,1]
v_pk_fma_f32 v[142:143], v[94:95], v[114:115], v[142:143] op_sel_hi:[1,0,1] neg_lo:[0,0,1] neg_hi:[0,0,1]
v_cvt_pk_bf16_f32 v144, v140, v141
v_cvt_pk_bf16_f32 v145, v142, v143
ds_write_b64 v190, v[144:145] offset:7680
v_pk_mul_f32 v[148:149], v[132:133], v[114:115] op_sel:[0,1] op_sel_hi:[1,1]
v_pk_mul_f32 v[150:151], v[134:135], v[114:115] op_sel:[0,1] op_sel_hi:[1,1]
v_pk_fma_f32 v[148:149], v[96:97], v[114:115], v[148:149] op_sel_hi:[1,0,1] neg_lo:[0,0,1] neg_hi:[0,0,1]
v_pk_fma_f32 v[150:151], v[98:99], v[114:115], v[150:151] op_sel_hi:[1,0,1] neg_lo:[0,0,1] neg_hi:[0,0,1]
v_cvt_pk_bf16_f32 v152, v148, v149
v_cvt_pk_bf16_f32 v153, v150, v151
ds_write_b64 v191, v[152:153] offset:7680
v_pk_mul_f32 v[140:141], v[120:121], v[116:117] op_sel:[0,1] op_sel_hi:[1,1]
v_pk_mul_f32 v[142:143], v[122:123], v[116:117] op_sel:[0,1] op_sel_hi:[1,1]
v_pk_fma_f32 v[140:141], v[100:101], v[116:117], v[140:141] op_sel_hi:[1,0,1] neg_lo:[0,0,1] neg_hi:[0,0,1]
v_pk_fma_f32 v[142:143], v[102:103], v[116:117], v[142:143] op_sel_hi:[1,0,1] neg_lo:[0,0,1] neg_hi:[0,0,1]
v_cvt_pk_bf16_f32 v144, v140, v141
v_cvt_pk_bf16_f32 v145, v142, v143
ds_write_b64 v192, v[144:145] offset:0
v_pk_mul_f32 v[148:149], v[124:125], v[116:117] op_sel:[0,1] op_sel_hi:[1,1]
v_pk_mul_f32 v[150:151], v[126:127], v[116:117] op_sel:[0,1] op_sel_hi:[1,1]
v_pk_fma_f32 v[148:149], v[104:105], v[116:117], v[148:149] op_sel_hi:[1,0,1] neg_lo:[0,0,1] neg_hi:[0,0,1]
v_pk_fma_f32 v[150:151], v[106:107], v[116:117], v[150:151] op_sel_hi:[1,0,1] neg_lo:[0,0,1] neg_hi:[0,0,1]
v_cvt_pk_bf16_f32 v152, v148, v149
v_cvt_pk_bf16_f32 v153, v150, v151
ds_write_b64 v193, v[152:153] offset:0
s_cmp_eq_u32 s14, 0
s_cbranch_scc0 e25
s_waitcnt vmcnt(0)
s_mov_b32 s33, 0
ng6:
v_readfirstlane_b32 s52, v252
s_nop 3
s_cmp_lg_u32 s52, 0
s_cbranch_scc1 ng7
s_mov_b32 s28, s84
s_and_b32 s29, s85, 0xffff
s_mov_b32 s30, 256
s_mov_b32 s31, 0x20000
s_sleep 8
v_mov_b32 v255, 0
buffer_load_dword v252, v255, s[28:31], 0 offen sc1
s_waitcnt vmcnt(0)
s_add_u32 s33, s33, 1
s_cmp_lt_u32 s33, 0x20000
s_cbranch_scc1 ng6
ng7:
s_mov_b32 s33, 0
pc8:
v_cmp_ne_u32 vcc, s52, v253
v_cmp_ne_u32 s[54:55], s52, v254
s_nop 3
s_or_b64 vcc, vcc, s[54:55]
s_cmp_eq_u64 vcc, 0
s_cbranch_scc1 pc9
s_sleep 4
s_add_u32 s28, s8, 25165824
s_addc_u32 s29, s9, 0
s_and_b32 s29, s29, 0xffff
s_mov_b32 s30, 8192
s_mov_b32 s31, 0x20000
v_lshlrev_b32 v255, 2, v0
v_add_u32 v255, 4096, v255
buffer_load_dword v253, v255, s[28:31], 0 offen sc1
v_and_b32 v249, 3, v0
v_lshlrev_b32 v249, 2, v249
v_add_u32 v249, 4352, v249
buffer_load_dword v254, v249, s[28:31], 0 offen sc1
s_waitcnt vmcnt(0)
s_add_u32 s33, s33, 1
s_cmp_lt_u32 s33, 0x20000
s_cbranch_scc1 pc8
pc9:
v_mov_b32 v22, 99328
v_mov_b32 v23, s52
ds_write_b32 v22, v23
e25:
s_waitcnt lgkmcnt(0)
s_barrier
s_mov_b32 s53, 1
s_lshl_b32 s66, s12, 7
s_lshl_b32 s29, s13, 2
s_add_u32 s66, s66, s29
s_and_b32 s10, s2, 7
s_lshr_b32 s11, s2, 3
s_lshr_b32 s12, s10, 1
s_lshl_b32 s12, s12, 3
s_and_b32 s13, s11, 7
s_add_u32 s12, s12, s13
s_and_b32 s13, s10, 1
s_lshl_b32 s13, s13, 2
s_lshr_b32 s15, s11, 3
s_add_u32 s13, s13, s15
v_lshlrev_b32 v2, 4, v0
s_and_b32 s15, s14, 3
s_lshr_b32 s16, s14, 2
s_lshl_b32 s20, s14, 10
s_lshl_b32 s23, s16, 13
s_add_u32 s20, s20, s23
s_mul_i32 s19, s13, 348160
s_add_u32 s21, s20, 4096
s_add_u32 s22, s20, 8192
s_add_u32 s23, s19, s20
s_add_u32 s24, s19, s21
s_add_u32 s25, s19, s22
s_add_u32 s20, s20, 102400
s_add_u32 s21, s21, 102400
s_add_u32 s22, s22, 102400
s_add_u32 s32, s8, 16777216
s_addc_u32 s33, s9, 0
s_and_b32 s33, s33, 0xffff
s_mov_b32 s34, 2785280
s_mov_b32 s35, 0x20000
s_lshl_b32 s17, s12, 2
s_add_u32 s17, s17, s15
s_mul_i32 s18, s17, 69632
s_lshl_b32 s19, s16, 11
s_add_u32 s18, s18, s19
s_lshl_b32 s26, s14, 11
s_lshr_b32 s38, s12, 1
s_lshl_b32 s38, s38, 7
s_and_b32 s39, s12, 1
s_add_u32 s38, s38, s39
s_lshl_b32 s39, s15, 5
s_add_u32 s38, s38, s39
v_and_b32 v3, 15, v0
v_lshlrev_b32 v3, 1, v3
v_add_u32 v3, s38, v3
v_mul_u32_u24 v3, 1280, v3
v_lshrrev_b32 v4, 4, v0
s_mul_i32 s39, s13, 160
v_add_u32 v3, s39, v3
v_lshlrev_b32 v5, 4, v4
v_add_u32 v5, v3, v5
s_lshl_b32 s39, s16, 6
v_add_u32 v5, s39, v5
v_lshlrev_b32 v6, 3, v4
v_add_u32 v6, v3, v6
v_add_u32 v6, 128, v6
s_mov_b32 s40, s4
s_and_b32 s41, s5, 0xffff
s_mov_b32 s42, 2621440
s_mov_b32 s43, 0x20000
s_mov_b32 s44, s96
s_and_b32 s45, s97, 0xffff
s_mov_b32 s46, 2621440
s_mov_b32 s47, 0x20000
v_add_u32 v14, 102400, v2
s_lshl_b32 s39, s15, 11
v_add_u32 v15, s39, v2
v_lshlrev_b32 v223, 3, v0
v_add_u32 v223, s39, v223
s_lshr_b32 s38, s12, 1
s_lshl_b32 s38, s38, 7
v_and_b32 v21, 7, v0
v_lshlrev_b32 v21, 2, v21
v_add_u32 v21, s38, v21
v_add_u32 v20, 32, v21
s_cmp_eq_u32 s16, 0
s_cbranch_scc0 wp1_qA
s_add_u32 m0, s20, 0
s_nop 0
buffer_load_dwordx4 v2, s[32:35], s23 offen sc1 lds
s_add_u32 s23, s23, 20480
s_add_u32 m0, s21, 0
s_nop 0
buffer_load_dwordx4 v2, s[32:35], s24 offen sc1 lds
s_add_u32 s24, s24, 20480
s_add_u32 m0, s22, 0
s_nop 0
buffer_load_dwordx4 v2, s[32:35], s25 offen sc1 lds
s_add_u32 s25, s25, 20480
s_add_u32 m0, s20, 20480
s_nop 0
buffer_load_dwordx4 v2, s[32:35], s23 offen sc1 lds
s_add_u32 s23, s23, 20480
s_add_u32 m0, s21, 20480
s_nop 0
buffer_load_dwordx4 v2, s[32:35], s24 offen sc1 lds
s_add_u32 s24, s24, 20480
s_add_u32 m0, s22, 20480
s_nop 0
buffer_load_dwordx4 v2, s[32:35], s25 offen sc1 lds
s_add_u32 s25, s25, 20480
s_add_u32 m0, s20, 40960
s_nop 0
buffer_load_dwordx4 v2, s[32:35], s23 offen sc1 lds
s_add_u32 s23, s23, 20480
s_add_u32 m0, s21, 40960
s_nop 0
buffer_load_dwordx4 v2, s[32:35], s24 offen sc1 lds
s_add_u32 s24, s24, 20480
s_add_u32 m0, s22, 40960
s_nop 0
buffer_load_dwordx4 v2, s[32:35], s25 offen sc1 lds
s_add_u32 s25, s25, 20480
s_branch wp2_qA
wp1_qA:
s_add_u32 m0, s20, 0
s_nop 0
buffer_load_dwordx4 v2, s[32:35], s23 offen sc1 lds
s_add_u32 s23, s23, 20480
s_add_u32 m0, s21, 0
s_nop 0
buffer_load_dwordx4 v2, s[32:35], s24 offen sc1 lds
s_add_u32 s24, s24, 20480
s_add_u32 m0, s20, 20480
s_nop 0
buffer_load_dwordx4 v2, s[32:35], s23 offen sc1 lds
s_add_u32 s23, s23, 20480
s_add_u32 m0, s21, 20480
s_nop 0
buffer_load_dwordx4 v2, s[32:35], s24 offen sc1 lds
s_add_u32 s24, s24, 20480
s_add_u32 m0, s20, 40960
s_nop 0
buffer_load_dwordx4 v2, s[32:35], s23 offen sc1 lds
s_add_u32 s23, s23, 20480
s_add_u32 m0, s21, 40960
s_nop 0
buffer_load_dwordx4 v2, s[32:35], s24 offen sc1 lds
s_add_u32 s24, s24, 20480
wp2_qA:
s_branch q_attn
q_pathB:
v_mov_b32 v240, 0x3f803f80
v_mov_b32 v241, 0x3f803f80
v_mov_b32 v242, 0x3f803f80
v_mov_b32 v243, 0x3f803f80
s_waitcnt vmcnt(6) lgkmcnt(0)
s_barrier
ds_read_b64_tr_b16 v[132:133], v22 offset:0
ds_read_b64_tr_b16 v[134:135], v22 offset:1280
ds_read_b128 v[108:111], v16 offset:0
ds_read_b64_tr_b16 v[136:137], v23 offset:0
ds_read_b64_tr_b16 v[138:139], v23 offset:1280
ds_read_b128 v[112:115], v16 offset:2048
ds_read_b64_tr_b16 v[140:141], v24 offset:0
ds_read_b64_tr_b16 v[142:143], v24 offset:1280
ds_read_b128 v[116:119], v16 offset:4096
ds_read_b128 v[120:123], v16 offset:6144
ds_read_b128 v[124:127], v18 offset:0
ds_read_b128 v[128:131], v20 offset:0
ds_read_b64_tr_b16 v[172:173], v22 offset:5120
s_add_u32 m0, s34, 36864
s_waitcnt lgkmcnt(10)
v_mfma_f32_16x16x32_bf16 v[36:39], v[132:135], v[108:111], 0
ds_read_b64_tr_b16 v[174:175], v22 offset:6400
buffer_load_dwordx4 v10, s[20:23], s48 offen  lds
s_add_u32 m0, s35, 36864
s_waitcnt lgkmcnt(9)
v_mfma_f32_16x16x32_bf16 v[40:43], v[136:139], v[108:111], 0
ds_read_b128 v[148:151], v17 offset:0
buffer_load_dwordx4 v11, s[20:23], s48 offen  lds
s_waitcnt lgkmcnt(7)
v_mfma_f32_16x16x32_bf16 v[44:47], v[140:143], v[108:111], 0
ds_read_b64_tr_b16 v[176:177], v23 offset:5120
ds_read_b64_tr_b16 v[178:179], v23 offset:6400
s_add_u32 m0, s36, 20480
v_mfma_f32_16x16x32_bf16 v[52:55], v[132:135], v[112:115], 0
buffer_load_dwordx4 v12, s[24:27], s49 offen  lds
s_waitcnt lgkmcnt(5)
v_lshlrev_b32 v30, 16, v128
v_and_b32 v31, s87, v128
v_mfma_f32_16x16x32_bf16 v[232:235], v[124:127], v[124:127], 0
ds_read_b128 v[152:155], v17 offset:2048
v_add_f32 v26, v26, v30
v_fmac_f32 v27, v30, v30
v_mfma_f32_16x16x32_bf16 v[56:59], v[136:139], v[112:115], 0
ds_read_b64_tr_b16 v[180:181], v24 offset:5120
v_add_f32 v26, v26, v31
v_fmac_f32 v27, v31, v31
s_add_u32 m0, s37, 20480
v_mfma_f32_16x16x32_bf16 v[60:63], v[140:143], v[112:115], 0
buffer_load_dwordx4 v13, s[24:27], s49 offen  lds
v_lshlrev_b32 v32, 16, v129
v_and_b32 v33, s87, v129
v_mfma_f32_16x16x32_bf16 v[68:71], v[132:135], v[116:119], 0
ds_read_b64_tr_b16 v[182:183], v24 offset:6400
v_add_f32 v26, v26, v32
v_fmac_f32 v27, v32, v32
v_mfma_f32_16x16x32_bf16 v[72:75], v[136:139], v[116:119], 0
ds_read_b128 v[156:159], v17 offset:4096
v_add_f32 v26, v26, v33
v_fmac_f32 v27, v33, v33
s_add_u32 m0, s38, 20480
v_mfma_f32_16x16x32_bf16 v[236:239], v[240:243], v[124:127], 0
buffer_load_dwordx4 v14, s[24:27], s49 offen  lds
v_lshlrev_b32 v30, 16, v130
v_and_b32 v31, s87, v130
v_mfma_f32_16x16x32_bf16 v[76:79], v[140:143], v[116:119], 0
ds_read_b128 v[160:163], v17 offset:6144
v_add_f32 v26, v26, v30
v_fmac_f32 v27, v30, v30
v_mfma_f32_16x16x32_bf16 v[84:87], v[132:135], v[120:123], 0
ds_read_b128 v[164:167], v19 offset:0
v_add_f32 v26, v26, v31
v_fmac_f32 v27, v31, v31
s_mov_b32 m0, s53
v_mfma_f32_16x16x32_bf16 v[88:91], v[136:139], v[120:123], 0
s_mov_b64 exec, s[46:47]
buffer_load_dwordx4 v15, s[40:43], s45 offen  lds
s_mov_b64 exec, -1
s_add_u32 s55, s55, 1
s_cmp_eq_u32 s55, 10
s_cselect_b32 s55, 2, s55
s_lshl_b32 s48, s55, 7
s_mul_i32 s49, s55, 245760
s_mul_i32 s45, s55, s44
v_lshlrev_b32 v32, 16, v131
v_and_b32 v33, s87, v131
v_mfma_f32_16x16x32_bf16 v[92:95], v[140:143], v[120:123], 0
ds_read_b128 v[168:171], v21 offset:0
v_add_f32 v26, v26, v32
v_fmac_f32 v27, v32, v32
v_mfma_f32_16x16x32_bf16 v[100:103], v[132:135], v[124:127], 0
v_add_f32 v26, v26, v33
v_mfma_f32_16x16x32_bf16 v[104:107], v[136:139], v[124:127], 0
v_fmac_f32 v27, v33, v33
s_waitcnt vmcnt(6)
s_barrier
s_add_u32 m0, s34, 0
s_waitcnt lgkmcnt(9)
v_mfma_f32_16x16x32_bf16 v[36:39], v[172:175], v[148:151], v[36:39]
ds_read_b64_tr_b16 v[132:133], v22 offset:10240
buffer_load_dwordx4 v10, s[20:23], s48 offen  lds
s_waitcnt lgkmcnt(8)
v_mfma_f32_16x16x32_bf16 v[40:43], v[176:179], v[148:151], v[40:43]
ds_read_b64_tr_b16 v[134:135], v22 offset:11520
s_waitcnt lgkmcnt(2)
v_lshlrev_b32 v30, 16, v168
v_and_b32 v31, s87, v168
v_mfma_f32_16x16x32_bf16 v[44:47], v[180:183], v[148:151], v[44:47]
ds_read_b128 v[108:111], v16 offset:18432
v_add_f32 v26, v26, v30
v_fmac_f32 v27, v30, v30
v_mfma_f32_16x16x32_bf16 v[52:55], v[172:175], v[152:155], v[52:55]
ds_read_b64_tr_b16 v[136:137], v23 offset:10240
v_add_f32 v26, v26, v31
v_fmac_f32 v27, v31, v31
v_mfma_f32_16x16x32_bf16 v[232:235], v[164:167], v[164:167], v[232:235]
ds_read_b64_tr_b16 v[138:139], v23 offset:11520
v_lshlrev_b32 v32, 16, v169
v_and_b32 v33, s87, v169
s_add_u32 m0, s35, 0
v_mfma_f32_16x16x32_bf16 v[56:59], v[176:179], v[152:155], v[56:59]
buffer_load_dwordx4 v11, s[20:23], s48 offen  lds
v_add_f32 v26, v26, v32
v_fmac_f32 v27, v32, v32
v_mfma_f32_16x16x32_bf16 v[60:63], v[180:183], v[152:155], v[60:63]
ds_read_b128 v[112:115], v16 offset:20480
v_add_f32 v26, v26, v33
v_fmac_f32 v27, v33, v33
v_mfma_f32_16x16x32_bf16 v[68:71], v[172:175], v[156:159], v[68:71]
ds_read_b64_tr_b16 v[140:141], v24 offset:10240
v_lshlrev_b32 v30, 16, v170
v_and_b32 v31, s87, v170
v_mfma_f32_16x16x32_bf16 v[72:75], v[176:179], v[156:159], v[72:75]
ds_read_b64_tr_b16 v[142:143], v24 offset:11520
v_add_f32 v26, v26, v30
v_fmac_f32 v27, v30, v30
v_mfma_f32_16x16x32_bf16 v[236:239], v[240:243], v[164:167], v[236:239]
ds_read_b128 v[116:119], v16 offset:22528
v_add_f32 v26, v26, v31
v_fmac_f32 v27, v31, v31
s_add_u32 m0, s36, 0
v_mfma_f32_16x16x32_bf16 v[76:79], v[180:183], v[156:159], v[76:79]
buffer_load_dwordx4 v12, s[24:27], s49 offen  lds
v_lshlrev_b32 v32, 16, v171
v_mfma_f32_16x16x32_bf16 v[84:87], v[172:175], v[160:163], v[84:87]
ds_read_b128 v[120:123], v16 offset:24576
v_and_b32 v33, s87, v171
v_mfma_f32_16x16x32_bf16 v[88:91], v[176:179], v[160:163], v[88:91]
ds_read_b128 v[124:127], v18 offset:18432
v_add_f32 v26, v26, v32
v_mfma_f32_16x16x32_bf16 v[92:95], v[180:183], v[160:163], v[92:95]
ds_read_b128 v[128:131], v20 offset:18432
v_fmac_f32 v27, v32, v32
v_mfma_f32_16x16x32_bf16 v[100:103], v[172:175], v[164:167], v[100:103]
v_add_f32 v26, v26, v33
v_mfma_f32_16x16x32_bf16 v[104:107], v[176:179], v[164:167], v[104:107]
v_fmac_f32 v27, v33, v33
ds_read_b64_tr_b16 v[172:173], v22 offset:15360
s_waitcnt lgkmcnt(10)
v_mfma_f32_16x16x32_bf16 v[36:39], v[132:135], v[108:111], v[36:39]
ds_read_b64_tr_b16 v[174:175], v22 offset:16640
s_waitcnt lgkmcnt(2)
v_lshlrev_b32 v30, 16, v128
v_and_b32 v31, s87, v128
s_add_u32 m0, s37, 0
v_mfma_f32_16x16x32_bf16 v[40:43], v[136:139], v[108:111], v[40:43]
buffer_load_dwordx4 v13, s[24:27], s49 offen  lds
v_add_f32 v26, v26, v30
v_fmac_f32 v27, v30, v30
v_mfma_f32_16x16x32_bf16 v[44:47], v[140:143], v[108:111], v[44:47]
ds_read_b128 v[148:151], v17 offset:18432
v_add_f32 v26, v26, v31
v_fmac_f32 v27, v31, v31
v_mfma_f32_16x16x32_bf16 v[52:55], v[132:135], v[112:115], v[52:55]
ds_read_b64_tr_b16 v[176:177], v23 offset:15360
v_lshlrev_b32 v32, 16, v129
v_and_b32 v33, s87, v129
v_mfma_f32_16x16x32_bf16 v[232:235], v[124:127], v[124:127], v[232:235]
ds_read_b64_tr_b16 v[178:179], v23 offset:16640
v_add_f32 v26, v26, v32
v_fmac_f32 v27, v32, v32
s_add_u32 m0, s38, 0
v_mfma_f32_16x16x32_bf16 v[56:59], v[136:139], v[112:115], v[56:59]
buffer_load_dwordx4 v14, s[24:27], s49 offen  lds
v_add_f32 v26, v26, v33
v_fmac_f32 v27, v33, v33
v_mfma_f32_16x16x32_bf16 v[60:63], v[140:143], v[112:115], v[60:63]
ds_read_b128 v[152:155], v17 offset:20480
v_lshlrev_b32 v30, 16, v130
v_and_b32 v31, s87, v130
v_mfma_f32_16x16x32_bf16 v[68:71], v[132:135], v[116:119], v[68:71]
ds_read_b64_tr_b16 v[180:181], v24 offset:15360
v_add_f32 v26, v26, v30
v_fmac_f32 v27, v30, v30
v_mfma_f32_16x16x32_bf16 v[72:75], v[136:139], v[116:119], v[72:75]
ds_read_b64_tr_b16 v[182:183], v24 offset:16640
v_add_f32 v26, v26, v31
v_mfma_f32_16x16x32_bf16 v[236:239], v[240:243], v[124:127], v[236:239]
ds_read_b128 v[156:159], v17 offset:22528
v_fmac_f32 v27, v31, v31
s_mov_b32 m0, s39
v_mfma_f32_16x16x32_bf16 v[76:79], v[140:143], v[116:119], v[76:79]
s_mov_b64 exec, s[46:47]
buffer_load_dwordx4 v15, s[40:43], s45 offen  lds
s_mov_b64 exec, -1
s_add_u32 s55, s55, 1
s_cmp_eq_u32 s55, 10
s_cselect_b32 s55, 2, s55
s_lshl_b32 s48, s55, 7
s_mul_i32 s49, s55, 245760
s_mul_i32 s45, s55, s44
v_lshlrev_b32 v32, 16, v131
v_mfma_f32_16x16x32_bf16 v[84:87], v[132:135], v[120:123], v[84:87]
ds_read_b128 v[160:163], v17 offset:24576
v_and_b32 v33, s87, v131
v_mfma_f32_16x16x32_bf16 v[88:91], v[136:139], v[120:123], v[88:91]
ds_read_b128 v[164:167], v19 offset:18432
v_add_f32 v26, v26, v32
v_mfma_f32_16x16x32_bf16 v[92:95], v[140:143], v[120:123], v[92:95]
ds_read_b128 v[168:171], v21 offset:18432
v_fmac_f32 v27, v32, v32
v_mfma_f32_16x16x32_bf16 v[100:103], v[132:135], v[124:127], v[100:103]
v_add_f32 v26, v26, v33
v_mfma_f32_16x16x32_bf16 v[104:107], v[136:139], v[124:127], v[104:107]
v_fmac_f32 v27, v33, v33
s_waitcnt vmcnt(6)
s_barrier
s_add_u32 m0, s34, 18432
s_waitcnt lgkmcnt(9)
v_mfma_f32_16x16x32_bf16 v[36:39], v[172:175], v[148:151], v[36:39]
ds_read_b64_tr_b16 v[132:133], v22 offset:20480
buffer_load_dwordx4 v10, s[20:23], s48 offen  lds
s_waitcnt lgkmcnt(8)
v_mfma_f32_16x16x32_bf16 v[40:43], v[176:179], v[148:151], v[40:43]
ds_read_b64_tr_b16 v[134:135], v22 offset:21760
s_waitcnt lgkmcnt(2)
v_lshlrev_b32 v30, 16, v168
v_and_b32 v31, s87, v168
v_mfma_f32_16x16x32_bf16 v[44:47], v[180:183], v[148:151], v[44:47]
ds_read_b128 v[108:111], v16 offset:36864
v_add_f32 v26, v26, v30
v_fmac_f32 v27, v30, v30
v_mfma_f32_16x16x32_bf16 v[52:55], v[172:175], v[152:155], v[52:55]
ds_read_b64_tr_b16 v[136:137], v23 offset:20480
v_add_f32 v26, v26, v31
v_fmac_f32 v27, v31, v31
v_mfma_f32_16x16x32_bf16 v[232:235], v[164:167], v[164:167], v[232:235]
ds_read_b64_tr_b16 v[138:139], v23 offset:21760
v_lshlrev_b32 v32, 16, v169
v_and_b32 v33, s87, v169
s_add_u32 m0, s35, 18432
v_mfma_f32_16x16x32_bf16 v[56:59], v[176:179], v[152:155], v[56:59]
buffer_load_dwordx4 v11, s[20:23], s48 offen  lds
v_add_f32 v26, v26, v32
v_fmac_f32 v27, v32, v32
v_mfma_f32_16x16x32_bf16 v[60:63], v[180:183], v[152:155], v[60:63]
ds_read_b128 v[112:115], v16 offset:38912
v_add_f32 v26, v26, v33
v_fmac_f32 v27, v33, v33
v_mfma_f32_16x16x32_bf16 v[68:71], v[172:175], v[156:159], v[68:71]
ds_read_b64_tr_b16 v[140:141], v24 offset:20480
v_lshlrev_b32 v30, 16, v170
v_and_b32 v31, s87, v170
v_mfma_f32_16x16x32_bf16 v[72:75], v[176:179], v[156:159], v[72:75]
ds_read_b64_tr_b16 v[142:143], v24 offset:21760
v_add_f32 v26, v26, v30
v_fmac_f32 v27, v30, v30
v_mfma_f32_16x16x32_bf16 v[236:239], v[240:243], v[164:167], v[236:239]
ds_read_b128 v[116:119], v16 offset:40960
v_add_f32 v26, v26, v31
v_fmac_f32 v27, v31, v31
s_add_u32 m0, s36, 10240
v_mfma_f32_16x16x32_bf16 v[76:79], v[180:183], v[156:159], v[76:79]
buffer_load_dwordx4 v12, s[24:27], s49 offen  lds
v_lshlrev_b32 v32, 16, v171
v_mfma_f32_16x16x32_bf16 v[84:87], v[172:175], v[160:163], v[84:87]
ds_read_b128 v[120:123], v16 offset:43008
v_and_b32 v33, s87, v171
v_mfma_f32_16x16x32_bf16 v[88:91], v[176:179], v[160:163], v[88:91]
ds_read_b128 v[124:127], v18 offset:36864
v_add_f32 v26, v26, v32
v_mfma_f32_16x16x32_bf16 v[92:95], v[180:183], v[160:163], v[92:95]
ds_read_b128 v[128:131], v20 offset:36864
v_fmac_f32 v27, v32, v32
v_mfma_f32_16x16x32_bf16 v[100:103], v[172:175], v[164:167], v[100:103]
v_add_f32 v26, v26, v33
v_mfma_f32_16x16x32_bf16 v[104:107], v[176:179], v[164:167], v[104:107]
v_fmac_f32 v27, v33, v33
ds_read_b64_tr_b16 v[172:173], v22 offset:25600
s_waitcnt lgkmcnt(10)
v_mfma_f32_16x16x32_bf16 v[36:39], v[132:135], v[108:111], v[36:39]
ds_read_b64_tr_b16 v[174:175], v22 offset:26880
s_waitcnt lgkmcnt(2)
v_lshlrev_b32 v30, 16, v128
v_and_b32 v31, s87, v128
s_add_u32 m0, s37, 10240
v_mfma_f32_16x16x32_bf16 v[40:43], v[136:139], v[108:111], v[40:43]
buffer_load_dwordx4 v13, s[24:27], s49 offen  lds
v_add_f32 v26, v26, v30
v_fmac_f32 v27, v30, v30
v_mfma_f32_16x16x32_bf16 v[44:47], v[140:143], v[108:111], v[44:47]
ds_read_b128 v[148:151], v17 offset:36864
v_add_f32 v26, v26, v31
v_fmac_f32 v27, v31, v31
v_mfma_f32_16x16x32_bf16 v[52:55], v[132:135], v[112:115], v[52:55]
ds_read_b64_tr_b16 v[176:177], v23 offset:25600
v_lshlrev_b32 v32, 16, v129
v_and_b32 v33, s87, v129
v_mfma_f32_16x16x32_bf16 v[232:235], v[124:127], v[124:127], v[232:235]
ds_read_b64_tr_b16 v[178:179], v23 offset:26880
v_add_f32 v26, v26, v32
v_fmac_f32 v27, v32, v32
s_add_u32 m0, s38, 10240
v_mfma_f32_16x16x32_bf16 v[56:59], v[136:139], v[112:115], v[56:59]
buffer_load_dwordx4 v14, s[24:27], s49 offen  lds
v_add_f32 v26, v26, v33
v_fmac_f32 v27, v33, v33
v_mfma_f32_16x16x32_bf16 v[60:63], v[140:143], v[112:115], v[60:63]
ds_read_b128 v[152:155], v17 offset:38912
v_lshlrev_b32 v30, 16, v130
v_and_b32 v31, s87, v130
v_mfma_f32_16x16x32_bf16 v[68:71], v[132:135], v[116:119], v[68:71]
ds_read_b64_tr_b16 v[180:181], v24 offset:25600
v_add_f32 v26, v26, v30
v_fmac_f32 v27, v30, v30
v_mfma_f32_16x16x32_bf16 v[72:75], v[136:139], v[116:119], v[72:75]
ds_read_b64_tr_b16 v[182:183], v24 offset:26880
v_add_f32 v26, v26, v31
v_mfma_f32_16x16x32_bf16 v[236:239], v[240:243], v[124:127], v[236:239]
ds_read_b128 v[156:159], v17 offset:40960
v_fmac_f32 v27, v31, v31
s_mov_b32 m0, s52
v_mfma_f32_16x16x32_bf16 v[76:79], v[140:143], v[116:119], v[76:79]
s_mov_b64 exec, s[46:47]
buffer_load_dwordx4 v15, s[40:43], s45 offen  lds
s_mov_b64 exec, -1
s_add_u32 s55, s55, 1
s_cmp_eq_u32 s55, 10
s_cselect_b32 s55, 2, s55
s_lshl_b32 s48, s55, 7
s_mul_i32 s49, s55, 245760
s_mul_i32 s45, s55, s44
v_lshlrev_b32 v32, 16, v131
v_mfma_f32_16x16x32_bf16 v[84:87], v[132:135], v[120:123], v[84:87]
ds_read_b128 v[160:163], v17 offset:43008
v_and_b32 v33, s87, v131
v_mfma_f32_16x16x32_bf16 v[88:91], v[136:139], v[120:123], v[88:91]
ds_read_b128 v[164:167], v19 offset:36864
v_add_f32 v26, v26, v32
v_mfma_f32_16x16x32_bf16 v[92:95], v[140:143], v[120:123], v[92:95]
ds_read_b128 v[168:171], v21 offset:36864
v_fmac_f32 v27, v32, v32
v_mfma_f32_16x16x32_bf16 v[100:103], v[132:135], v[124:127], v[100:103]
v_add_f32 v26, v26, v33
v_mfma_f32_16x16x32_bf16 v[104:107], v[136:139], v[124:127], v[104:107]
v_fmac_f32 v27, v33, v33
s_waitcnt vmcnt(6)
s_barrier
s_add_u32 m0, s34, 36864
s_waitcnt lgkmcnt(9)
v_mfma_f32_16x16x32_bf16 v[36:39], v[172:175], v[148:151], v[36:39]
ds_read_b64_tr_b16 v[132:133], v22 offset:0
buffer_load_dwordx4 v10, s[20:23], s48 offen  lds
s_waitcnt lgkmcnt(8)
v_mfma_f32_16x16x32_bf16 v[40:43], v[176:179], v[148:151], v[40:43]
ds_read_b64_tr_b16 v[134:135], v22 offset:1280
s_waitcnt lgkmcnt(2)
v_lshlrev_b32 v30, 16, v168
v_and_b32 v31, s87, v168
v_mfma_f32_16x16x32_bf16 v[44:47], v[180:183], v[148:151], v[44:47]
ds_read_b128 v[108:111], v16 offset:0
v_add_f32 v26, v26, v30
v_fmac_f32 v27, v30, v30
v_mfma_f32_16x16x32_bf16 v[52:55], v[172:175], v[152:155], v[52:55]
ds_read_b64_tr_b16 v[136:137], v23 offset:0
v_add_f32 v26, v26, v31
v_fmac_f32 v27, v31, v31
v_mfma_f32_16x16x32_bf16 v[232:235], v[164:167], v[164:167], v[232:235]
ds_read_b64_tr_b16 v[138:139], v23 offset:1280
v_lshlrev_b32 v32, 16, v169
v_and_b32 v33, s87, v169
s_add_u32 m0, s35, 36864
v_mfma_f32_16x16x32_bf16 v[56:59], v[176:179], v[152:155], v[56:59]
buffer_load_dwordx4 v11, s[20:23], s48 offen  lds
v_add_f32 v26, v26, v32
v_fmac_f32 v27, v32, v32
v_mfma_f32_16x16x32_bf16 v[60:63], v[180:183], v[152:155], v[60:63]
ds_read_b128 v[112:115], v16 offset:2048
v_add_f32 v26, v26, v33
v_fmac_f32 v27, v33, v33
v_mfma_f32_16x16x32_bf16 v[68:71], v[172:175], v[156:159], v[68:71]
ds_read_b64_tr_b16 v[140:141], v24 offset:0
v_lshlrev_b32 v30, 16, v170
v_and_b32 v31, s87, v170
v_mfma_f32_16x16x32_bf16 v[72:75], v[176:179], v[156:159], v[72:75]
ds_read_b64_tr_b16 v[142:143], v24 offset:1280
v_add_f32 v26, v26, v30
v_fmac_f32 v27, v30, v30
v_mfma_f32_16x16x32_bf16 v[236:239], v[240:243], v[164:167], v[236:239]
ds_read_b128 v[116:119], v16 offset:4096
v_add_f32 v26, v26, v31
v_fmac_f32 v27, v31, v31
s_add_u32 m0, s36, 20480
v_mfma_f32_16x16x32_bf16 v[76:79], v[180:183], v[156:159], v[76:79]
buffer_load_dwordx4 v12, s[24:27], s49 offen  lds
v_lshlrev_b32 v32, 16, v171
v_mfma_f32_16x16x32_bf16 v[84:87], v[172:175], v[160:163], v[84:87]
ds_read_b128 v[120:123], v16 offset:6144
v_and_b32 v33, s87, v171
v_mfma_f32_16x16x32_bf16 v[88:91], v[176:179], v[160:163], v[88:91]
ds_read_b128 v[124:127], v18 offset:0
v_add_f32 v26, v26, v32
v_mfma_f32_16x16x32_bf16 v[92:95], v[180:183], v[160:163], v[92:95]
ds_read_b128 v[128:131], v20 offset:0
v_fmac_f32 v27, v32, v32
v_mfma_f32_16x16x32_bf16 v[100:103], v[172:175], v[164:167], v[100:103]
v_add_f32 v26, v26, v33
v_mfma_f32_16x16x32_bf16 v[104:107], v[176:179], v[164:167], v[104:107]
v_fmac_f32 v27, v33, v33
ds_read_b64_tr_b16 v[172:173], v22 offset:5120
s_waitcnt lgkmcnt(10)
v_mfma_f32_16x16x32_bf16 v[36:39], v[132:135], v[108:111], v[36:39]
ds_read_b64_tr_b16 v[174:175], v22 offset:6400
s_waitcnt lgkmcnt(2)
v_lshlrev_b32 v30, 16, v128
v_and_b32 v31, s87, v128
s_add_u32 m0, s37, 20480
v_mfma_f32_16x16x32_bf16 v[40:43], v[136:139], v[108:111], v[40:43]
buffer_load_dwordx4 v13, s[24:27], s49 offen  lds
v_add_f32 v26, v26, v30
v_fmac_f32 v27, v30, v30
v_mfma_f32_16x16x32_bf16 v[44:47], v[140:143], v[108:111], v[44:47]
ds_read_b128 v[148:151], v17 offset:0
v_add_f32 v26, v26, v31
v_fmac_f32 v27, v31, v31
v_mfma_f32_16x16x32_bf16 v[52:55], v[132:135], v[112:115], v[52:55]
ds_read_b64_tr_b16 v[176:177], v23 offset:5120
v_lshlrev_b32 v32, 16, v129
v_and_b32 v33, s87, v129
v_mfma_f32_16x16x32_bf16 v[232:235], v[124:127], v[124:127], v[232:235]
ds_read_b64_tr_b16 v[178:179], v23 offset:6400
v_add_f32 v26, v26, v32
v_fmac_f32 v27, v32, v32
s_add_u32 m0, s38, 20480
v_mfma_f32_16x16x32_bf16 v[56:59], v[136:139], v[112:115], v[56:59]
buffer_load_dwordx4 v14, s[24:27], s49 offen  lds
v_add_f32 v26, v26, v33
v_fmac_f32 v27, v33, v33
v_mfma_f32_16x16x32_bf16 v[60:63], v[140:143], v[112:115], v[60:63]
ds_read_b128 v[152:155], v17 offset:2048
v_lshlrev_b32 v30, 16, v130
v_and_b32 v31, s87, v130
v_mfma_f32_16x16x32_bf16 v[68:71], v[132:135], v[116:119], v[68:71]
ds_read_b64_tr_b16 v[180:181], v24 offset:5120
v_add_f32 v26, v26, v30
v_fmac_f32 v27, v30, v30
v_mfma_f32_16x16x32_bf16 v[72:75], v[136:139], v[116:119], v[72:75]
ds_read_b64_tr_b16 v[182:183], v24 offset:6400
v_add_f32 v26, v26, v31
v_mfma_f32_16x16x32_bf16 v[236:239], v[240:243], v[124:127], v[236:239]
ds_read_b128 v[156:159], v17 offset:4096
v_fmac_f32 v27, v31, v31
s_mov_b32 m0, s53
v_mfma_f32_16x16x32_bf16 v[76:79], v[140:143], v[116:119], v[76:79]
s_mov_b64 exec, s[46:47]
buffer_load_dwordx4 v15, s[40:43], s45 offen  lds
s_mov_b64 exec, -1
s_add_u32 s55, s55, 1
s_cmp_eq_u32 s55, 10
s_cselect_b32 s55, 2, s55
s_lshl_b32 s48, s55, 7
s_mul_i32 s49, s55, 245760
s_mul_i32 s45, s55, s44
v_lshlrev_b32 v32, 16, v131
v_mfma_f32_16x16x32_bf16 v[84:87], v[132:135], v[120:123], v[84:87]
ds_read_b128 v[160:163], v17 offset:6144
v_and_b32 v33, s87, v131
v_mfma_f32_16x16x32_bf16 v[88:91], v[136:139], v[120:123], v[88:91]
ds_read_b128 v[164:167], v19 offset:0
v_add_f32 v26, v26, v32
v_mfma_f32_16x16x32_bf16 v[92:95], v[140:143], v[120:123], v[92:95]
ds_read_b128 v[168:171], v21 offset:0
v_fmac_f32 v27, v32, v32
v_mfma_f32_16x16x32_bf16 v[100:103], v[132:135], v[124:127], v[100:103]
v_add_f32 v26, v26, v33
v_mfma_f32_16x16x32_bf16 v[104:107], v[136:139], v[124:127], v[104:107]
v_fmac_f32 v27, v33, v33
s_waitcnt vmcnt(6)
s_barrier
s_add_u32 m0, s34, 0
s_waitcnt lgkmcnt(9)
v_mfma_f32_16x16x32_bf16 v[36:39], v[172:175], v[148:151], v[36:39]
ds_read_b64_tr_b16 v[132:133], v22 offset:10240
buffer_load_dwordx4 v10, s[20:23], s48 offen  lds
s_waitcnt lgkmcnt(8)
v_mfma_f32_16x16x32_bf16 v[40:43], v[176:179], v[148:151], v[40:43]
ds_read_b64_tr_b16 v[134:135], v22 offset:11520
s_waitcnt lgkmcnt(2)
v_lshlrev_b32 v30, 16, v168
v_and_b32 v31, s87, v168
v_mfma_f32_16x16x32_bf16 v[44:47], v[180:183], v[148:151], v[44:47]
ds_read_b128 v[108:111], v16 offset:18432
v_add_f32 v26, v26, v30
v_fmac_f32 v27, v30, v30
v_mfma_f32_16x16x32_bf16 v[52:55], v[172:175], v[152:155], v[52:55]
ds_read_b64_tr_b16 v[136:137], v23 offset:10240
v_add_f32 v26, v26, v31
v_fmac_f32 v27, v31, v31
v_mfma_f32_16x16x32_bf16 v[232:235], v[164:167], v[164:167], v[232:235]
ds_read_b64_tr_b16 v[138:139], v23 offset:11520
v_lshlrev_b32 v32, 16, v169
v_and_b32 v33, s87, v169
s_add_u32 m0, s35, 0
v_mfma_f32_16x16x32_bf16 v[56:59], v[176:179], v[152:155], v[56:59]
buffer_load_dwordx4 v11, s[20:23], s48 offen  lds
v_add_f32 v26, v26, v32
v_fmac_f32 v27, v32, v32
v_mfma_f32_16x16x32_bf16 v[60:63], v[180:183], v[152:155], v[60:63]
ds_read_b128 v[112:115], v16 offset:20480
v_add_f32 v26, v26, v33
v_fmac_f32 v27, v33, v33
v_mfma_f32_16x16x32_bf16 v[68:71], v[172:175], v[156:159], v[68:71]
ds_read_b64_tr_b16 v[140:141], v24 offset:10240
v_lshlrev_b32 v30, 16, v170
v_and_b32 v31, s87, v170
v_mfma_f32_16x16x32_bf16 v[72:75], v[176:179], v[156:159], v[72:75]
ds_read_b64_tr_b16 v[142:143], v24 offset:11520
v_add_f32 v26, v26, v30
v_fmac_f32 v27, v30, v30
v_mfma_f32_16x16x32_bf16 v[236:239], v[240:243], v[164:167], v[236:239]
ds_read_b128 v[116:119], v16 offset:22528
v_add_f32 v26, v26, v31
v_fmac_f32 v27, v31, v31
s_add_u32 m0, s36, 0
v_mfma_f32_16x16x32_bf16 v[76:79], v[180:183], v[156:159], v[76:79]
buffer_load_dwordx4 v12, s[24:27], s49 offen  lds
v_lshlrev_b32 v32, 16, v171
v_mfma_f32_16x16x32_bf16 v[84:87], v[172:175], v[160:163], v[84:87]
ds_read_b128 v[120:123], v16 offset:24576
v_and_b32 v33, s87, v171
v_mfma_f32_16x16x32_bf16 v[88:91], v[176:179], v[160:163], v[88:91]
ds_read_b128 v[124:127], v18 offset:18432
v_add_f32 v26, v26, v32
v_mfma_f32_16x16x32_bf16 v[92:95], v[180:183], v[160:163], v[92:95]
ds_read_b128 v[128:131], v20 offset:18432
v_fmac_f32 v27, v32, v32
v_mfma_f32_16x16x32_bf16 v[100:103], v[172:175], v[164:167], v[100:103]
v_add_f32 v26, v26, v33
v_mfma_f32_16x16x32_bf16 v[104:107], v[176:179], v[164:167], v[104:107]
v_fmac_f32 v27, v33, v33
ds_read_b64_tr_b16 v[172:173], v22 offset:15360
s_waitcnt lgkmcnt(10)
v_mfma_f32_16x16x32_bf16 v[36:39], v[132:135], v[108:111], v[36:39]
ds_read_b64_tr_b16 v[174:175], v22 offset:16640
s_waitcnt lgkmcnt(2)
v_lshlrev_b32 v30, 16, v128
v_and_b32 v31, s87, v128
s_add_u32 m0, s37, 0
v_mfma_f32_16x16x32_bf16 v[40:43], v[136:139], v[108:111], v[40:43]
buffer_load_dwordx4 v13, s[24:27], s49 offen  lds
v_add_f32 v26, v26, v30
v_fmac_f32 v27, v30, v30
v_mfma_f32_16x16x32_bf16 v[44:47], v[140:143], v[108:111], v[44:47]
ds_read_b128 v[148:151], v17 offset:18432
v_add_f32 v26, v26, v31
v_fmac_f32 v27, v31, v31
v_mfma_f32_16x16x32_bf16 v[52:55], v[132:135], v[112:115], v[52:55]
ds_read_b64_tr_b16 v[176:177], v23 offset:15360
v_lshlrev_b32 v32, 16, v129
v_and_b32 v33, s87, v129
v_mfma_f32_16x16x32_bf16 v[232:235], v[124:127], v[124:127], v[232:235]
ds_read_b64_tr_b16 v[178:179], v23 offset:16640
v_add_f32 v26, v26, v32
v_fmac_f32 v27, v32, v32
s_add_u32 m0, s38, 0
v_mfma_f32_16x16x32_bf16 v[56:59], v[136:139], v[112:115], v[56:59]
buffer_load_dwordx4 v14, s[24:27], s49 offen  lds
v_add_f32 v26, v26, v33
v_fmac_f32 v27, v33, v33
v_mfma_f32_16x16x32_bf16 v[60:63], v[140:143], v[112:115], v[60:63]
ds_read_b128 v[152:155], v17 offset:20480
v_lshlrev_b32 v30, 16, v130
v_and_b32 v31, s87, v130
v_mfma_f32_16x16x32_bf16 v[68:71], v[132:135], v[116:119], v[68:71]
ds_read_b64_tr_b16 v[180:181], v24 offset:15360
v_add_f32 v26, v26, v30
v_fmac_f32 v27, v30, v30
v_mfma_f32_16x16x32_bf16 v[72:75], v[136:139], v[116:119], v[72:75]
ds_read_b64_tr_b16 v[182:183], v24 offset:16640
v_add_f32 v26, v26, v31
v_mfma_f32_16x16x32_bf16 v[236:239], v[240:243], v[124:127], v[236:239]
ds_read_b128 v[156:159], v17 offset:22528
v_fmac_f32 v27, v31, v31
s_mov_b32 m0, s39
v_mfma_f32_16x16x32_bf16 v[76:79], v[140:143], v[116:119], v[76:79]
s_mov_b64 exec, s[46:47]
buffer_load_dwordx4 v15, s[40:43], s45 offen  lds
s_mov_b64 exec, -1
s_add_u32 s55, s55, 1
s_cmp_eq_u32 s55, 10
s_cselect_b32 s55, 2, s55
s_lshl_b32 s48, s55, 7
s_mul_i32 s49, s55, 245760
s_mul_i32 s45, s55, s44
v_lshlrev_b32 v32, 16, v131
v_mfma_f32_16x16x32_bf16 v[84:87], v[132:135], v[120:123], v[84:87]
ds_read_b128 v[160:163], v17 offset:24576
v_and_b32 v33, s87, v131
v_mfma_f32_16x16x32_bf16 v[88:91], v[136:139], v[120:123], v[88:91]
ds_read_b128 v[164:167], v19 offset:18432
v_add_f32 v26, v26, v32
v_mfma_f32_16x16x32_bf16 v[92:95], v[140:143], v[120:123], v[92:95]
ds_read_b128 v[168:171], v21 offset:18432
v_fmac_f32 v27, v32, v32
v_mfma_f32_16x16x32_bf16 v[100:103], v[132:135], v[124:127], v[100:103]
v_add_f32 v26, v26, v33
v_mfma_f32_16x16x32_bf16 v[104:107], v[136:139], v[124:127], v[104:107]
v_fmac_f32 v27, v33, v33
s_waitcnt vmcnt(6)
s_barrier
s_add_u32 m0, s34, 18432
s_waitcnt lgkmcnt(9)
v_mfma_f32_16x16x32_bf16 v[36:39], v[172:175], v[148:151], v[36:39]
ds_read_b64_tr_b16 v[132:133], v22 offset:20480
buffer_load_dwordx4 v10, s[20:23], s48 offen  lds
s_waitcnt lgkmcnt(8)
v_mfma_f32_16x16x32_bf16 v[40:43], v[176:179], v[148:151], v[40:43]
ds_read_b64_tr_b16 v[134:135], v22 offset:21760
s_waitcnt lgkmcnt(2)
v_lshlrev_b32 v30, 16, v168
v_and_b32 v31, s87, v168
v_mfma_f32_16x16x32_bf16 v[44:47], v[180:183], v[148:151], v[44:47]
ds_read_b128 v[108:111], v16 offset:36864
v_add_f32 v26, v26, v30
v_fmac_f32 v27, v30, v30
v_mfma_f32_16x16x32_bf16 v[52:55], v[172:175], v[152:155], v[52:55]
ds_read_b64_tr_b16 v[136:137], v23 offset:20480
v_add_f32 v26, v26, v31
v_fmac_f32 v27, v31, v31
v_mfma_f32_16x16x32_bf16 v[232:235], v[164:167], v[164:167], v[232:235]
ds_read_b64_tr_b16 v[138:139], v23 offset:21760
v_lshlrev_b32 v32, 16, v169
v_and_b32 v33, s87, v169
s_add_u32 m0, s35, 18432
v_mfma_f32_16x16x32_bf16 v[56:59], v[176:179], v[152:155], v[56:59]
buffer_load_dwordx4 v11, s[20:23], s48 offen  lds
v_add_f32 v26, v26, v32
v_fmac_f32 v27, v32, v32
v_mfma_f32_16x16x32_bf16 v[60:63], v[180:183], v[152:155], v[60:63]
ds_read_b128 v[112:115], v16 offset:38912
v_add_f32 v26, v26, v33
v_fmac_f32 v27, v33, v33
v_mfma_f32_16x16x32_bf16 v[68:71], v[172:175], v[156:159], v[68:71]
ds_read_b64_tr_b16 v[140:141], v24 offset:20480
v_lshlrev_b32 v30, 16, v170
v_and_b32 v31, s87, v170
v_mfma_f32_16x16x32_bf16 v[72:75], v[176:179], v[156:159], v[72:75]
ds_read_b64_tr_b16 v[142:143], v24 offset:21760
v_add_f32 v26, v26, v30
v_fmac_f32 v27, v30, v30
v_mfma_f32_16x16x32_bf16 v[236:239], v[240:243], v[164:167], v[236:239]
ds_read_b128 v[116:119], v16 offset:40960
v_add_f32 v26, v26, v31
v_fmac_f32 v27, v31, v31
s_add_u32 m0, s36, 10240
v_mfma_f32_16x16x32_bf16 v[76:79], v[180:183], v[156:159], v[76:79]
buffer_load_dwordx4 v12, s[24:27], s49 offen  lds
v_lshlrev_b32 v32, 16, v171
v_mfma_f32_16x16x32_bf16 v[84:87], v[172:175], v[160:163], v[84:87]
ds_read_b128 v[120:123], v16 offset:43008
v_and_b32 v33, s87, v171
v_mfma_f32_16x16x32_bf16 v[88:91], v[176:179], v[160:163], v[88:91]
ds_read_b128 v[124:127], v18 offset:36864
v_add_f32 v26, v26, v32
v_mfma_f32_16x16x32_bf16 v[92:95], v[180:183], v[160:163], v[92:95]
ds_read_b128 v[128:131], v20 offset:36864
v_fmac_f32 v27, v32, v32
v_mfma_f32_16x16x32_bf16 v[100:103], v[172:175], v[164:167], v[100:103]
v_add_f32 v26, v26, v33
v_mfma_f32_16x16x32_bf16 v[104:107], v[176:179], v[164:167], v[104:107]
v_fmac_f32 v27, v33, v33
ds_read_b64_tr_b16 v[172:173], v22 offset:25600
s_waitcnt lgkmcnt(10)
v_mfma_f32_16x16x32_bf16 v[36:39], v[132:135], v[108:111], v[36:39]
ds_read_b64_tr_b16 v[174:175], v22 offset:26880
s_waitcnt lgkmcnt(2)
v_lshlrev_b32 v30, 16, v128
v_and_b32 v31, s87, v128
s_add_u32 m0, s37, 10240
v_mfma_f32_16x16x32_bf16 v[40:43], v[136:139], v[108:111], v[40:43]
buffer_load_dwordx4 v13, s[24:27], s49 offen  lds
v_add_f32 v26, v26, v30
v_fmac_f32 v27, v30, v30
v_mfma_f32_16x16x32_bf16 v[44:47], v[140:143], v[108:111], v[44:47]
ds_read_b128 v[148:151], v17 offset:36864
v_add_f32 v26, v26, v31
v_fmac_f32 v27, v31, v31
v_mfma_f32_16x16x32_bf16 v[52:55], v[132:135], v[112:115], v[52:55]
ds_read_b64_tr_b16 v[176:177], v23 offset:25600
v_lshlrev_b32 v32, 16, v129
v_and_b32 v33, s87, v129
v_mfma_f32_16x16x32_bf16 v[232:235], v[124:127], v[124:127], v[232:235]
ds_read_b64_tr_b16 v[178:179], v23 offset:26880
v_add_f32 v26, v26, v32
v_fmac_f32 v27, v32, v32
s_add_u32 m0, s38, 10240
v_mfma_f32_16x16x32_bf16 v[56:59], v[136:139], v[112:115], v[56:59]
buffer_load_dwordx4 v14, s[24:27], s49 offen  lds
v_add_f32 v26, v26, v33
v_fmac_f32 v27, v33, v33
v_mfma_f32_16x16x32_bf16 v[60:63], v[140:143], v[112:115], v[60:63]
ds_read_b128 v[152:155], v17 offset:38912
v_lshlrev_b32 v30, 16, v130
v_and_b32 v31, s87, v130
v_mfma_f32_16x16x32_bf16 v[68:71], v[132:135], v[116:119], v[68:71]
ds_read_b64_tr_b16 v[180:181], v24 offset:25600
v_add_f32 v26, v26, v30
v_fmac_f32 v27, v30, v30
v_mfma_f32_16x16x32_bf16 v[72:75], v[136:139], v[116:119], v[72:75]
ds_read_b64_tr_b16 v[182:183], v24 offset:26880
v_add_f32 v26, v26, v31
v_mfma_f32_16x16x32_bf16 v[236:239], v[240:243], v[124:127], v[236:239]
ds_read_b128 v[156:159], v17 offset:40960
v_fmac_f32 v27, v31, v31
s_mov_b32 m0, s52
v_mfma_f32_16x16x32_bf16 v[76:79], v[140:143], v[116:119], v[76:79]
s_mov_b64 exec, s[46:47]
buffer_load_dwordx4 v15, s[40:43], s45 offen  lds
s_mov_b64 exec, -1
s_add_u32 s55, s55, 1
s_cmp_eq_u32 s55, 10
s_cselect_b32 s55, 2, s55
s_lshl_b32 s48, s55, 7
s_mul_i32 s49, s55, 245760
s_mul_i32 s45, s55, s44
v_lshlrev_b32 v32, 16, v131
v_mfma_f32_16x16x32_bf16 v[84:87], v[132:135], v[120:123], v[84:87]
ds_read_b128 v[160:163], v17 offset:43008
v_and_b32 v33, s87, v131
v_mfma_f32_16x16x32_bf16 v[88:91], v[136:139], v[120:123], v[88:91]
ds_read_b128 v[164:167], v19 offset:36864
v_add_f32 v26, v26, v32
v_mfma_f32_16x16x32_bf16 v[92:95], v[140:143], v[120:123], v[92:95]
ds_read_b128 v[168:171], v21 offset:36864
v_fmac_f32 v27, v32, v32
v_mfma_f32_16x16x32_bf16 v[100:103], v[132:135], v[124:127], v[100:103]
v_add_f32 v26, v26, v33
v_mfma_f32_16x16x32_bf16 v[104:107], v[136:139], v[124:127], v[104:107]
v_fmac_f32 v27, v33, v33
s_waitcnt vmcnt(6)
s_barrier
s_add_u32 m0, s34, 36864
s_waitcnt lgkmcnt(9)
v_mfma_f32_16x16x32_bf16 v[36:39], v[172:175], v[148:151], v[36:39]
ds_read_b64_tr_b16 v[132:133], v22 offset:0
buffer_load_dwordx4 v10, s[20:23], s48 offen  lds
s_waitcnt lgkmcnt(8)
v_mfma_f32_16x16x32_bf16 v[40:43], v[176:179], v[148:151], v[40:43]
ds_read_b64_tr_b16 v[134:135], v22 offset:1280
s_waitcnt lgkmcnt(2)
v_lshlrev_b32 v30, 16, v168
v_and_b32 v31, s87, v168
v_mfma_f32_16x16x32_bf16 v[44:47], v[180:183], v[148:151], v[44:47]
ds_read_b128 v[108:111], v16 offset:0
v_add_f32 v26, v26, v30
v_fmac_f32 v27, v30, v30
v_mfma_f32_16x16x32_bf16 v[52:55], v[172:175], v[152:155], v[52:55]
ds_read_b64_tr_b16 v[136:137], v23 offset:0
v_add_f32 v26, v26, v31
v_fmac_f32 v27, v31, v31
v_mfma_f32_16x16x32_bf16 v[232:235], v[164:167], v[164:167], v[232:235]
ds_read_b64_tr_b16 v[138:139], v23 offset:1280
v_lshlrev_b32 v32, 16, v169
v_and_b32 v33, s87, v169
s_add_u32 m0, s35, 36864
v_mfma_f32_16x16x32_bf16 v[56:59], v[176:179], v[152:155], v[56:59]
buffer_load_dwordx4 v11, s[20:23], s48 offen  lds
v_add_f32 v26, v26, v32
v_fmac_f32 v27, v32, v32
v_mfma_f32_16x16x32_bf16 v[60:63], v[180:183], v[152:155], v[60:63]
ds_read_b128 v[112:115], v16 offset:2048
v_add_f32 v26, v26, v33
v_fmac_f32 v27, v33, v33
v_mfma_f32_16x16x32_bf16 v[68:71], v[172:175], v[156:159], v[68:71]
ds_read_b64_tr_b16 v[140:141], v24 offset:0
v_lshlrev_b32 v30, 16, v170
v_and_b32 v31, s87, v170
v_mfma_f32_16x16x32_bf16 v[72:75], v[176:179], v[156:159], v[72:75]
ds_read_b64_tr_b16 v[142:143], v24 offset:1280
v_add_f32 v26, v26, v30
v_fmac_f32 v27, v30, v30
v_mfma_f32_16x16x32_bf16 v[236:239], v[240:243], v[164:167], v[236:239]
ds_read_b128 v[116:119], v16 offset:4096
v_add_f32 v26, v26, v31
v_fmac_f32 v27, v31, v31
s_add_u32 m0, s36, 20480
v_mfma_f32_16x16x32_bf16 v[76:79], v[180:183], v[156:159], v[76:79]
buffer_load_dwordx4 v12, s[24:27], s49 offen  lds
v_lshlrev_b32 v32, 16, v171
v_mfma_f32_16x16x32_bf16 v[84:87], v[172:175], v[160:163], v[84:87]
ds_read_b128 v[120:123], v16 offset:6144
v_and_b32 v33, s87, v171
v_mfma_f32_16x16x32_bf16 v[88:91], v[176:179], v[160:163], v[88:91]
ds_read_b128 v[124:127], v18 offset:0
v_add_f32 v26, v26, v32
v_mfma_f32_16x16x32_bf16 v[92:95], v[180:183], v[160:163], v[92:95]
ds_read_b128 v[128:131], v20 offset:0
v_fmac_f32 v27, v32, v32
v_mfma_f32_16x16x32_bf16 v[100:103], v[172:175], v[164:167], v[100:103]
v_add_f32 v26, v26, v33
v_mfma_f32_16x16x32_bf16 v[104:107], v[176:179], v[164:167], v[104:107]
v_fmac_f32 v27, v33, v33
ds_read_b64_tr_b16 v[172:173], v22 offset:5120
s_waitcnt lgkmcnt(10)
v_mfma_f32_16x16x32_bf16 v[36:39], v[132:135], v[108:111], v[36:39]
ds_read_b64_tr_b16 v[174:175], v22 offset:6400
s_waitcnt lgkmcnt(2)
v_lshlrev_b32 v30, 16, v128
v_and_b32 v31, s87, v128
s_add_u32 m0, s37, 20480
v_mfma_f32_16x16x32_bf16 v[40:43], v[136:139], v[108:111], v[40:43]
buffer_load_dwordx4 v13, s[24:27], s49 offen  lds
v_add_f32 v26, v26, v30
v_fmac_f32 v27, v30, v30
v_mfma_f32_16x16x32_bf16 v[44:47], v[140:143], v[108:111], v[44:47]
ds_read_b128 v[148:151], v17 offset:0
v_add_f32 v26, v26, v31
v_fmac_f32 v27, v31, v31
v_mfma_f32_16x16x32_bf16 v[52:55], v[132:135], v[112:115], v[52:55]
ds_read_b64_tr_b16 v[176:177], v23 offset:5120
v_lshlrev_b32 v32, 16, v129
v_and_b32 v33, s87, v129
v_mfma_f32_16x16x32_bf16 v[232:235], v[124:127], v[124:127], v[232:235]
ds_read_b64_tr_b16 v[178:179], v23 offset:6400
v_add_f32 v26, v26, v32
v_fmac_f32 v27, v32, v32
s_add_u32 m0, s38, 20480
v_mfma_f32_16x16x32_bf16 v[56:59], v[136:139], v[112:115], v[56:59]
buffer_load_dwordx4 v14, s[24:27], s49 offen  lds
v_add_f32 v26, v26, v33
v_fmac_f32 v27, v33, v33
v_mfma_f32_16x16x32_bf16 v[60:63], v[140:143], v[112:115], v[60:63]
ds_read_b128 v[152:155], v17 offset:2048
v_lshlrev_b32 v30, 16, v130
v_and_b32 v31, s87, v130
v_mfma_f32_16x16x32_bf16 v[68:71], v[132:135], v[116:119], v[68:71]
ds_read_b64_tr_b16 v[180:181], v24 offset:5120
v_add_f32 v26, v26, v30
v_fmac_f32 v27, v30, v30
v_mfma_f32_16x16x32_bf16 v[72:75], v[136:139], v[116:119], v[72:75]
ds_read_b64_tr_b16 v[182:183], v24 offset:6400
v_add_f32 v26, v26, v31
v_mfma_f32_16x16x32_bf16 v[236:239], v[240:243], v[124:127], v[236:239]
ds_read_b128 v[156:159], v17 offset:4096
v_fmac_f32 v27, v31, v31
s_mov_b32 m0, s53
v_mfma_f32_16x16x32_bf16 v[76:79], v[140:143], v[116:119], v[76:79]
s_mov_b64 exec, s[46:47]
buffer_load_dwordx4 v15, s[40:43], s45 offen  lds
s_mov_b64 exec, -1
s_add_u32 s55, s55, 1
s_cmp_eq_u32 s55, 10
s_cselect_b32 s55, 2, s55
s_lshl_b32 s48, s55, 7
s_mul_i32 s49, s55, 245760
s_mul_i32 s45, s55, s44
v_lshlrev_b32 v32, 16, v131
v_mfma_f32_16x16x32_bf16 v[84:87], v[132:135], v[120:123], v[84:87]
ds_read_b128 v[160:163], v17 offset:6144
v_and_b32 v33, s87, v131
v_mfma_f32_16x16x32_bf16 v[88:91], v[136:139], v[120:123], v[88:91]
ds_read_b128 v[164:167], v19 offset:0
v_add_f32 v26, v26, v32
v_mfma_f32_16x16x32_bf16 v[92:95], v[140:143], v[120:123], v[92:95]
ds_read_b128 v[168:171], v21 offset:0
v_fmac_f32 v27, v32, v32
v_mfma_f32_16x16x32_bf16 v[100:103], v[132:135], v[124:127], v[100:103]
v_add_f32 v26, v26, v33
v_mfma_f32_16x16x32_bf16 v[104:107], v[136:139], v[124:127], v[104:107]
v_fmac_f32 v27, v33, v33
s_waitcnt vmcnt(6)
s_barrier
s_add_u32 m0, s34, 0
s_waitcnt lgkmcnt(9)
v_mfma_f32_16x16x32_bf16 v[36:39], v[172:175], v[148:151], v[36:39]
ds_read_b64_tr_b16 v[132:133], v22 offset:10240
buffer_load_dwordx4 v10, s[20:23], s48 offen  lds
s_waitcnt lgkmcnt(8)
v_mfma_f32_16x16x32_bf16 v[40:43], v[176:179], v[148:151], v[40:43]
ds_read_b64_tr_b16 v[134:135], v22 offset:11520
s_waitcnt lgkmcnt(2)
v_lshlrev_b32 v30, 16, v168
v_and_b32 v31, s87, v168
v_mfma_f32_16x16x32_bf16 v[44:47], v[180:183], v[148:151], v[44:47]
ds_read_b128 v[108:111], v16 offset:18432
v_add_f32 v26, v26, v30
v_fmac_f32 v27, v30, v30
v_mfma_f32_16x16x32_bf16 v[52:55], v[172:175], v[152:155], v[52:55]
ds_read_b64_tr_b16 v[136:137], v23 offset:10240
v_add_f32 v26, v26, v31
v_fmac_f32 v27, v31, v31
v_mfma_f32_16x16x32_bf16 v[232:235], v[164:167], v[164:167], v[232:235]
ds_read_b64_tr_b16 v[138:139], v23 offset:11520
v_lshlrev_b32 v32, 16, v169
v_and_b32 v33, s87, v169
s_add_u32 m0, s35, 0
v_mfma_f32_16x16x32_bf16 v[56:59], v[176:179], v[152:155], v[56:59]
buffer_load_dwordx4 v11, s[20:23], s48 offen  lds
v_add_f32 v26, v26, v32
v_fmac_f32 v27, v32, v32
v_mfma_f32_16x16x32_bf16 v[60:63], v[180:183], v[152:155], v[60:63]
ds_read_b128 v[112:115], v16 offset:20480
v_add_f32 v26, v26, v33
v_fmac_f32 v27, v33, v33
v_mfma_f32_16x16x32_bf16 v[68:71], v[172:175], v[156:159], v[68:71]
ds_read_b64_tr_b16 v[140:141], v24 offset:10240
v_lshlrev_b32 v30, 16, v170
v_and_b32 v31, s87, v170
v_mfma_f32_16x16x32_bf16 v[72:75], v[176:179], v[156:159], v[72:75]
ds_read_b64_tr_b16 v[142:143], v24 offset:11520
v_add_f32 v26, v26, v30
v_fmac_f32 v27, v30, v30
v_mfma_f32_16x16x32_bf16 v[236:239], v[240:243], v[164:167], v[236:239]
ds_read_b128 v[116:119], v16 offset:22528
v_add_f32 v26, v26, v31
v_fmac_f32 v27, v31, v31
s_add_u32 m0, s36, 0
v_mfma_f32_16x16x32_bf16 v[76:79], v[180:183], v[156:159], v[76:79]
buffer_load_dwordx4 v12, s[24:27], s49 offen  lds
v_lshlrev_b32 v32, 16, v171
v_mfma_f32_16x16x32_bf16 v[84:87], v[172:175], v[160:163], v[84:87]
ds_read_b128 v[120:123], v16 offset:24576
v_and_b32 v33, s87, v171
v_mfma_f32_16x16x32_bf16 v[88:91], v[176:179], v[160:163], v[88:91]
ds_read_b128 v[124:127], v18 offset:18432
v_add_f32 v26, v26, v32
v_mfma_f32_16x16x32_bf16 v[92:95], v[180:183], v[160:163], v[92:95]
ds_read_b128 v[128:131], v20 offset:18432
v_fmac_f32 v27, v32, v32
v_mfma_f32_16x16x32_bf16 v[100:103], v[172:175], v[164:167], v[100:103]
v_add_f32 v26, v26, v33
v_mfma_f32_16x16x32_bf16 v[104:107], v[176:179], v[164:167], v[104:107]
v_fmac_f32 v27, v33, v33
ds_read_b64_tr_b16 v[172:173], v22 offset:15360
s_waitcnt lgkmcnt(10)
v_mfma_f32_16x16x32_bf16 v[36:39], v[132:135], v[108:111], v[36:39]
ds_read_b64_tr_b16 v[174:175], v22 offset:16640
s_waitcnt lgkmcnt(2)
v_lshlrev_b32 v30, 16, v128
v_and_b32 v31, s87, v128
s_add_u32 m0, s37, 0
v_mfma_f32_16x16x32_bf16 v[40:43], v[136:139], v[108:111], v[40:43]
buffer_load_dwordx4 v13, s[24:27], s49 offen  lds
v_add_f32 v26, v26, v30
v_fmac_f32 v27, v30, v30
v_mfma_f32_16x16x32_bf16 v[44:47], v[140:143], v[108:111], v[44:47]
ds_read_b128 v[148:151], v17 offset:18432
v_add_f32 v26, v26, v31
v_fmac_f32 v27, v31, v31
v_mfma_f32_16x16x32_bf16 v[52:55], v[132:135], v[112:115], v[52:55]
ds_read_b64_tr_b16 v[176:177], v23 offset:15360
v_lshlrev_b32 v32, 16, v129
v_and_b32 v33, s87, v129
v_mfma_f32_16x16x32_bf16 v[232:235], v[124:127], v[124:127], v[232:235]
ds_read_b64_tr_b16 v[178:179], v23 offset:16640
v_add_f32 v26, v26, v32
v_fmac_f32 v27, v32, v32
s_add_u32 m0, s38, 0
v_mfma_f32_16x16x32_bf16 v[56:59], v[136:139], v[112:115], v[56:59]
buffer_load_dwordx4 v14, s[24:27], s49 offen  lds
v_add_f32 v26, v26, v33
v_fmac_f32 v27, v33, v33
v_mfma_f32_16x16x32_bf16 v[60:63], v[140:143], v[112:115], v[60:63]
ds_read_b128 v[152:155], v17 offset:20480
v_lshlrev_b32 v30, 16, v130
v_and_b32 v31, s87, v130
v_mfma_f32_16x16x32_bf16 v[68:71], v[132:135], v[116:119], v[68:71]
ds_read_b64_tr_b16 v[180:181], v24 offset:15360
v_add_f32 v26, v26, v30
v_fmac_f32 v27, v30, v30
v_mfma_f32_16x16x32_bf16 v[72:75], v[136:139], v[116:119], v[72:75]
ds_read_b64_tr_b16 v[182:183], v24 offset:16640
v_add_f32 v26, v26, v31
v_mfma_f32_16x16x32_bf16 v[236:239], v[240:243], v[124:127], v[236:239]
ds_read_b128 v[156:159], v17 offset:22528
v_fmac_f32 v27, v31, v31
s_mov_b32 m0, s39
v_mfma_f32_16x16x32_bf16 v[76:79], v[140:143], v[116:119], v[76:79]
s_mov_b64 exec, s[46:47]
buffer_load_dwordx4 v15, s[40:43], s45 offen  lds
s_mov_b64 exec, -1
s_add_u32 s55, s55, 1
s_cmp_eq_u32 s55, 10
s_cselect_b32 s55, 2, s55
s_lshl_b32 s48, s55, 7
s_mul_i32 s49, s55, 245760
s_mul_i32 s45, s55, s44
v_lshlrev_b32 v32, 16, v131
v_mfma_f32_16x16x32_bf16 v[84:87], v[132:135], v[120:123], v[84:87]
ds_read_b128 v[160:163], v17 offset:24576
v_and_b32 v33, s87, v131
v_mfma_f32_16x16x32_bf16 v[88:91], v[136:139], v[120:123], v[88:91]
ds_read_b128 v[164:167], v19 offset:18432
v_add_f32 v26, v26, v32
v_mfma_f32_16x16x32_bf16 v[92:95], v[140:143], v[120:123], v[92:95]
ds_read_b128 v[168:171], v21 offset:18432
v_fmac_f32 v27, v32, v32
v_mfma_f32_16x16x32_bf16 v[100:103], v[132:135], v[124:127], v[100:103]
v_add_f32 v26, v26, v33
v_mfma_f32_16x16x32_bf16 v[104:107], v[136:139], v[124:127], v[104:107]
v_fmac_f32 v27, v33, v33
s_waitcnt vmcnt(6)
s_barrier
s_waitcnt lgkmcnt(9)
v_mfma_f32_16x16x32_bf16 v[36:39], v[172:175], v[148:151], v[36:39]
ds_read_b64_tr_b16 v[132:133], v22 offset:20480
s_waitcnt lgkmcnt(1)
v_lshlrev_b32 v30, 16, v168
v_and_b32 v31, s87, v168
v_mfma_f32_16x16x32_bf16 v[40:43], v[176:179], v[148:151], v[40:43]
ds_read_b64_tr_b16 v[134:135], v22 offset:21760
v_add_f32 v26, v26, v30
v_fmac_f32 v27, v30, v30
v_mfma_f32_16x16x32_bf16 v[44:47], v[180:183], v[148:151], v[44:47]
ds_read_b128 v[108:111], v16 offset:36864
v_add_f32 v26, v26, v31
v_fmac_f32 v27, v31, v31
v_mfma_f32_16x16x32_bf16 v[52:55], v[172:175], v[152:155], v[52:55]
ds_read_b64_tr_b16 v[136:137], v23 offset:20480
v_lshlrev_b32 v32, 16, v169
v_and_b32 v33, s87, v169
v_mfma_f32_16x16x32_bf16 v[232:235], v[164:167], v[164:167], v[232:235]
ds_read_b64_tr_b16 v[138:139], v23 offset:21760
v_add_f32 v26, v26, v32
v_fmac_f32 v27, v32, v32
v_mfma_f32_16x16x32_bf16 v[56:59], v[176:179], v[152:155], v[56:59]
ds_read_b128 v[112:115], v16 offset:38912
v_add_f32 v26, v26, v33
v_fmac_f32 v27, v33, v33
v_mfma_f32_16x16x32_bf16 v[60:63], v[180:183], v[152:155], v[60:63]
ds_read_b64_tr_b16 v[140:141], v24 offset:20480
v_lshlrev_b32 v30, 16, v170
v_and_b32 v31, s87, v170
v_mfma_f32_16x16x32_bf16 v[68:71], v[172:175], v[156:159], v[68:71]
ds_read_b64_tr_b16 v[142:143], v24 offset:21760
v_add_f32 v26, v26, v30
v_fmac_f32 v27, v30, v30
v_mfma_f32_16x16x32_bf16 v[72:75], v[176:179], v[156:159], v[72:75]
ds_read_b128 v[116:119], v16 offset:40960
v_add_f32 v26, v26, v31
v_mfma_f32_16x16x32_bf16 v[236:239], v[240:243], v[164:167], v[236:239]
ds_read_b128 v[120:123], v16 offset:43008
v_fmac_f32 v27, v31, v31
v_mfma_f32_16x16x32_bf16 v[76:79], v[180:183], v[156:159], v[76:79]
ds_read_b128 v[124:127], v18 offset:36864
v_lshlrev_b32 v32, 16, v171
v_mfma_f32_16x16x32_bf16 v[84:87], v[172:175], v[160:163], v[84:87]
ds_read_b128 v[128:131], v20 offset:36864
v_and_b32 v33, s87, v171
v_mfma_f32_16x16x32_bf16 v[88:91], v[176:179], v[160:163], v[88:91]
v_add_f32 v26, v26, v32
v_mfma_f32_16x16x32_bf16 v[92:95], v[180:183], v[160:163], v[92:95]
v_fmac_f32 v27, v32, v32
v_mfma_f32_16x16x32_bf16 v[100:103], v[172:175], v[164:167], v[100:103]
v_add_f32 v26, v26, v33
v_mfma_f32_16x16x32_bf16 v[104:107], v[176:179], v[164:167], v[104:107]
v_fmac_f32 v27, v33, v33
ds_read_b64_tr_b16 v[172:173], v22 offset:25600
s_waitcnt lgkmcnt(10)
v_mfma_f32_16x16x32_bf16 v[36:39], v[132:135], v[108:111], v[36:39]
ds_read_b64_tr_b16 v[174:175], v22 offset:26880
s_waitcnt lgkmcnt(2)
v_lshlrev_b32 v30, 16, v128
v_and_b32 v31, s87, v128
v_mfma_f32_16x16x32_bf16 v[40:43], v[136:139], v[108:111], v[40:43]
ds_read_b128 v[148:151], v17 offset:36864
v_add_f32 v26, v26, v30
v_fmac_f32 v27, v30, v30
v_mfma_f32_16x16x32_bf16 v[44:47], v[140:143], v[108:111], v[44:47]
ds_read_b64_tr_b16 v[176:177], v23 offset:25600
v_add_f32 v26, v26, v31
v_fmac_f32 v27, v31, v31
v_mfma_f32_16x16x32_bf16 v[52:55], v[132:135], v[112:115], v[52:55]
ds_read_b64_tr_b16 v[178:179], v23 offset:26880
v_lshlrev_b32 v32, 16, v129
v_and_b32 v33, s87, v129
v_mfma_f32_16x16x32_bf16 v[232:235], v[124:127], v[124:127], v[232:235]
ds_read_b128 v[152:155], v17 offset:38912
v_add_f32 v26, v26, v32
v_fmac_f32 v27, v32, v32
v_mfma_f32_16x16x32_bf16 v[56:59], v[136:139], v[112:115], v[56:59]
ds_read_b64_tr_b16 v[180:181], v24 offset:25600
v_add_f32 v26, v26, v33
v_fmac_f32 v27, v33, v33
v_mfma_f32_16x16x32_bf16 v[60:63], v[140:143], v[112:115], v[60:63]
ds_read_b64_tr_b16 v[182:183], v24 offset:26880
v_lshlrev_b32 v30, 16, v130
v_and_b32 v31, s87, v130
v_mfma_f32_16x16x32_bf16 v[68:71], v[132:135], v[116:119], v[68:71]
ds_read_b128 v[156:159], v17 offset:40960
v_add_f32 v26, v26, v30
v_fmac_f32 v27, v30, v30
v_mfma_f32_16x16x32_bf16 v[72:75], v[136:139], v[116:119], v[72:75]
ds_read_b128 v[160:163], v17 offset:43008
v_add_f32 v26, v26, v31
v_mfma_f32_16x16x32_bf16 v[236:239], v[240:243], v[124:127], v[236:239]
ds_read_b128 v[164:167], v19 offset:36864
v_fmac_f32 v27, v31, v31
v_mfma_f32_16x16x32_bf16 v[76:79], v[140:143], v[116:119], v[76:79]
ds_read_b128 v[168:171], v21 offset:36864
v_lshlrev_b32 v32, 16, v131
v_mfma_f32_16x16x32_bf16 v[84:87], v[132:135], v[120:123], v[84:87]
v_and_b32 v33, s87, v131
v_mfma_f32_16x16x32_bf16 v[88:91], v[136:139], v[120:123], v[88:91]
v_add_f32 v26, v26, v32
v_mfma_f32_16x16x32_bf16 v[92:95], v[140:143], v[120:123], v[92:95]
v_fmac_f32 v27, v32, v32
v_mfma_f32_16x16x32_bf16 v[100:103], v[132:135], v[124:127], v[100:103]
v_add_f32 v26, v26, v33
v_mfma_f32_16x16x32_bf16 v[104:107], v[136:139], v[124:127], v[104:107]
v_fmac_f32 v27, v33, v33
s_waitcnt vmcnt(0)
s_barrier
s_waitcnt lgkmcnt(9)
v_mfma_f32_16x16x32_bf16 v[36:39], v[172:175], v[148:151], v[36:39]
ds_read_b64_tr_b16 v[132:133], v22 offset:0
s_waitcnt lgkmcnt(1)
v_lshlrev_b32 v30, 16, v168
v_and_b32 v31, s87, v168
v_mfma_f32_16x16x32_bf16 v[40:43], v[176:179], v[148:151], v[40:43]
ds_read_b64_tr_b16 v[134:135], v22 offset:1280
v_add_f32 v26, v26, v30
v_fmac_f32 v27, v30, v30
v_mfma_f32_16x16x32_bf16 v[44:47], v[180:183], v[148:151], v[44:47]
ds_read_b128 v[108:111], v16 offset:0
v_add_f32 v26, v26, v31
v_fmac_f32 v27, v31, v31
v_mfma_f32_16x16x32_bf16 v[52:55], v[172:175], v[152:155], v[52:55]
ds_read_b64_tr_b16 v[136:137], v23 offset:0
v_lshlrev_b32 v32, 16, v169
v_and_b32 v33, s87, v169
v_mfma_f32_16x16x32_bf16 v[232:235], v[164:167], v[164:167], v[232:235]
ds_read_b64_tr_b16 v[138:139], v23 offset:1280
v_add_f32 v26, v26, v32
v_fmac_f32 v27, v32, v32
v_mfma_f32_16x16x32_bf16 v[56:59], v[176:179], v[152:155], v[56:59]
ds_read_b128 v[112:115], v16 offset:2048
v_add_f32 v26, v26, v33
v_fmac_f32 v27, v33, v33
v_mfma_f32_16x16x32_bf16 v[60:63], v[180:183], v[152:155], v[60:63]
ds_read_b64_tr_b16 v[140:141], v24 offset:0
v_lshlrev_b32 v30, 16, v170
v_and_b32 v31, s87, v170
v_mfma_f32_16x16x32_bf16 v[68:71], v[172:175], v[156:159], v[68:71]
ds_read_b64_tr_b16 v[142:143], v24 offset:1280
v_add_f32 v26, v26, v30
v_fmac_f32 v27, v30, v30
v_mfma_f32_16x16x32_bf16 v[72:75], v[176:179], v[156:159], v[72:75]
ds_read_b128 v[116:119], v16 offset:4096
v_add_f32 v26, v26, v31
v_mfma_f32_16x16x32_bf16 v[236:239], v[240:243], v[164:167], v[236:239]
ds_read_b128 v[120:123], v16 offset:6144
v_fmac_f32 v27, v31, v31
v_mfma_f32_16x16x32_bf16 v[76:79], v[180:183], v[156:159], v[76:79]
ds_read_b128 v[124:127], v18 offset:0
v_lshlrev_b32 v32, 16, v171
v_mfma_f32_16x16x32_bf16 v[84:87], v[172:175], v[160:163], v[84:87]
ds_read_b128 v[128:131], v20 offset:0
v_and_b32 v33, s87, v171
v_mfma_f32_16x16x32_bf16 v[88:91], v[176:179], v[160:163], v[88:91]
v_add_f32 v26, v26, v32
v_mfma_f32_16x16x32_bf16 v[92:95], v[180:183], v[160:163], v[92:95]
v_fmac_f32 v27, v32, v32
v_mfma_f32_16x16x32_bf16 v[100:103], v[172:175], v[164:167], v[100:103]
v_add_f32 v26, v26, v33
v_mfma_f32_16x16x32_bf16 v[104:107], v[176:179], v[164:167], v[104:107]
v_fmac_f32 v27, v33, v33
ds_read_b128 v[168:171], v21 offset:0
s_waitcnt lgkmcnt(10)
v_mfma_f32_16x16x32_bf16 v[36:39], v[132:135], v[108:111], v[36:39]
ds_read_b64_tr_b16 v[172:173], v22 offset:5120
s_waitcnt lgkmcnt(2)
v_lshlrev_b32 v30, 16, v128
v_and_b32 v31, s87, v128
v_add_f32 v26, v26, v30
v_mfma_f32_16x16x32_bf16 v[40:43], v[136:139], v[108:111], v[40:43]
ds_read_b64_tr_b16 v[174:175], v22 offset:6400
v_fmac_f32 v27, v30, v30
v_add_f32 v26, v26, v31
v_fmac_f32 v27, v31, v31
v_mfma_f32_16x16x32_bf16 v[44:47], v[140:143], v[108:111], v[44:47]
ds_read_b128 v[148:151], v17 offset:0
v_lshlrev_b32 v32, 16, v129
v_and_b32 v33, s87, v129
v_add_f32 v26, v26, v32
v_mfma_f32_16x16x32_bf16 v[52:55], v[132:135], v[112:115], v[52:55]
ds_read_b64_tr_b16 v[176:177], v23 offset:5120
v_fmac_f32 v27, v32, v32
v_add_f32 v26, v26, v33
v_fmac_f32 v27, v33, v33
v_mfma_f32_16x16x32_bf16 v[232:235], v[124:127], v[124:127], v[232:235]
ds_read_b64_tr_b16 v[178:179], v23 offset:6400
v_lshlrev_b32 v30, 16, v130
v_and_b32 v31, s87, v130
v_add_f32 v26, v26, v30
v_mfma_f32_16x16x32_bf16 v[56:59], v[136:139], v[112:115], v[56:59]
ds_read_b128 v[152:155], v17 offset:2048
v_fmac_f32 v27, v30, v30
v_add_f32 v26, v26, v31
v_fmac_f32 v27, v31, v31
v_mfma_f32_16x16x32_bf16 v[60:63], v[140:143], v[112:115], v[60:63]
ds_read_b64_tr_b16 v[180:181], v24 offset:5120
v_lshlrev_b32 v32, 16, v131
v_and_b32 v33, s87, v131
v_add_f32 v26, v26, v32
v_mfma_f32_16x16x32_bf16 v[68:71], v[132:135], v[116:119], v[68:71]
ds_read_b64_tr_b16 v[182:183], v24 offset:6400
v_fmac_f32 v27, v32, v32
v_add_f32 v26, v26, v33
v_fmac_f32 v27, v33, v33
v_mfma_f32_16x16x32_bf16 v[72:75], v[136:139], v[116:119], v[72:75]
ds_read_b128 v[156:159], v17 offset:4096
s_waitcnt lgkmcnt(9)
v_lshlrev_b32 v30, 16, v168
v_and_b32 v31, s87, v168
v_add_f32 v26, v26, v30
v_mfma_f32_16x16x32_bf16 v[236:239], v[240:243], v[124:127], v[236:239]
ds_read_b128 v[160:163], v17 offset:6144
v_fmac_f32 v27, v30, v30
v_add_f32 v26, v26, v31
v_fmac_f32 v27, v31, v31
v_mfma_f32_16x16x32_bf16 v[76:79], v[140:143], v[116:119], v[76:79]
ds_read_b128 v[164:167], v19 offset:0
v_lshlrev_b32 v32, 16, v169
v_and_b32 v33, s87, v169
v_add_f32 v26, v26, v32
v_mfma_f32_16x16x32_bf16 v[84:87], v[132:135], v[120:123], v[84:87]
v_fmac_f32 v27, v32, v32
v_add_f32 v26, v26, v33
v_fmac_f32 v27, v33, v33
v_mfma_f32_16x16x32_bf16 v[88:91], v[136:139], v[120:123], v[88:91]
v_lshlrev_b32 v30, 16, v170
v_and_b32 v31, s87, v170
v_add_f32 v26, v26, v30
v_mfma_f32_16x16x32_bf16 v[92:95], v[140:143], v[120:123], v[92:95]
v_fmac_f32 v27, v30, v30
v_add_f32 v26, v26, v31
v_fmac_f32 v27, v31, v31
v_mfma_f32_16x16x32_bf16 v[100:103], v[132:135], v[124:127], v[100:103]
v_lshlrev_b32 v32, 16, v171
v_and_b32 v33, s87, v171
v_add_f32 v26, v26, v32
v_mfma_f32_16x16x32_bf16 v[104:107], v[136:139], v[124:127], v[104:107]
v_fmac_f32 v27, v32, v32
v_add_f32 v26, v26, v33
v_fmac_f32 v27, v33, v33
s_waitcnt lgkmcnt(0)
v_mfma_f32_16x16x32_bf16 v[232:235], v[164:167], v[164:167], v[232:235]
v_mov_b32 v30, v26
v_mov_b32 v31, v27
s_nop 0
v_permlane32_swap_b32 v30, v26
v_mfma_f32_16x16x32_bf16 v[236:239], v[240:243], v[164:167], v[236:239]
v_permlane32_swap_b32 v31, v27
v_add_f32 v26, v26, v30
v_add_f32 v27, v27, v31
v_mfma_f32_16x16x32_bf16 v[36:39], v[172:175], v[148:151], v[36:39]
v_mov_b32 v30, v26
v_mov_b32 v31, v27
s_nop 0
v_permlane16_swap_b32 v30, v26
v_mfma_f32_16x16x32_bf16 v[40:43], v[176:179], v[148:151], v[40:43]
v_permlane16_swap_b32 v31, v27
v_add_f32 v26, v26, v30
v_add_f32 v27, v27, v31
v_mfma_f32_16x16x32_bf16 v[44:47], v[180:183], v[148:151], v[44:47]
v_and_b32 v32, 3, v1
v_cmp_eq_u32 vcc, 1, v32
v_cmp_eq_u32 s[28:29], 2, v32
v_cmp_eq_u32 s[30:31], 3, v32
v_cndmask_b32 v29, v232, v233, vcc
v_mfma_f32_16x16x32_bf16 v[52:55], v[172:175], v[152:155], v[52:55]
v_cndmask_b32 v29, v29, v234, s[28:29]
v_cndmask_b32 v29, v29, v235, s[30:31]
v_mov_b32 v28, v236
v_mfma_f32_16x16x32_bf16 v[56:59], v[176:179], v[152:155], v[56:59]
v_mul_f32 v26, 0x3acccccd, v26
v_mul_f32 v28, 0x3acccccd, v28
v_mul_f32 v27, 0x3acccccd, v27
v_mfma_f32_16x16x32_bf16 v[60:63], v[180:183], v[152:155], v[60:63]
v_mul_f32 v29, 0x3acccccd, v29
v_fma_f32 v27, -v26, v26, v27
v_fma_f32 v29, -v28, v28, v29
v_mfma_f32_16x16x32_bf16 v[68:71], v[172:175], v[156:159], v[68:71]
v_max_f32 v27, 0, v27
v_max_f32 v29, 0, v29
v_cvt_pk_bf16_f32 v26, v26, v26
v_cvt_pk_bf16_f32 v28, v28, v28
v_mfma_f32_16x16x32_bf16 v[72:75], v[176:179], v[156:159], v[72:75]
v_and_b32 v26, s87, v26
v_and_b32 v28, s87, v28
v_cvt_pk_bf16_f32 v27, v27, v27
v_cvt_pk_bf16_f32 v29, v29, v29
v_mfma_f32_16x16x32_bf16 v[76:79], v[180:183], v[156:159], v[76:79]
v_and_b32 v27, s87, v27
v_and_b32 v29, s87, v29
v_add_f32 v27, 0x3727c5ac, v27
v_add_f32 v29, 0x3727c5ac, v29
v_mfma_f32_16x16x32_bf16 v[84:87], v[172:175], v[160:163], v[84:87]
v_cvt_pk_bf16_f32 v27, v27, v27
v_cvt_pk_bf16_f32 v29, v29, v29
v_and_b32 v27, s87, v27
v_and_b32 v29, s87, v29
v_mfma_f32_16x16x32_bf16 v[88:91], v[176:179], v[160:163], v[88:91]
v_sqrt_f32 v27, v27
v_sqrt_f32 v29, v29
s_nop 0
s_nop 0
v_mfma_f32_16x16x32_bf16 v[92:95], v[180:183], v[160:163], v[92:95]
v_cvt_pk_bf16_f32 v27, v27, v27
v_cvt_pk_bf16_f32 v29, v29, v29
v_and_b32 v27, s87, v27
v_and_b32 v29, s87, v29
v_mfma_f32_16x16x32_bf16 v[100:103], v[172:175], v[164:167], v[100:103]
v_rcp_f32 v30, v27
v_rcp_f32 v34, v29
s_nop 0
s_nop 0
v_mfma_f32_16x16x32_bf16 v[104:107], v[176:179], v[164:167], v[104:107]
v_mul_f32 v27, v26, v30
v_mul_f32 v29, v28, v34
v_mov_b32 v26, v30
v_mov_b32 v28, v34
s_cmp_eq_u32 s14, 0
s_cbranch_scc0 nl10
s_mov_b32 s28, s84
s_and_b32 s29, s85, 0xffff
s_mov_b32 s30, 256
s_mov_b32 s31, 0x20000
v_mov_b32 v255, 0
buffer_load_dword v252, v255, s[28:31], 0 offen sc1
nl10:
s_cmp_eq_u32 s14, 0
s_cbranch_scc0 pl11
s_add_u32 s28, s8, 25165824
s_addc_u32 s29, s9, 0
s_and_b32 s29, s29, 0xffff
s_mov_b32 s30, 8192
s_mov_b32 s31, 0x20000
v_lshlrev_b32 v255, 2, v0
v_add_u32 v255, 4096, v255
buffer_load_dword v253, v255, s[28:31], 0 offen sc1
v_and_b32 v249, 3, v0
v_lshlrev_b32 v249, 2, v249
v_add_u32 v249, 4352, v249
buffer_load_dword v254, v249, s[28:31], 0 offen sc1
pl11:
ds_write_b64 v219, v[26:27]
s_mov_b32 exec_lo, 0x00010001
s_mov_b32 exec_hi, 0x00010001
ds_write_b128 v220, v[100:103]
ds_write_b128 v221, v[104:107]
s_mov_b64 exec, -1
s_mov_b32 exec_lo, 0x00f0000f
s_mov_b32 exec_hi, 0xf0000f00
ds_write_b64 v214, v[28:29]
s_mov_b64 exec, -1
s_waitcnt lgkmcnt(0)
s_barrier
ds_read_b64 v[108:109], v213 offset:0
ds_read_b64 v[110:111], v213 offset:128
ds_read_b64 v[112:113], v213 offset:256
ds_read_b64 v[114:115], v213 offset:384
ds_read_b128 v[120:123], v215
ds_read_b128 v[124:127], v216
ds_read_b128 v[128:131], v217
ds_read_b64 v[116:117], v214
s_waitcnt lgkmcnt(0)
v_pk_mul_f32 v[140:141], v[120:121], v[108:109] op_sel:[0,1] op_sel_hi:[1,1]
v_pk_mul_f32 v[142:143], v[122:123], v[108:109] op_sel:[0,1] op_sel_hi:[1,1]
v_pk_fma_f32 v[140:141], v[36:37], v[108:109], v[140:141] op_sel_hi:[1,0,1] neg_lo:[0,0,1] neg_hi:[0,0,1]
v_pk_fma_f32 v[142:143], v[38:39], v[108:109], v[142:143] op_sel_hi:[1,0,1] neg_lo:[0,0,1] neg_hi:[0,0,1]
v_cvt_pk_bf16_f32 v144, v140, v141
v_cvt_pk_bf16_f32 v145, v142, v143
ds_write_b64 v188, v[144:145] offset:0
v_pk_mul_f32 v[148:149], v[124:125], v[108:109] op_sel:[0,1] op_sel_hi:[1,1]
v_pk_mul_f32 v[150:151], v[126:127], v[108:109] op_sel:[0,1] op_sel_hi:[1,1]
v_pk_fma_f32 v[148:149], v[40:41], v[108:109], v[148:149] op_sel_hi:[1,0,1] neg_lo:[0,0,1] neg_hi:[0,0,1]
v_pk_fma_f32 v[150:151], v[42:43], v[108:109], v[150:151] op_sel_hi:[1,0,1] neg_lo:[0,0,1] neg_hi:[0,0,1]
v_cvt_pk_bf16_f32 v152, v148, v149
v_cvt_pk_bf16_f32 v153, v150, v151
ds_write_b64 v189, v[152:153] offset:0
v_pk_mul_f32 v[140:141], v[128:129], v[108:109] op_sel:[0,1] op_sel_hi:[1,1]
v_pk_mul_f32 v[142:143], v[130:131], v[108:109] op_sel:[0,1] op_sel_hi:[1,1]
v_pk_fma_f32 v[140:141], v[44:45], v[108:109], v[140:141] op_sel_hi:[1,0,1] neg_lo:[0,0,1] neg_hi:[0,0,1]
v_pk_fma_f32 v[142:143], v[46:47], v[108:109], v[142:143] op_sel_hi:[1,0,1] neg_lo:[0,0,1] neg_hi:[0,0,1]
v_cvt_pk_bf16_f32 v144, v140, v141
v_cvt_pk_bf16_f32 v145, v142, v143
ds_write_b64 v190, v[144:145] offset:0
v_pk_mul_f32 v[148:149], v[120:121], v[110:111] op_sel:[0,1] op_sel_hi:[1,1]
v_pk_mul_f32 v[150:151], v[122:123], v[110:111] op_sel:[0,1] op_sel_hi:[1,1]
v_pk_fma_f32 v[148:149], v[52:53], v[110:111], v[148:149] op_sel_hi:[1,0,1] neg_lo:[0,0,1] neg_hi:[0,0,1]
v_pk_fma_f32 v[150:151], v[54:55], v[110:111], v[150:151] op_sel_hi:[1,0,1] neg_lo:[0,0,1] neg_hi:[0,0,1]
v_cvt_pk_bf16_f32 v152, v148, v149
v_cvt_pk_bf16_f32 v153, v150, v151
ds_write_b64 v188, v[152:153] offset:2560
v_pk_mul_f32 v[140:141], v[124:125], v[110:111] op_sel:[0,1] op_sel_hi:[1,1]
v_pk_mul_f32 v[142:143], v[126:127], v[110:111] op_sel:[0,1] op_sel_hi:[1,1]
v_pk_fma_f32 v[140:141], v[56:57], v[110:111], v[140:141] op_sel_hi:[1,0,1] neg_lo:[0,0,1] neg_hi:[0,0,1]
v_pk_fma_f32 v[142:143], v[58:59], v[110:111], v[142:143] op_sel_hi:[1,0,1] neg_lo:[0,0,1] neg_hi:[0,0,1]
v_cvt_pk_bf16_f32 v144, v140, v141
v_cvt_pk_bf16_f32 v145, v142, v143
ds_write_b64 v189, v[144:145] offset:2560
v_pk_mul_f32 v[148:149], v[128:129], v[110:111] op_sel:[0,1] op_sel_hi:[1,1]
v_pk_mul_f32 v[150:151], v[130:131], v[110:111] op_sel:[0,1] op_sel_hi:[1,1]
v_pk_fma_f32 v[148:149], v[60:61], v[110:111], v[148:149] op_sel_hi:[1,0,1] neg_lo:[0,0,1] neg_hi:[0,0,1]
v_pk_fma_f32 v[150:151], v[62:63], v[110:111], v[150:151] op_sel_hi:[1,0,1] neg_lo:[0,0,1] neg_hi:[0,0,1]
v_cvt_pk_bf16_f32 v152, v148, v149
v_cvt_pk_bf16_f32 v153, v150, v151
ds_write_b64 v190, v[152:153] offset:2560
v_pk_mul_f32 v[140:141], v[120:121], v[112:113] op_sel:[0,1] op_sel_hi:[1,1]
v_pk_mul_f32 v[142:143], v[122:123], v[112:113] op_sel:[0,1] op_sel_hi:[1,1]
v_pk_fma_f32 v[140:141], v[68:69], v[112:113], v[140:141] op_sel_hi:[1,0,1] neg_lo:[0,0,1] neg_hi:[0,0,1]
v_pk_fma_f32 v[142:143], v[70:71], v[112:113], v[142:143] op_sel_hi:[1,0,1] neg_lo:[0,0,1] neg_hi:[0,0,1]
v_cvt_pk_bf16_f32 v144, v140, v141
v_cvt_pk_bf16_f32 v145, v142, v143
ds_write_b64 v188, v[144:145] offset:5120
v_pk_mul_f32 v[148:149], v[124:125], v[112:113] op_sel:[0,1] op_sel_hi:[1,1]
v_pk_mul_f32 v[150:151], v[126:127], v[112:113] op_sel:[0,1] op_sel_hi:[1,1]
v_pk_fma_f32 v[148:149], v[72:73], v[112:113], v[148:149] op_sel_hi:[1,0,1] neg_lo:[0,0,1] neg_hi:[0,0,1]
v_pk_fma_f32 v[150:151], v[74:75], v[112:113], v[150:151] op_sel_hi:[1,0,1] neg_lo:[0,0,1] neg_hi:[0,0,1]
v_cvt_pk_bf16_f32 v152, v148, v149
v_cvt_pk_bf16_f32 v153, v150, v151
ds_write_b64 v189, v[152:153] offset:5120
v_pk_mul_f32 v[140:141], v[128:129], v[112:113] op_sel:[0,1] op_sel_hi:[1,1]
v_pk_mul_f32 v[142:143], v[130:131], v[112:113] op_sel:[0,1] op_sel_hi:[1,1]
v_pk_fma_f32 v[140:141], v[76:77], v[112:113], v[140:141] op_sel_hi:[1,0,1] neg_lo:[0,0,1] neg_hi:[0,0,1]
v_pk_fma_f32 v[142:143], v[78:79], v[112:113], v[142:143] op_sel_hi:[1,0,1] neg_lo:[0,0,1] neg_hi:[0,0,1]
v_cvt_pk_bf16_f32 v144, v140, v141
v_cvt_pk_bf16_f32 v145, v142, v143
ds_write_b64 v190, v[144:145] offset:5120
v_pk_mul_f32 v[148:149], v[120:121], v[114:115] op_sel:[0,1] op_sel_hi:[1,1]
v_pk_mul_f32 v[150:151], v[122:123], v[114:115] op_sel:[0,1] op_sel_hi:[1,1]
v_pk_fma_f32 v[148:149], v[84:85], v[114:115], v[148:149] op_sel_hi:[1,0,1] neg_lo:[0,0,1] neg_hi:[0,0,1]
v_pk_fma_f32 v[150:151], v[86:87], v[114:115], v[150:151] op_sel_hi:[1,0,1] neg_lo:[0,0,1] neg_hi:[0,0,1]
v_cvt_pk_bf16_f32 v152, v148, v149
v_cvt_pk_bf16_f32 v153, v150, v151
ds_write_b64 v188, v[152:153] offset:7680
v_pk_mul_f32 v[140:141], v[124:125], v[114:115] op_sel:[0,1] op_sel_hi:[1,1]
v_pk_mul_f32 v[142:143], v[126:127], v[114:115] op_sel:[0,1] op_sel_hi:[1,1]
v_pk_fma_f32 v[140:141], v[88:89], v[114:115], v[140:141] op_sel_hi:[1,0,1] neg_lo:[0,0,1] neg_hi:[0,0,1]
v_pk_fma_f32 v[142:143], v[90:91], v[114:115], v[142:143] op_sel_hi:[1,0,1] neg_lo:[0,0,1] neg_hi:[0,0,1]
v_cvt_pk_bf16_f32 v144, v140, v141
v_cvt_pk_bf16_f32 v145, v142, v143
ds_write_b64 v189, v[144:145] offset:7680
v_pk_mul_f32 v[148:149], v[128:129], v[114:115] op_sel:[0,1] op_sel_hi:[1,1]
v_pk_mul_f32 v[150:151], v[130:131], v[114:115] op_sel:[0,1] op_sel_hi:[1,1]
v_pk_fma_f32 v[148:149], v[92:93], v[114:115], v[148:149] op_sel_hi:[1,0,1] neg_lo:[0,0,1] neg_hi:[0,0,1]
v_pk_fma_f32 v[150:151], v[94:95], v[114:115], v[150:151] op_sel_hi:[1,0,1] neg_lo:[0,0,1] neg_hi:[0,0,1]
v_cvt_pk_bf16_f32 v152, v148, v149
v_cvt_pk_bf16_f32 v153, v150, v151
ds_write_b64 v190, v[152:153] offset:7680
v_pk_mul_f32 v[140:141], v[120:121], v[116:117] op_sel:[0,1] op_sel_hi:[1,1]
v_pk_mul_f32 v[142:143], v[122:123], v[116:117] op_sel:[0,1] op_sel_hi:[1,1]
v_pk_fma_f32 v[140:141], v[100:101], v[116:117], v[140:141] op_sel_hi:[1,0,1] neg_lo:[0,0,1] neg_hi:[0,0,1]
v_pk_fma_f32 v[142:143], v[102:103], v[116:117], v[142:143] op_sel_hi:[1,0,1] neg_lo:[0,0,1] neg_hi:[0,0,1]
v_cvt_pk_bf16_f32 v144, v140, v141
v_cvt_pk_bf16_f32 v145, v142, v143
ds_write_b64 v192, v[144:145] offset:0
v_pk_mul_f32 v[148:149], v[124:125], v[116:117] op_sel:[0,1] op_sel_hi:[1,1]
v_pk_mul_f32 v[150:151], v[126:127], v[116:117] op_sel:[0,1] op_sel_hi:[1,1]
v_pk_fma_f32 v[148:149], v[104:105], v[116:117], v[148:149] op_sel_hi:[1,0,1] neg_lo:[0,0,1] neg_hi:[0,0,1]
v_pk_fma_f32 v[150:151], v[106:107], v[116:117], v[150:151] op_sel_hi:[1,0,1] neg_lo:[0,0,1] neg_hi:[0,0,1]
v_cvt_pk_bf16_f32 v152, v148, v149
v_cvt_pk_bf16_f32 v153, v150, v151
ds_write_b64 v193, v[152:153] offset:0
s_cmp_eq_u32 s14, 0
s_cbranch_scc0 e212
s_waitcnt vmcnt(0)
s_mov_b32 s33, 0
ng13:
v_readfirstlane_b32 s52, v252
s_nop 3
s_cmp_lg_u32 s52, 0
s_cbranch_scc1 ng14
s_mov_b32 s28, s84
s_and_b32 s29, s85, 0xffff
s_mov_b32 s30, 256
s_mov_b32 s31, 0x20000
s_sleep 8
v_mov_b32 v255, 0
buffer_load_dword v252, v255, s[28:31], 0 offen sc1
s_waitcnt vmcnt(0)
s_add_u32 s33, s33, 1
s_cmp_lt_u32 s33, 0x20000
s_cbranch_scc1 ng13
ng14:
s_mov_b32 s33, 0
pc15:
v_cmp_ne_u32 vcc, s52, v253
v_cmp_ne_u32 s[54:55], s52, v254
s_nop 3
s_or_b64 vcc, vcc, s[54:55]
s_cmp_eq_u64 vcc, 0
s_cbranch_scc1 pc16
s_sleep 4
s_add_u32 s28, s8, 25165824
s_addc_u32 s29, s9, 0
s_and_b32 s29, s29, 0xffff
s_mov_b32 s30, 8192
s_mov_b32 s31, 0x20000
v_lshlrev_b32 v255, 2, v0
v_add_u32 v255, 4096, v255
buffer_load_dword v253, v255, s[28:31], 0 offen sc1
v_and_b32 v249, 3, v0
v_lshlrev_b32 v249, 2, v249
v_add_u32 v249, 4352, v249
buffer_load_dword v254, v249, s[28:31], 0 offen sc1
s_waitcnt vmcnt(0)
s_add_u32 s33, s33, 1
s_cmp_lt_u32 s33, 0x20000
s_cbranch_scc1 pc15
pc16:
v_mov_b32 v22, 99328
v_mov_b32 v23, s52
ds_write_b32 v22, v23
e212:
s_waitcnt lgkmcnt(0)
s_barrier
s_mov_b32 s53, 1
s_lshl_b32 s66, s12, 7
s_lshl_b32 s29, s13, 2
s_add_u32 s66, s66, s29
s_and_b32 s10, s2, 7
s_lshr_b32 s11, s2, 3
s_lshr_b32 s12, s10, 1
s_lshl_b32 s12, s12, 3
s_and_b32 s13, s11, 7
s_add_u32 s12, s12, s13
s_and_b32 s13, s10, 1
s_lshl_b32 s13, s13, 2
s_lshr_b32 s15, s11, 3
s_add_u32 s13, s13, s15
v_lshlrev_b32 v2, 4, v0
s_and_b32 s15, s14, 3
s_lshr_b32 s16, s14, 2
s_lshl_b32 s20, s14, 10
s_lshl_b32 s23, s16, 13
s_add_u32 s20, s20, s23
s_mul_i32 s19, s13, 348160
s_add_u32 s21, s20, 4096
s_add_u32 s22, s20, 8192
s_add_u32 s23, s19, s20
s_add_u32 s24, s19, s21
s_add_u32 s25, s19, s22
s_add_u32 s20, s20, 102400
s_add_u32 s21, s21, 102400
s_add_u32 s22, s22, 102400
s_add_u32 s32, s8, 16777216
s_addc_u32 s33, s9, 0
s_and_b32 s33, s33, 0xffff
s_mov_b32 s34, 2785280
s_mov_b32 s35, 0x20000
s_lshl_b32 s17, s12, 2
s_add_u32 s17, s17, s15
s_mul_i32 s18, s17, 69632
s_lshl_b32 s19, s16, 11
s_add_u32 s18, s18, s19
s_lshl_b32 s26, s14, 11
s_lshr_b32 s38, s12, 1
s_lshl_b32 s38, s38, 7
s_and_b32 s39, s12, 1
s_add_u32 s38, s38, s39
s_lshl_b32 s39, s15, 5
s_add_u32 s38, s38, s39
v_and_b32 v3, 15, v0
v_lshlrev_b32 v3, 1, v3
v_add_u32 v3, s38, v3
v_mul_u32_u24 v3, 1280, v3
v_lshrrev_b32 v4, 4, v0
s_mul_i32 s39, s13, 160
v_add_u32 v3, s39, v3
v_lshlrev_b32 v5, 4, v4
v_add_u32 v5, v3, v5
s_lshl_b32 s39, s16, 6
v_add_u32 v5, s39, v5
v_lshlrev_b32 v6, 3, v4
v_add_u32 v6, v3, v6
v_add_u32 v6, 128, v6
s_mov_b32 s40, s4
s_and_b32 s41, s5, 0xffff
s_mov_b32 s42, 2621440
s_mov_b32 s43, 0x20000
s_mov_b32 s44, s96
s_and_b32 s45, s97, 0xffff
s_mov_b32 s46, 2621440
s_mov_b32 s47, 0x20000
v_add_u32 v14, 102400, v2
s_lshl_b32 s39, s15, 11
v_add_u32 v15, s39, v2
v_lshlrev_b32 v223, 3, v0
v_add_u32 v223, s39, v223
s_lshr_b32 s38, s12, 1
s_lshl_b32 s38, s38, 7
v_and_b32 v21, 7, v0
v_lshlrev_b32 v21, 2, v21
v_add_u32 v21, s38, v21
v_add_u32 v20, 32, v21
s_cmp_eq_u32 s16, 0
s_cbranch_scc0 wp1_qB
s_add_u32 m0, s20, 0
s_nop 0
buffer_load_dwordx4 v2, s[32:35], s23 offen sc1 lds
s_add_u32 s23, s23, 20480
s_add_u32 m0, s21, 0
s_nop 0
buffer_load_dwordx4 v2, s[32:35], s24 offen sc1 lds
s_add_u32 s24, s24, 20480
s_add_u32 m0, s22, 0
s_nop 0
buffer_load_dwordx4 v2, s[32:35], s25 offen sc1 lds
s_add_u32 s25, s25, 20480
s_add_u32 m0, s20, 20480
s_nop 0
buffer_load_dwordx4 v2, s[32:35], s23 offen sc1 lds
s_add_u32 s23, s23, 20480
s_add_u32 m0, s21, 20480
s_nop 0
buffer_load_dwordx4 v2, s[32:35], s24 offen sc1 lds
s_add_u32 s24, s24, 20480
s_add_u32 m0, s22, 20480
s_nop 0
buffer_load_dwordx4 v2, s[32:35], s25 offen sc1 lds
s_add_u32 s25, s25, 20480
s_add_u32 m0, s20, 40960
s_nop 0
buffer_load_dwordx4 v2, s[32:35], s23 offen sc1 lds
s_add_u32 s23, s23, 20480
s_add_u32 m0, s21, 40960
s_nop 0
buffer_load_dwordx4 v2, s[32:35], s24 offen sc1 lds
s_add_u32 s24, s24, 20480
s_add_u32 m0, s22, 40960
s_nop 0
buffer_load_dwordx4 v2, s[32:35], s25 offen sc1 lds
s_add_u32 s25, s25, 20480
s_branch wp2_qB
wp1_qB:
s_add_u32 m0, s20, 0
s_nop 0
buffer_load_dwordx4 v2, s[32:35], s23 offen sc1 lds
s_add_u32 s23, s23, 20480
s_add_u32 m0, s21, 0
s_nop 0
buffer_load_dwordx4 v2, s[32:35], s24 offen sc1 lds
s_add_u32 s24, s24, 20480
s_add_u32 m0, s20, 20480
s_nop 0
buffer_load_dwordx4 v2, s[32:35], s23 offen sc1 lds
s_add_u32 s23, s23, 20480
s_add_u32 m0, s21, 20480
s_nop 0
buffer_load_dwordx4 v2, s[32:35], s24 offen sc1 lds
s_add_u32 s24, s24, 20480
s_add_u32 m0, s20, 40960
s_nop 0
buffer_load_dwordx4 v2, s[32:35], s23 offen sc1 lds
s_add_u32 s23, s23, 20480
s_add_u32 m0, s21, 40960
s_nop 0
buffer_load_dwordx4 v2, s[32:35], s24 offen sc1 lds
s_add_u32 s24, s24, 20480
wp2_qB:
q_attn:
ds_read_b64 v[36:37], v200 offset:0
ds_read_b64 v[38:39], v200 offset:512
ds_read_b64 v[40:41], v200 offset:1024
ds_read_b64 v[42:43], v200 offset:1536
ds_read_b64 v[44:45], v200 offset:2048
ds_read_b64 v[46:47], v194 offset:0
ds_read_b64 v[56:57], v195 offset:0
ds_read_b64 v[66:67], v196 offset:0
ds_read_b64 v[48:49], v194 offset:512
ds_read_b64 v[58:59], v195 offset:512
ds_read_b64 v[68:69], v196 offset:512
ds_read_b64 v[50:51], v194 offset:1024
ds_read_b64 v[60:61], v195 offset:1024
ds_read_b64 v[70:71], v196 offset:1024
ds_read_b64 v[52:53], v194 offset:1536
ds_read_b64 v[62:63], v195 offset:1536
ds_read_b64 v[72:73], v196 offset:1536
ds_read_b64 v[54:55], v194 offset:2048
ds_read_b64 v[64:65], v195 offset:2048
ds_read_b64 v[74:75], v196 offset:2048
s_mov_b32 s30, 0x3ea52b5c
s_waitcnt lgkmcnt(12)
v_mfma_f32_4x4x4_16b_bf16 v[128:131], v[46:47], v[36:37], 0
v_mfma_f32_4x4x4_16b_bf16 v[132:135], v[56:57], v[36:37], 0
v_mfma_f32_4x4x4_16b_bf16 v[136:139], v[66:67], v[36:37], 0
s_waitcnt lgkmcnt(9)
v_mfma_f32_4x4x4_16b_bf16 v[128:131], v[48:49], v[38:39], v[128:131]
v_mfma_f32_4x4x4_16b_bf16 v[132:135], v[58:59], v[38:39], v[132:135]
v_mfma_f32_4x4x4_16b_bf16 v[136:139], v[68:69], v[38:39], v[136:139]
s_waitcnt lgkmcnt(6)
v_mfma_f32_4x4x4_16b_bf16 v[128:131], v[50:51], v[40:41], v[128:131]
v_mfma_f32_4x4x4_16b_bf16 v[132:135], v[60:61], v[40:41], v[132:135]
v_mfma_f32_4x4x4_16b_bf16 v[136:139], v[70:71], v[40:41], v[136:139]
s_waitcnt lgkmcnt(3)
v_mfma_f32_4x4x4_16b_bf16 v[128:131], v[52:53], v[42:43], v[128:131]
v_mfma_f32_4x4x4_16b_bf16 v[132:135], v[62:63], v[42:43], v[132:135]
v_mfma_f32_4x4x4_16b_bf16 v[136:139], v[72:73], v[42:43], v[136:139]
s_waitcnt lgkmcnt(0)
v_mfma_f32_4x4x4_16b_bf16 v[128:131], v[54:55], v[44:45], v[128:131]
v_mfma_f32_4x4x4_16b_bf16 v[132:135], v[64:65], v[44:45], v[132:135]
v_mfma_f32_4x4x4_16b_bf16 v[136:139], v[74:75], v[44:45], v[136:139]
ds_read_b64_tr_b16 v[76:77], v197 offset:0
ds_read_b64_tr_b16 v[78:79], v197 offset:512
ds_read_b64_tr_b16 v[80:81], v197 offset:1024
ds_read_b64_tr_b16 v[82:83], v197 offset:1536
ds_read_b64_tr_b16 v[84:85], v197 offset:2048
ds_read_b64_tr_b16 v[86:87], v198 offset:0
ds_read_b64_tr_b16 v[88:89], v198 offset:512
ds_read_b64_tr_b16 v[90:91], v198 offset:1024
ds_read_b64_tr_b16 v[92:93], v198 offset:1536
ds_read_b64_tr_b16 v[94:95], v198 offset:2048
ds_read_b64_tr_b16 v[96:97], v199 offset:0
ds_read_b64_tr_b16 v[98:99], v199 offset:512
ds_read_b64_tr_b16 v[100:101], v199 offset:1024
ds_read_b64_tr_b16 v[102:103], v199 offset:1536
ds_read_b64_tr_b16 v[104:105], v199 offset:2048
v_fma_f32 v128, v128, s30, v201
v_fma_f32 v129, v129, s30, v202
v_fma_f32 v130, v130, s30, v203
v_fma_f32 v131, v131, s30, v204
v_fma_f32 v132, v132, s30, v205
v_fma_f32 v133, v133, s30, v206
v_fma_f32 v134, v134, s30, v207
v_fma_f32 v135, v135, s30, v208
v_fma_f32 v136, v136, s30, v209
v_fma_f32 v137, v137, s30, v210
v_fma_f32 v138, v138, s30, v211
v_fma_f32 v139, v139, s30, v212
v_max3_f32 v34, v128, v129, v130
v_max3_f32 v35, v131, v132, v133
v_max3_f32 v34, v34, v134, v135
v_max3_f32 v35, v35, v136, v137
v_max3_f32 v34, v34, v138, v139
v_max_f32 v34, v34, v35
v_sub_f32 v128, v128, v34
v_sub_f32 v129, v129, v34
v_sub_f32 v130, v130, v34
v_sub_f32 v131, v131, v34
v_sub_f32 v132, v132, v34
v_sub_f32 v133, v133, v34
v_sub_f32 v134, v134, v34
v_sub_f32 v135, v135, v34
v_sub_f32 v136, v136, v34
v_sub_f32 v137, v137, v34
v_sub_f32 v138, v138, v34
v_sub_f32 v139, v139, v34
v_exp_f32 v128, v128
v_exp_f32 v129, v129
v_exp_f32 v130, v130
v_exp_f32 v131, v131
v_exp_f32 v132, v132
v_exp_f32 v133, v133
v_exp_f32 v134, v134
v_exp_f32 v135, v135
v_exp_f32 v136, v136
v_exp_f32 v137, v137
v_exp_f32 v138, v138
v_exp_f32 v139, v139
v_add_f32 v34, v128, v129
v_add_f32 v35, v130, v131
v_add_f32 v34, v34, v132
v_add_f32 v35, v35, v133
v_add_f32 v34, v34, v134
v_add_f32 v35, v35, v135
v_add_f32 v34, v34, v136
v_add_f32 v35, v35, v137
v_add_f32 v34, v34, v138
v_add_f32 v35, v35, v139
v_add_f32 v34, v34, v35
v_rcp_f32 v34, v34
s_nop 0
v_mul_f32 v128, v128, v34
v_mul_f32 v129, v129, v34
v_mul_f32 v130, v130, v34
v_mul_f32 v131, v131, v34
v_mul_f32 v132, v132, v34
v_mul_f32 v133, v133, v34
v_mul_f32 v134, v134, v34
v_mul_f32 v135, v135, v34
v_mul_f32 v136, v136, v34
v_mul_f32 v137, v137, v34
v_mul_f32 v138, v138, v34
v_mul_f32 v139, v139, v34
v_cvt_pk_bf16_f32 v116, v128, v129
v_cvt_pk_bf16_f32 v117, v130, v131
v_cvt_pk_bf16_f32 v118, v132, v133
v_cvt_pk_bf16_f32 v119, v134, v135
v_cvt_pk_bf16_f32 v120, v136, v137
v_cvt_pk_bf16_f32 v121, v138, v139
s_waitcnt lgkmcnt(0)
v_mfma_f32_4x4x4_16b_bf16 v[140:143], v[76:77], v[116:117], 0
v_mfma_f32_4x4x4_16b_bf16 v[144:147], v[78:79], v[116:117], 0
v_mfma_f32_4x4x4_16b_bf16 v[148:151], v[80:81], v[116:117], 0
v_mfma_f32_4x4x4_16b_bf16 v[152:155], v[82:83], v[116:117], 0
v_mfma_f32_4x4x4_16b_bf16 v[156:159], v[84:85], v[116:117], 0
v_mfma_f32_4x4x4_16b_bf16 v[140:143], v[86:87], v[118:119], v[140:143]
v_mfma_f32_4x4x4_16b_bf16 v[144:147], v[88:89], v[118:119], v[144:147]
v_mfma_f32_4x4x4_16b_bf16 v[148:151], v[90:91], v[118:119], v[148:151]
v_mfma_f32_4x4x4_16b_bf16 v[152:155], v[92:93], v[118:119], v[152:155]
v_mfma_f32_4x4x4_16b_bf16 v[156:159], v[94:95], v[118:119], v[156:159]
v_mfma_f32_4x4x4_16b_bf16 v[140:143], v[96:97], v[120:121], v[140:143]
v_mfma_f32_4x4x4_16b_bf16 v[144:147], v[98:99], v[120:121], v[144:147]
v_mfma_f32_4x4x4_16b_bf16 v[148:151], v[100:101], v[120:121], v[148:151]
v_mfma_f32_4x4x4_16b_bf16 v[152:155], v[102:103], v[120:121], v[152:155]
v_mfma_f32_4x4x4_16b_bf16 v[156:159], v[104:105], v[120:121], v[156:159]
s_nop 0
v_cvt_pk_bf16_f32 v36, v140, v141
v_cvt_pk_bf16_f32 v37, v142, v143
v_cvt_pk_bf16_f32 v38, v144, v145
v_cvt_pk_bf16_f32 v39, v146, v147
v_cvt_pk_bf16_f32 v40, v148, v149
v_cvt_pk_bf16_f32 v41, v150, v151
v_cvt_pk_bf16_f32 v42, v152, v153
v_cvt_pk_bf16_f32 v43, v154, v155
v_cvt_pk_bf16_f32 v44, v156, v157
v_cvt_pk_bf16_f32 v45, v158, v159
s_branch p1_end
p1_ffn:
s_sub_u32 s13, s13, 8
s_add_u32 s28, s14, 0
s_lshl_b32 s31, s28, 6
v_add_u32 v32, s31, v0
v_mul_u32_u24 v33, 2731, v32
v_lshrrev_b32 v33, 16, v33
v_mul_u32_u24 v34, 24, v33
v_sub_u32 v34, v32, v34
v_bfe_u32 v35, v33, 1, 2
v_lshlrev_b32 v35, 1, v35
v_xor_b32 v34, v34, v35
v_and_b32 v35, 0xfffffff3, v33
v_and_b32 v32, 4, v33
v_lshl_or_b32 v35, v32, 1, v35
v_bfe_u32 v32, v33, 3, 1
v_lshl_or_b32 v35, v32, 2, v35
v_mul_u32_u24 v35, 3072, v35
v_lshl_add_u32 v35, v34, 4, v35
s_mul_i32 s33, s13, 384
v_add_u32 v12, s33, v35
s_lshl_b32 s33, s28, 10
s_add_u32 s36, s33, 49152
s_mul_i32 s49, s55, 196608
s_mov_b32 s24, s56
s_and_b32 s25, s57, 0xffff
s_mov_b32 s26, 1966080
s_mov_b32 s27, 0x20000
s_add_u32 m0, s36, 0
s_nop 0
buffer_load_dwordx4 v12, s[24:27], s49 offen  lds
s_add_u32 s28, s14, 8
s_lshl_b32 s31, s28, 6
v_add_u32 v32, s31, v0
v_mul_u32_u24 v33, 2731, v32
v_lshrrev_b32 v33, 16, v33
v_mul_u32_u24 v34, 24, v33
v_sub_u32 v34, v32, v34
v_bfe_u32 v35, v33, 1, 2
v_lshlrev_b32 v35, 1, v35
v_xor_b32 v34, v34, v35
v_and_b32 v35, 0xfffffff3, v33
v_and_b32 v32, 4, v33
v_lshl_or_b32 v35, v32, 1, v35
v_bfe_u32 v32, v33, 3, 1
v_lshl_or_b32 v35, v32, 2, v35
v_mul_u32_u24 v35, 3072, v35
v_lshl_add_u32 v35, v34, 4, v35
s_mul_i32 s33, s13, 384
v_add_u32 v13, s33, v35
s_lshl_b32 s33, s28, 10
s_add_u32 s37, s33, 49152
s_add_u32 m0, s37, 0
s_nop 0
buffer_load_dwordx4 v13, s[24:27], s49 offen  lds
s_add_u32 s28, s14, 16
s_lshl_b32 s31, s28, 6
v_add_u32 v32, s31, v0
v_mul_u32_u24 v33, 2731, v32
v_lshrrev_b32 v33, 16, v33
v_mul_u32_u24 v34, 24, v33
v_sub_u32 v34, v32, v34
v_bfe_u32 v35, v33, 1, 2
v_lshlrev_b32 v35, 1, v35
v_xor_b32 v34, v34, v35
v_and_b32 v35, 0xfffffff3, v33
v_and_b32 v32, 4, v33
v_lshl_or_b32 v35, v32, 1, v35
v_bfe_u32 v32, v33, 3, 1
v_lshl_or_b32 v35, v32, 2, v35
v_mul_u32_u24 v35, 3072, v35
v_lshl_add_u32 v35, v34, 4, v35
s_mul_i32 s33, s13, 384
v_add_u32 v14, s33, v35
s_lshl_b32 s33, s28, 10
s_add_u32 s38, s33, 49152
s_add_u32 m0, s38, 0
s_nop 0
buffer_load_dwordx4 v14, s[24:27], s49 offen  lds
s_mov_b32 s55, 1
s_lshl_b32 s48, s55, 7
s_mul_i32 s49, s55, 196608
v_mov_b32 v26, 0
v_mov_b32 v27, 0
v_cmp_eq_u32 vcc, 0, v1
v_mov_b32 v32, 0x3f803f80
s_nop 1
v_cndmask_b32 v92, 0, v32, vcc
v_mov_b32 v93, v92
v_mov_b32 v94, v92
v_mov_b32 v95, v92
s_add_u32 m0, s34, 16384
s_nop 0
buffer_load_dwordx4 v10, s[20:23], s48 offen  lds
s_xor_b32 s28, s16, 0
s_lshl_b32 s29, s15, 1
s_add_u32 s28, s28, s29
s_mov_b32 s70, s28
s_lshl_b32 s28, s28, 11
v_add_u32 v16, s28, v6
v_add_u32 v17, s28, v7
s_xor_b32 s28, s16, 1
s_lshl_b32 s29, s15, 1
s_add_u32 s28, s28, s29
s_mov_b32 s71, s28
s_lshl_b32 s28, s28, 11
v_add_u32 v18, s28, v6
v_add_u32 v19, s28, v7
v_mul_u32_u24 v32, 384, v30
v_and_b32 v33, 1, v9
v_lshl_add_u32 v32, v33, 3, v32
v_add_u32 v32, 49152, v32
v_bfe_u32 v33, v30, 1, 2
v_lshlrev_b32 v33, 1, v33
v_lshrrev_b32 v34, 1, v9
s_bfe_u32 s72, 0x6a860420, s19
s_lshl_b32 s28, s72, 1
v_add_u32 v35, s28, v34
v_xor_b32 v35, v35, v33
v_lshl_add_u32 v20, v35, 4, v32
s_bfe_u32 s73, 0x7b971531, s19
s_lshl_b32 s28, s73, 1
v_add_u32 v35, s28, v34
v_xor_b32 v35, v35, v33
v_lshl_add_u32 v21, v35, 4, v32
s_bfe_u32 s74, 0x86a82042, s19
s_lshl_b32 s28, s74, 1
v_add_u32 v35, s28, v34
v_xor_b32 v35, v35, v33
v_lshl_add_u32 v22, v35, 4, v32
s_bfe_u32 s75, 0x97b93153, s19
s_lshl_b32 s28, s75, 1
v_add_u32 v35, s28, v34
v_xor_b32 v35, v35, v33
v_lshl_add_u32 v23, v35, 4, v32
s_bfe_u32 s76, 0xa86a4204, s19
s_lshl_b32 s28, s76, 1
v_add_u32 v35, s28, v34
v_xor_b32 v35, v35, v33
v_lshl_add_u32 v24, v35, 4, v32
s_add_u32 m0, s35, 16384
s_nop 0
buffer_load_dwordx4 v11, s[20:23], s48 offen  lds
s_bfe_u32 s77, 0xb97b5315, s19
s_lshl_b32 s28, s77, 1
v_add_u32 v35, s28, v34
v_xor_b32 v35, v35, v33
v_lshl_add_u32 v25, v35, 4, v32
v_lshlrev_b32 v224, 4, v2
v_lshlrev_b32 v225, 3, v1
v_lshlrev_b32 v171, 4, v0
s_lshl_b32 s28, s72, 6
s_add_u32 s28, s28, 17664
v_add_u32 v160, s28, v224
s_lshl_b32 s28, s73, 6
s_add_u32 s28, s28, 17664
v_add_u32 v161, s28, v224
s_lshl_b32 s28, s74, 6
s_add_u32 s28, s28, 17664
v_add_u32 v162, s28, v224
s_lshl_b32 s28, s75, 6
s_add_u32 s28, s28, 17664
v_add_u32 v163, s28, v224
s_lshl_b32 s28, s76, 6
s_add_u32 s28, s28, 17664
v_add_u32 v164, s28, v224
s_lshl_b32 s28, s77, 6
s_add_u32 s28, s28, 17664
v_add_u32 v165, s28, v224
s_lshl_b32 s28, s70, 7
s_add_u32 s28, s28, 16384
v_add_u32 v168, s28, v225
s_lshl_b32 s28, s12, 3
s_add_u32 s28, s28, s70
s_mul_i32 s28, s28, 69632
s_mul_i32 s29, s13, 6144
s_add_u32 s78, s28, s29
s_lshl_b32 s28, s71, 7
s_add_u32 s28, s28, 16384
v_add_u32 v169, s28, v225
s_lshl_b32 s28, s12, 3
s_add_u32 s28, s28, s71
s_mul_i32 s28, s28, 69632
s_mul_i32 s29, s13, 6144
s_add_u32 s79, s28, s29
s_add_u32 m0, s36, 24576
s_nop 0
buffer_load_dwordx4 v12, s[24:27], s49 offen  lds
s_mov_b32 s80, s8
s_and_b32 s81, s9, 0xffff
s_mov_b32 s82, 8912896
s_mov_b32 s83, 0x20000
s_lshl_b32 s64, s13, 4
s_add_u32 s64, s64, s12
s_cmp_lt_u32 s64, 68
s_cselect_b32 s68, 5, 0
s_sub_u32 s28, s64, 48
s_mul_i32 s29, s28, 52
s_lshr_b32 s29, s29, 8
s_mul_i32 s30, s29, 5
s_sub_u32 s30, s28, s30
s_lshr_b32 s31, s30, 1
s_mul_i32 s31, s31, 80
s_and_b32 s33, s30, 1
s_lshl_b32 s33, s33, 3
s_add_u32 s31, s31, s33
s_cmp_eq_u32 s30, 4
s_cselect_b32 s31, 16, s31
s_cselect_b32 s67, 80, 4
s_mul_i32 s65, s29, 160
s_add_u32 s65, s65, s31
s_mov_b32 s66, 20
s_lshl_b32 s28, s64, 5
s_cmp_lt_u32 s64, 48
s_cselect_b32 s65, s28, s65
s_cselect_b32 s66, 4, s66
s_cselect_b32 s67, 16, s67
s_cselect_b32 s40, s58, s60
s_cselect_b32 s41, s59, s61
s_and_b32 s41, s41, 0xffff
s_cmp_lt_u32 s64, 48
s_mov_b32 s42, 819200
s_cselect_b32 s42, 1966080, s42
s_mov_b32 s43, 0x20000
s_add_u32 s28, s14, 0
s_lshl_b32 s31, s28, 6
v_add_u32 v224, s31, v0
v_mul_u32_u24 v225, 3277, v224
v_lshrrev_b32 v225, 18, v225
v_mul_u32_u24 v226, 80, v225
v_sub_u32 v226, v224, v226
v_lshrrev_b32 v227, 4, v225
v_mul_lo_u32 v227, v227, s67
s_add_u32 m0, s37, 24576
s_nop 0
buffer_load_dwordx4 v13, s[24:27], s49 offen  lds
v_bfe_u32 v224, v225, 2, 2
v_mul_lo_u32 v224, v224, s66
v_and_b32 v225, 3, v225
v_add3_u32 v227, v227, v224, v225
v_add_u32 v227, s65, v227
v_mul_u32_u24 v227, 1280, v227
v_lshl_add_u32 v174, v226, 4, v227
s_add_u32 s28, s14, 8
s_lshl_b32 s31, s28, 6
v_add_u32 v224, s31, v0
v_mul_u32_u24 v225, 3277, v224
v_lshrrev_b32 v225, 18, v225
v_mul_u32_u24 v226, 80, v225
v_sub_u32 v226, v224, v226
v_lshrrev_b32 v227, 4, v225
v_mul_lo_u32 v227, v227, s67
v_bfe_u32 v224, v225, 2, 2
v_mul_lo_u32 v224, v224, s66
v_and_b32 v225, 3, v225
v_add3_u32 v227, v227, v224, v225
v_add_u32 v227, s65, v227
v_mul_u32_u24 v227, 1280, v227
v_lshl_add_u32 v175, v226, 4, v227
s_add_u32 s28, s14, 16
s_lshl_b32 s31, s28, 6
v_add_u32 v224, s31, v0
v_mul_u32_u24 v225, 3277, v224
v_lshrrev_b32 v225, 18, v225
v_mul_u32_u24 v226, 80, v225
v_sub_u32 v226, v224, v226
v_lshrrev_b32 v227, 4, v225
v_mul_lo_u32 v227, v227, s67
v_bfe_u32 v224, v225, 2, 2
v_mul_lo_u32 v224, v224, s66
v_and_b32 v225, 3, v225
v_add3_u32 v227, v227, v224, v225
v_add_u32 v227, s65, v227
v_mul_u32_u24 v227, 1280, v227
v_lshl_add_u32 v176, v226, 4, v227
s_add_u32 s28, s14, 24
s_lshl_b32 s31, s28, 6
v_add_u32 v224, s31, v0
v_mul_u32_u24 v225, 3277, v224
v_lshrrev_b32 v225, 18, v225
s_add_u32 m0, s38, 24576
s_nop 0
buffer_load_dwordx4 v14, s[24:27], s49 offen  lds
s_mov_b32 s55, s54
s_lshl_b32 s48, s55, 7
s_mul_i32 s49, s55, 196608
v_mul_u32_u24 v226, 80, v225
v_sub_u32 v226, v224, v226
v_lshrrev_b32 v227, 4, v225
v_mul_lo_u32 v227, v227, s67
v_bfe_u32 v224, v225, 2, 2
v_mul_lo_u32 v224, v224, s66
v_and_b32 v225, 3, v225
v_add3_u32 v227, v227, v224, v225
v_add_u32 v227, s65, v227
v_mul_u32_u24 v227, 1280, v227
v_lshl_add_u32 v177, v226, 4, v227
s_add_u32 s28, s14, 32
s_lshl_b32 s31, s28, 6
v_add_u32 v224, s31, v0
v_mul_u32_u24 v225, 3277, v224
v_lshrrev_b32 v225, 18, v225
v_mul_u32_u24 v226, 80, v225
v_sub_u32 v226, v224, v226
v_lshrrev_b32 v227, 4, v225
v_mul_lo_u32 v227, v227, s67
v_bfe_u32 v224, v225, 2, 2
v_mul_lo_u32 v224, v224, s66
v_and_b32 v225, 3, v225
v_add3_u32 v227, v227, v224, v225
v_add_u32 v227, s65, v227
v_mul_u32_u24 v227, 1280, v227
v_lshl_add_u32 v178, v226, 4, v227
s_add_u32 s44, s8, 16777216
s_addc_u32 s45, s9, 0
s_and_b32 s45, s45, 0xffff
s_mov_b32 s46, 2785280
s_mov_b32 s47, 0x20000
v_lshrrev_b32 v224, 2, v0
v_mul_u32_u24 v224, 1280, v224
s_mul_i32 s28, s14, 160
s_add_u32 s28, s28, 122880
v_add_u32 v224, s28, v224
v_lshl_add_u32 v172, v9, 4, v224
v_lshl_add_u32 v173, v9, 3, v224
s_mul_i32 s28, s14, 348160
s_mul_i32 s29, s64, 5120
s_add_u32 s69, s28, s29
s_cmp_eq_u32 s68, 5
s_cselect_b32 s100, -1, 0
s_cselect_b32 s101, -1, 0
s_or_b32 s28, s2, s14
s_cmp_eq_u32 s28, 0
s_cbranch_scc0 nn17
s_memrealtime s[32:33]
s_mov_b32 s28, s84
s_and_b32 s29, s85, 0xffff
s_mov_b32 s30, 256
s_mov_b32 s31, 0x20000
s_waitcnt lgkmcnt(0)
s_or_b32 s32, s32, 1
v_mov_b32 v252, s32
v_mov_b32 v255, 0
s_mov_b64 exec, 1
buffer_store_dword v252, v255, s[28:31], 0 offen sc1
s_mov_b64 exec, -1
nn17:
s_waitcnt vmcnt(5)
s_barrier
ds_read_b64_tr_b16 v[104:105], v20 offset:0
ds_read_b64_tr_b16 v[106:107], v20 offset:3072
ds_read_b128 v[96:99], v16 offset:0
ds_read_b128 v[100:103], v18 offset:0
ds_read_b64_tr_b16 v[108:109], v21 offset:0
ds_read_b64_tr_b16 v[110:111], v21 offset:3072
ds_read_b64_tr_b16 v[112:113], v22 offset:0
ds_read_b64_tr_b16 v[114:115], v22 offset:3072
ds_read_b64_tr_b16 v[116:117], v23 offset:0
ds_read_b64_tr_b16 v[118:119], v23 offset:3072
ds_read_b64_tr_b16 v[120:121], v24 offset:0
ds_read_b64_tr_b16 v[122:123], v24 offset:3072
ds_read_b64_tr_b16 v[124:125], v25 offset:0
ds_read_b64_tr_b16 v[126:127], v25 offset:3072
ds_read_b64_tr_b16 v[136:137], v20 offset:12288
s_add_u32 m0, s34, 32768
s_waitcnt lgkmcnt(12)
v_mfma_f32_16x16x32_bf16 v[36:39], v[104:107], v[96:99], 0
ds_read_b64_tr_b16 v[138:139], v20 offset:15360
buffer_load_dwordx4 v10, s[20:23], s48 offen  lds
v_mfma_f32_16x16x32_bf16 v[232:235], v[92:95], v[96:99], 0
ds_read_b128 v[128:131], v17 offset:0
ds_read_b128 v[132:135], v19 offset:0
s_add_u32 m0, s35, 32768
s_waitcnt lgkmcnt(14)
v_mfma_f32_16x16x32_bf16 v[60:63], v[104:107], v[100:103], 0
buffer_load_dwordx4 v11, s[20:23], s48 offen  lds
ds_read_b64_tr_b16 v[140:141], v21 offset:12288
v_mfma_f32_16x16x32_bf16 v[84:87], v[104:107], v[92:95], 0
ds_read_b64_tr_b16 v[142:143], v21 offset:15360
ds_read_b64_tr_b16 v[144:145], v22 offset:12288
s_add_u32 m0, s36, 49152
s_waitcnt lgkmcnt(15)
v_mfma_f32_16x16x32_bf16 v[40:43], v[108:111], v[96:99], 0
buffer_load_dwordx4 v12, s[24:27], s49 offen  lds
ds_read_b64_tr_b16 v[146:147], v22 offset:15360
v_mfma_f32_16x16x32_bf16 v[64:67], v[108:111], v[100:103], 0
ds_read_b64_tr_b16 v[148:149], v23 offset:12288
v_lshlrev_b32 v30, 16, v96
v_and_b32 v31, s87, v96
s_add_u32 m0, s37, 49152
v_mfma_f32_16x16x32_bf16 v[88:91], v[108:111], v[92:95], 0
buffer_load_dwordx4 v13, s[24:27], s49 offen  lds
v_fmac_f32 v27, v30, v30
v_fmac_f32 v27, v31, v31
s_waitcnt lgkmcnt(15)
v_mfma_f32_16x16x32_bf16 v[44:47], v[112:115], v[96:99], 0
ds_read_b64_tr_b16 v[150:151], v23 offset:15360
v_lshlrev_b32 v32, 16, v97
v_and_b32 v33, s87, v97
v_mfma_f32_16x16x32_bf16 v[68:71], v[112:115], v[100:103], 0
ds_read_b64_tr_b16 v[152:153], v24 offset:12288
v_fmac_f32 v27, v32, v32
v_fmac_f32 v27, v33, v33
s_waitcnt lgkmcnt(15)
v_mfma_f32_16x16x32_bf16 v[48:51], v[116:119], v[96:99], 0
ds_read_b64_tr_b16 v[154:155], v24 offset:15360
v_lshlrev_b32 v30, 16, v98
v_and_b32 v31, s87, v98
s_add_u32 m0, s38, 49152
v_mfma_f32_16x16x32_bf16 v[72:75], v[116:119], v[100:103], 0
buffer_load_dwordx4 v14, s[24:27], s49 offen  lds
s_add_u32 s55, s55, 1
s_cmp_eq_u32 s55, 10
s_cselect_b32 s55, 2, s55
s_lshl_b32 s48, s55, 7
s_mul_i32 s49, s55, 196608
v_fmac_f32 v27, v30, v30
v_fmac_f32 v27, v31, v31
s_waitcnt lgkmcnt(14)
v_mfma_f32_16x16x32_bf16 v[52:55], v[120:123], v[96:99], 0
ds_read_b64_tr_b16 v[156:157], v25 offset:12288
v_lshlrev_b32 v32, 16, v99
v_mfma_f32_16x16x32_bf16 v[76:79], v[120:123], v[100:103], 0
ds_read_b64_tr_b16 v[158:159], v25 offset:15360
v_and_b32 v33, s87, v99
s_waitcnt lgkmcnt(14)
v_mfma_f32_16x16x32_bf16 v[56:59], v[124:127], v[96:99], 0
v_fmac_f32 v27, v32, v32
v_mfma_f32_16x16x32_bf16 v[80:83], v[124:127], v[100:103], 0
v_fmac_f32 v27, v33, v33
s_waitcnt vmcnt(5)
s_barrier
s_add_u32 m0, s34, 0
s_waitcnt lgkmcnt(11)
v_mfma_f32_16x16x32_bf16 v[36:39], v[136:139], v[128:131], v[36:39]
ds_read_b64_tr_b16 v[104:105], v20 offset:24576
buffer_load_dwordx4 v10, s[20:23], s48 offen  lds
v_mfma_f32_16x16x32_bf16 v[232:235], v[92:95], v[128:131], v[232:235]
ds_read_b64_tr_b16 v[106:107], v20 offset:27648
ds_read_b128 v[96:99], v16 offset:16384
s_waitcnt lgkmcnt(13)
v_mfma_f32_16x16x32_bf16 v[60:63], v[136:139], v[132:135], v[60:63]
ds_read_b128 v[100:103], v18 offset:16384
ds_read_b64_tr_b16 v[108:109], v21 offset:24576
v_mfma_f32_16x16x32_bf16 v[84:87], v[136:139], v[92:95], v[84:87]
ds_read_b64_tr_b16 v[110:111], v21 offset:27648
v_lshlrev_b32 v30, 16, v128
v_and_b32 v31, s87, v128
s_waitcnt lgkmcnt(14)
v_mfma_f32_16x16x32_bf16 v[40:43], v[140:143], v[128:131], v[40:43]
ds_read_b64_tr_b16 v[112:113], v22 offset:24576
v_fmac_f32 v27, v30, v30
v_fmac_f32 v27, v31, v31
v_mfma_f32_16x16x32_bf16 v[64:67], v[140:143], v[132:135], v[64:67]
ds_read_b64_tr_b16 v[114:115], v22 offset:27648
v_lshlrev_b32 v32, 16, v129
v_and_b32 v33, s87, v129
s_add_u32 m0, s35, 0
v_mfma_f32_16x16x32_bf16 v[88:91], v[140:143], v[92:95], v[88:91]
buffer_load_dwordx4 v11, s[20:23], s48 offen  lds
v_fmac_f32 v27, v32, v32
v_fmac_f32 v27, v33, v33
s_waitcnt lgkmcnt(14)
v_mfma_f32_16x16x32_bf16 v[44:47], v[144:147], v[128:131], v[44:47]
ds_read_b64_tr_b16 v[116:117], v23 offset:24576
v_lshlrev_b32 v30, 16, v130
v_mfma_f32_16x16x32_bf16 v[68:71], v[144:147], v[132:135], v[68:71]
ds_read_b64_tr_b16 v[118:119], v23 offset:27648
v_and_b32 v31, s87, v130
s_waitcnt lgkmcnt(14)
v_mfma_f32_16x16x32_bf16 v[48:51], v[148:151], v[128:131], v[48:51]
ds_read_b64_tr_b16 v[120:121], v24 offset:24576
v_fmac_f32 v27, v30, v30
v_mfma_f32_16x16x32_bf16 v[72:75], v[148:151], v[132:135], v[72:75]
ds_read_b64_tr_b16 v[122:123], v24 offset:27648
v_fmac_f32 v27, v31, v31
s_waitcnt lgkmcnt(14)
v_mfma_f32_16x16x32_bf16 v[52:55], v[152:155], v[128:131], v[52:55]
ds_read_b64_tr_b16 v[124:125], v25 offset:24576
v_lshlrev_b32 v32, 16, v131
v_mfma_f32_16x16x32_bf16 v[76:79], v[152:155], v[132:135], v[76:79]
ds_read_b64_tr_b16 v[126:127], v25 offset:27648
v_and_b32 v33, s87, v131
s_waitcnt lgkmcnt(14)
v_mfma_f32_16x16x32_bf16 v[56:59], v[156:159], v[128:131], v[56:59]
v_fmac_f32 v27, v32, v32
v_mfma_f32_16x16x32_bf16 v[80:83], v[156:159], v[132:135], v[80:83]
v_fmac_f32 v27, v33, v33
ds_read_b64_tr_b16 v[136:137], v20 offset:36864
s_add_u32 m0, s36, 0
s_waitcnt lgkmcnt(12)
v_mfma_f32_16x16x32_bf16 v[36:39], v[104:107], v[96:99], v[36:39]
ds_read_b64_tr_b16 v[138:139], v20 offset:39936
buffer_load_dwordx4 v12, s[24:27], s49 offen  lds
v_mfma_f32_16x16x32_bf16 v[232:235], v[92:95], v[96:99], v[232:235]
ds_read_b128 v[128:131], v17 offset:16384
ds_read_b128 v[132:135], v19 offset:16384
s_waitcnt lgkmcnt(14)
v_mfma_f32_16x16x32_bf16 v[60:63], v[104:107], v[100:103], v[60:63]
ds_read_b64_tr_b16 v[140:141], v21 offset:36864
ds_read_b64_tr_b16 v[142:143], v21 offset:39936
s_add_u32 m0, s37, 0
v_mfma_f32_16x16x32_bf16 v[84:87], v[104:107], v[92:95], v[84:87]
buffer_load_dwordx4 v13, s[24:27], s49 offen  lds
v_lshlrev_b32 v30, 16, v96
v_and_b32 v31, s87, v96
s_waitcnt lgkmcnt(14)
v_mfma_f32_16x16x32_bf16 v[40:43], v[108:111], v[96:99], v[40:43]
ds_read_b64_tr_b16 v[144:145], v22 offset:36864
v_fmac_f32 v27, v30, v30
v_fmac_f32 v27, v31, v31
v_mfma_f32_16x16x32_bf16 v[64:67], v[108:111], v[100:103], v[64:67]
ds_read_b64_tr_b16 v[146:147], v22 offset:39936
v_lshlrev_b32 v32, 16, v97
v_and_b32 v33, s87, v97
v_mfma_f32_16x16x32_bf16 v[88:91], v[108:111], v[92:95], v[88:91]
ds_read_b64_tr_b16 v[148:149], v23 offset:36864
v_fmac_f32 v27, v32, v32
v_fmac_f32 v27, v33, v33
s_waitcnt lgkmcnt(15)
v_mfma_f32_16x16x32_bf16 v[44:47], v[112:115], v[96:99], v[44:47]
ds_read_b64_tr_b16 v[150:151], v23 offset:39936
v_lshlrev_b32 v30, 16, v98
s_add_u32 m0, s38, 0
v_mfma_f32_16x16x32_bf16 v[68:71], v[112:115], v[100:103], v[68:71]
buffer_load_dwordx4 v14, s[24:27], s49 offen  lds
s_add_u32 s55, s55, 1
s_cmp_eq_u32 s55, 10
s_cselect_b32 s55, 2, s55
s_lshl_b32 s48, s55, 7
s_mul_i32 s49, s55, 196608
v_and_b32 v31, s87, v98
s_waitcnt lgkmcnt(14)
v_mfma_f32_16x16x32_bf16 v[48:51], v[116:119], v[96:99], v[48:51]
ds_read_b64_tr_b16 v[152:153], v24 offset:36864
v_fmac_f32 v27, v30, v30
v_mfma_f32_16x16x32_bf16 v[72:75], v[116:119], v[100:103], v[72:75]
ds_read_b64_tr_b16 v[154:155], v24 offset:39936
v_fmac_f32 v27, v31, v31
s_waitcnt lgkmcnt(14)
v_mfma_f32_16x16x32_bf16 v[52:55], v[120:123], v[96:99], v[52:55]
ds_read_b64_tr_b16 v[156:157], v25 offset:36864
v_lshlrev_b32 v32, 16, v99
v_mfma_f32_16x16x32_bf16 v[76:79], v[120:123], v[100:103], v[76:79]
ds_read_b64_tr_b16 v[158:159], v25 offset:39936
v_and_b32 v33, s87, v99
s_waitcnt lgkmcnt(14)
v_mfma_f32_16x16x32_bf16 v[56:59], v[124:127], v[96:99], v[56:59]
v_fmac_f32 v27, v32, v32
v_mfma_f32_16x16x32_bf16 v[80:83], v[124:127], v[100:103], v[80:83]
v_fmac_f32 v27, v33, v33
s_waitcnt vmcnt(5)
s_barrier
s_add_u32 m0, s34, 16384
s_waitcnt lgkmcnt(11)
v_mfma_f32_16x16x32_bf16 v[36:39], v[136:139], v[128:131], v[36:39]
ds_read_b64_tr_b16 v[104:105], v20 offset:49152
buffer_load_dwordx4 v10, s[20:23], s48 offen  lds
v_mfma_f32_16x16x32_bf16 v[232:235], v[92:95], v[128:131], v[232:235]
ds_read_b64_tr_b16 v[106:107], v20 offset:52224
ds_read_b128 v[96:99], v16 offset:32768
s_waitcnt lgkmcnt(13)
v_mfma_f32_16x16x32_bf16 v[60:63], v[136:139], v[132:135], v[60:63]
ds_read_b128 v[100:103], v18 offset:32768
ds_read_b64_tr_b16 v[108:109], v21 offset:49152
v_mfma_f32_16x16x32_bf16 v[84:87], v[136:139], v[92:95], v[84:87]
ds_read_b64_tr_b16 v[110:111], v21 offset:52224
v_lshlrev_b32 v30, 16, v128
v_and_b32 v31, s87, v128
s_waitcnt lgkmcnt(14)
v_mfma_f32_16x16x32_bf16 v[40:43], v[140:143], v[128:131], v[40:43]
ds_read_b64_tr_b16 v[112:113], v22 offset:49152
v_fmac_f32 v27, v30, v30
v_fmac_f32 v27, v31, v31
v_mfma_f32_16x16x32_bf16 v[64:67], v[140:143], v[132:135], v[64:67]
ds_read_b64_tr_b16 v[114:115], v22 offset:52224
v_lshlrev_b32 v32, 16, v129
v_and_b32 v33, s87, v129
s_add_u32 m0, s35, 16384
v_mfma_f32_16x16x32_bf16 v[88:91], v[140:143], v[92:95], v[88:91]
buffer_load_dwordx4 v11, s[20:23], s48 offen  lds
v_fmac_f32 v27, v32, v32
v_fmac_f32 v27, v33, v33
s_waitcnt lgkmcnt(14)
v_mfma_f32_16x16x32_bf16 v[44:47], v[144:147], v[128:131], v[44:47]
ds_read_b64_tr_b16 v[116:117], v23 offset:49152
v_lshlrev_b32 v30, 16, v130
v_mfma_f32_16x16x32_bf16 v[68:71], v[144:147], v[132:135], v[68:71]
ds_read_b64_tr_b16 v[118:119], v23 offset:52224
v_and_b32 v31, s87, v130
s_waitcnt lgkmcnt(14)
v_mfma_f32_16x16x32_bf16 v[48:51], v[148:151], v[128:131], v[48:51]
ds_read_b64_tr_b16 v[120:121], v24 offset:49152
v_fmac_f32 v27, v30, v30
v_mfma_f32_16x16x32_bf16 v[72:75], v[148:151], v[132:135], v[72:75]
ds_read_b64_tr_b16 v[122:123], v24 offset:52224
v_fmac_f32 v27, v31, v31
s_waitcnt lgkmcnt(14)
v_mfma_f32_16x16x32_bf16 v[52:55], v[152:155], v[128:131], v[52:55]
ds_read_b64_tr_b16 v[124:125], v25 offset:49152
v_lshlrev_b32 v32, 16, v131
v_mfma_f32_16x16x32_bf16 v[76:79], v[152:155], v[132:135], v[76:79]
ds_read_b64_tr_b16 v[126:127], v25 offset:52224
v_and_b32 v33, s87, v131
s_waitcnt lgkmcnt(14)
v_mfma_f32_16x16x32_bf16 v[56:59], v[156:159], v[128:131], v[56:59]
v_fmac_f32 v27, v32, v32
v_mfma_f32_16x16x32_bf16 v[80:83], v[156:159], v[132:135], v[80:83]
v_fmac_f32 v27, v33, v33
ds_read_b64_tr_b16 v[136:137], v20 offset:61440
s_add_u32 m0, s36, 24576
s_waitcnt lgkmcnt(12)
v_mfma_f32_16x16x32_bf16 v[36:39], v[104:107], v[96:99], v[36:39]
ds_read_b64_tr_b16 v[138:139], v20 offset:64512
buffer_load_dwordx4 v12, s[24:27], s49 offen  lds
v_mfma_f32_16x16x32_bf16 v[232:235], v[92:95], v[96:99], v[232:235]
ds_read_b128 v[128:131], v17 offset:32768
ds_read_b128 v[132:135], v19 offset:32768
s_waitcnt lgkmcnt(14)
v_mfma_f32_16x16x32_bf16 v[60:63], v[104:107], v[100:103], v[60:63]
ds_read_b64_tr_b16 v[140:141], v21 offset:61440
ds_read_b64_tr_b16 v[142:143], v21 offset:64512
s_add_u32 m0, s37, 24576
v_mfma_f32_16x16x32_bf16 v[84:87], v[104:107], v[92:95], v[84:87]
buffer_load_dwordx4 v13, s[24:27], s49 offen  lds
v_lshlrev_b32 v30, 16, v96
v_and_b32 v31, s87, v96
s_waitcnt lgkmcnt(14)
v_mfma_f32_16x16x32_bf16 v[40:43], v[108:111], v[96:99], v[40:43]
ds_read_b64_tr_b16 v[144:145], v22 offset:61440
v_fmac_f32 v27, v30, v30
v_fmac_f32 v27, v31, v31
v_mfma_f32_16x16x32_bf16 v[64:67], v[108:111], v[100:103], v[64:67]
ds_read_b64_tr_b16 v[146:147], v22 offset:64512
v_lshlrev_b32 v32, 16, v97
v_and_b32 v33, s87, v97
v_mfma_f32_16x16x32_bf16 v[88:91], v[108:111], v[92:95], v[88:91]
ds_read_b64_tr_b16 v[148:149], v23 offset:61440
v_fmac_f32 v27, v32, v32
v_fmac_f32 v27, v33, v33
s_waitcnt lgkmcnt(15)
v_mfma_f32_16x16x32_bf16 v[44:47], v[112:115], v[96:99], v[44:47]
ds_read_b64_tr_b16 v[150:151], v23 offset:64512
v_lshlrev_b32 v30, 16, v98
s_add_u32 m0, s38, 24576
v_mfma_f32_16x16x32_bf16 v[68:71], v[112:115], v[100:103], v[68:71]
buffer_load_dwordx4 v14, s[24:27], s49 offen  lds
s_add_u32 s55, s55, 1
s_cmp_eq_u32 s55, 10
s_cselect_b32 s55, 2, s55
s_lshl_b32 s48, s55, 7
s_mul_i32 s49, s55, 196608
v_and_b32 v31, s87, v98
s_waitcnt lgkmcnt(14)
v_mfma_f32_16x16x32_bf16 v[48:51], v[116:119], v[96:99], v[48:51]
ds_read_b64_tr_b16 v[152:153], v24 offset:61440
v_fmac_f32 v27, v30, v30
v_mfma_f32_16x16x32_bf16 v[72:75], v[116:119], v[100:103], v[72:75]
ds_read_b64_tr_b16 v[154:155], v24 offset:64512
v_fmac_f32 v27, v31, v31
s_waitcnt lgkmcnt(14)
v_mfma_f32_16x16x32_bf16 v[52:55], v[120:123], v[96:99], v[52:55]
ds_read_b64_tr_b16 v[156:157], v25 offset:61440
v_lshlrev_b32 v32, 16, v99
v_mfma_f32_16x16x32_bf16 v[76:79], v[120:123], v[100:103], v[76:79]
ds_read_b64_tr_b16 v[158:159], v25 offset:64512
v_and_b32 v33, s87, v99
s_waitcnt lgkmcnt(14)
v_mfma_f32_16x16x32_bf16 v[56:59], v[124:127], v[96:99], v[56:59]
v_fmac_f32 v27, v32, v32
v_mfma_f32_16x16x32_bf16 v[80:83], v[124:127], v[100:103], v[80:83]
v_fmac_f32 v27, v33, v33
s_waitcnt vmcnt(5)
s_barrier
s_add_u32 m0, s34, 32768
s_waitcnt lgkmcnt(11)
v_mfma_f32_16x16x32_bf16 v[36:39], v[136:139], v[128:131], v[36:39]
ds_read_b64_tr_b16 v[104:105], v20 offset:0
buffer_load_dwordx4 v10, s[20:23], s48 offen  lds
v_mfma_f32_16x16x32_bf16 v[232:235], v[92:95], v[128:131], v[232:235]
ds_read_b64_tr_b16 v[106:107], v20 offset:3072
ds_read_b128 v[96:99], v16 offset:0
s_add_u32 m0, s35, 32768
s_waitcnt lgkmcnt(13)
v_mfma_f32_16x16x32_bf16 v[60:63], v[136:139], v[132:135], v[60:63]
buffer_load_dwordx4 v11, s[20:23], s48 offen  lds
ds_read_b128 v[100:103], v18 offset:0
s_add_u32 s28, s14, 0
s_lshl_b32 s33, s28, 10
s_add_u32 m0, s33, 122880
v_mfma_f32_16x16x32_bf16 v[84:87], v[136:139], v[92:95], v[84:87]
ds_read_b64_tr_b16 v[108:109], v21 offset:0
s_mov_b64 exec, s[100:101]
buffer_load_dwordx4 v174, s[40:43], 0 offen lds
s_mov_b64 exec, -1
s_waitcnt lgkmcnt(13)
s_nop 0
v_mfma_f32_16x16x32_bf16 v[40:43], v[140:143], v[128:131], v[40:43]
ds_read_b64_tr_b16 v[110:111], v21 offset:3072
ds_read_b64_tr_b16 v[112:113], v22 offset:0
s_add_u32 s28, s14, 8
s_lshl_b32 s33, s28, 10
s_add_u32 m0, s33, 122880
v_mfma_f32_16x16x32_bf16 v[64:67], v[140:143], v[132:135], v[64:67]
s_mov_b64 exec, s[100:101]
buffer_load_dwordx4 v175, s[40:43], 0 offen lds
s_mov_b64 exec, -1
ds_read_b64_tr_b16 v[114:115], v22 offset:3072
s_add_u32 s28, s14, 16
s_lshl_b32 s33, s28, 10
s_add_u32 m0, s33, 122880
v_mfma_f32_16x16x32_bf16 v[88:91], v[140:143], v[92:95], v[88:91]
ds_read_b64_tr_b16 v[116:117], v23 offset:0
s_mov_b64 exec, s[100:101]
buffer_load_dwordx4 v176, s[40:43], 0 offen lds
s_mov_b64 exec, -1
s_waitcnt lgkmcnt(15)
s_nop 0
v_mfma_f32_16x16x32_bf16 v[44:47], v[144:147], v[128:131], v[44:47]
ds_read_b64_tr_b16 v[118:119], v23 offset:3072
ds_read_b64_tr_b16 v[120:121], v24 offset:0
s_add_u32 s28, s14, 24
s_lshl_b32 s33, s28, 10
s_add_u32 m0, s33, 122880
v_mfma_f32_16x16x32_bf16 v[68:71], v[144:147], v[132:135], v[68:71]
s_mov_b64 exec, s[100:101]
buffer_load_dwordx4 v177, s[40:43], 0 offen lds
s_mov_b64 exec, -1
v_lshlrev_b32 v30, 16, v128
v_and_b32 v31, s87, v128
s_waitcnt lgkmcnt(15)
v_mfma_f32_16x16x32_bf16 v[48:51], v[148:151], v[128:131], v[48:51]
ds_read_b64_tr_b16 v[122:123], v24 offset:3072
v_fmac_f32 v27, v30, v30
v_fmac_f32 v27, v31, v31
v_mfma_f32_16x16x32_bf16 v[72:75], v[148:151], v[132:135], v[72:75]
ds_read_b64_tr_b16 v[124:125], v25 offset:0
v_lshlrev_b32 v32, 16, v129
v_and_b32 v33, s87, v129
s_add_u32 s28, s14, 32
s_lshl_b32 s33, s28, 10
s_add_u32 m0, s33, 122880
s_waitcnt lgkmcnt(15)
v_mfma_f32_16x16x32_bf16 v[52:55], v[152:155], v[128:131], v[52:55]
s_mov_b64 exec, s[100:101]
buffer_load_dwordx4 v178, s[40:43], 0 offen lds
s_mov_b64 exec, -1
v_fmac_f32 v27, v32, v32
v_fmac_f32 v27, v33, v33
v_mfma_f32_16x16x32_bf16 v[76:79], v[152:155], v[132:135], v[76:79]
ds_read_b64_tr_b16 v[126:127], v25 offset:3072
v_lshlrev_b32 v30, 16, v130
v_and_b32 v31, s87, v130
s_waitcnt lgkmcnt(14)
v_mfma_f32_16x16x32_bf16 v[56:59], v[156:159], v[128:131], v[56:59]
v_fmac_f32 v27, v30, v30
v_fmac_f32 v27, v31, v31
v_lshlrev_b32 v32, 16, v131
v_mfma_f32_16x16x32_bf16 v[80:83], v[156:159], v[132:135], v[80:83]
v_and_b32 v33, s87, v131
v_fmac_f32 v27, v32, v32
v_fmac_f32 v27, v33, v33
ds_read_b64_tr_b16 v[136:137], v20 offset:12288
s_add_u32 m0, s36, 49152
s_waitcnt lgkmcnt(12)
v_mfma_f32_16x16x32_bf16 v[36:39], v[104:107], v[96:99], v[36:39]
ds_read_b64_tr_b16 v[138:139], v20 offset:15360
buffer_load_dwordx4 v12, s[24:27], s49 offen  lds
v_mfma_f32_16x16x32_bf16 v[232:235], v[92:95], v[96:99], v[232:235]
ds_read_b128 v[128:131], v17 offset:0
ds_read_b128 v[132:135], v19 offset:0
s_waitcnt lgkmcnt(14)
v_mfma_f32_16x16x32_bf16 v[60:63], v[104:107], v[100:103], v[60:63]
ds_read_b64_tr_b16 v[140:141], v21 offset:12288
ds_read_b64_tr_b16 v[142:143], v21 offset:15360
s_add_u32 m0, s37, 49152
v_mfma_f32_16x16x32_bf16 v[84:87], v[104:107], v[92:95], v[84:87]
buffer_load_dwordx4 v13, s[24:27], s49 offen  lds
v_lshlrev_b32 v30, 16, v96
v_and_b32 v31, s87, v96
s_waitcnt lgkmcnt(14)
v_mfma_f32_16x16x32_bf16 v[40:43], v[108:111], v[96:99], v[40:43]
ds_read_b64_tr_b16 v[144:145], v22 offset:12288
v_fmac_f32 v27, v30, v30
v_fmac_f32 v27, v31, v31
v_mfma_f32_16x16x32_bf16 v[64:67], v[108:111], v[100:103], v[64:67]
ds_read_b64_tr_b16 v[146:147], v22 offset:15360
v_lshlrev_b32 v32, 16, v97
v_and_b32 v33, s87, v97
v_mfma_f32_16x16x32_bf16 v[88:91], v[108:111], v[92:95], v[88:91]
ds_read_b64_tr_b16 v[148:149], v23 offset:12288
v_fmac_f32 v27, v32, v32
v_fmac_f32 v27, v33, v33
s_waitcnt lgkmcnt(15)
v_mfma_f32_16x16x32_bf16 v[44:47], v[112:115], v[96:99], v[44:47]
ds_read_b64_tr_b16 v[150:151], v23 offset:15360
v_lshlrev_b32 v30, 16, v98
s_add_u32 m0, s38, 49152
v_mfma_f32_16x16x32_bf16 v[68:71], v[112:115], v[100:103], v[68:71]
buffer_load_dwordx4 v14, s[24:27], s49 offen  lds
s_add_u32 s55, s55, 1
s_cmp_eq_u32 s55, 10
s_cselect_b32 s55, 2, s55
s_lshl_b32 s48, s55, 7
s_mul_i32 s49, s55, 196608
v_and_b32 v31, s87, v98
s_waitcnt lgkmcnt(14)
v_mfma_f32_16x16x32_bf16 v[48:51], v[116:119], v[96:99], v[48:51]
ds_read_b64_tr_b16 v[152:153], v24 offset:12288
v_fmac_f32 v27, v30, v30
v_mfma_f32_16x16x32_bf16 v[72:75], v[116:119], v[100:103], v[72:75]
ds_read_b64_tr_b16 v[154:155], v24 offset:15360
v_fmac_f32 v27, v31, v31
s_waitcnt lgkmcnt(14)
v_mfma_f32_16x16x32_bf16 v[52:55], v[120:123], v[96:99], v[52:55]
ds_read_b64_tr_b16 v[156:157], v25 offset:12288
v_lshlrev_b32 v32, 16, v99
v_mfma_f32_16x16x32_bf16 v[76:79], v[120:123], v[100:103], v[76:79]
ds_read_b64_tr_b16 v[158:159], v25 offset:15360
v_and_b32 v33, s87, v99
s_waitcnt lgkmcnt(14)
v_mfma_f32_16x16x32_bf16 v[56:59], v[124:127], v[96:99], v[56:59]
v_fmac_f32 v27, v32, v32
v_mfma_f32_16x16x32_bf16 v[80:83], v[124:127], v[100:103], v[80:83]
v_fmac_f32 v27, v33, v33
s_waitcnt vmcnt(10)
s_barrier
s_add_u32 m0, s34, 0
s_waitcnt lgkmcnt(11)
v_mfma_f32_16x16x32_bf16 v[36:39], v[136:139], v[128:131], v[36:39]
ds_read_b64_tr_b16 v[104:105], v20 offset:24576
buffer_load_dwordx4 v10, s[20:23], s48 offen  lds
s_cmp_eq_u32 s14, 0
s_cbranch_scc0 nl18
s_mov_b32 s28, s84
s_and_b32 s29, s85, 0xffff
s_mov_b32 s30, 256
s_mov_b32 s31, 0x20000
v_mov_b32 v255, 0
buffer_load_dword v252, v255, s[28:31], 0 offen sc1
nl18:
v_mfma_f32_16x16x32_bf16 v[232:235], v[92:95], v[128:131], v[232:235]
ds_read_b64_tr_b16 v[106:107], v20 offset:27648
ds_read_b128 v[96:99], v16 offset:16384
s_waitcnt lgkmcnt(13)
v_mfma_f32_16x16x32_bf16 v[60:63], v[136:139], v[132:135], v[60:63]
ds_read_b128 v[100:103], v18 offset:16384
ds_read_b64_tr_b16 v[108:109], v21 offset:24576
v_mfma_f32_16x16x32_bf16 v[84:87], v[136:139], v[92:95], v[84:87]
ds_read_b64_tr_b16 v[110:111], v21 offset:27648
v_lshlrev_b32 v30, 16, v128
v_and_b32 v31, s87, v128
s_waitcnt lgkmcnt(14)
v_mfma_f32_16x16x32_bf16 v[40:43], v[140:143], v[128:131], v[40:43]
ds_read_b64_tr_b16 v[112:113], v22 offset:24576
v_fmac_f32 v27, v30, v30
v_fmac_f32 v27, v31, v31
v_mfma_f32_16x16x32_bf16 v[64:67], v[140:143], v[132:135], v[64:67]
ds_read_b64_tr_b16 v[114:115], v22 offset:27648
v_lshlrev_b32 v32, 16, v129
v_and_b32 v33, s87, v129
s_add_u32 m0, s35, 0
v_mfma_f32_16x16x32_bf16 v[88:91], v[140:143], v[92:95], v[88:91]
buffer_load_dwordx4 v11, s[20:23], s48 offen  lds
v_fmac_f32 v27, v32, v32
v_fmac_f32 v27, v33, v33
s_waitcnt lgkmcnt(14)
v_mfma_f32_16x16x32_bf16 v[44:47], v[144:147], v[128:131], v[44:47]
ds_read_b64_tr_b16 v[116:117], v23 offset:24576
v_lshlrev_b32 v30, 16, v130
v_mfma_f32_16x16x32_bf16 v[68:71], v[144:147], v[132:135], v[68:71]
ds_read_b64_tr_b16 v[118:119], v23 offset:27648
v_and_b32 v31, s87, v130
s_waitcnt lgkmcnt(14)
v_mfma_f32_16x16x32_bf16 v[48:51], v[148:151], v[128:131], v[48:51]
ds_read_b64_tr_b16 v[120:121], v24 offset:24576
v_fmac_f32 v27, v30, v30
v_mfma_f32_16x16x32_bf16 v[72:75], v[148:151], v[132:135], v[72:75]
ds_read_b64_tr_b16 v[122:123], v24 offset:27648
v_fmac_f32 v27, v31, v31
s_waitcnt lgkmcnt(14)
v_mfma_f32_16x16x32_bf16 v[52:55], v[152:155], v[128:131], v[52:55]
ds_read_b64_tr_b16 v[124:125], v25 offset:24576
v_lshlrev_b32 v32, 16, v131
v_mfma_f32_16x16x32_bf16 v[76:79], v[152:155], v[132:135], v[76:79]
ds_read_b64_tr_b16 v[126:127], v25 offset:27648
v_and_b32 v33, s87, v131
s_waitcnt lgkmcnt(14)
v_mfma_f32_16x16x32_bf16 v[56:59], v[156:159], v[128:131], v[56:59]
v_fmac_f32 v27, v32, v32
v_mfma_f32_16x16x32_bf16 v[80:83], v[156:159], v[132:135], v[80:83]
v_fmac_f32 v27, v33, v33
ds_read_b64_tr_b16 v[136:137], v20 offset:36864
s_add_u32 m0, s36, 0
s_waitcnt lgkmcnt(12)
v_mfma_f32_16x16x32_bf16 v[36:39], v[104:107], v[96:99], v[36:39]
ds_read_b64_tr_b16 v[138:139], v20 offset:39936
buffer_load_dwordx4 v12, s[24:27], s49 offen  lds
v_mfma_f32_16x16x32_bf16 v[232:235], v[92:95], v[96:99], v[232:235]
ds_read_b128 v[128:131], v17 offset:16384
ds_read_b128 v[132:135], v19 offset:16384
s_waitcnt lgkmcnt(14)
v_mfma_f32_16x16x32_bf16 v[60:63], v[104:107], v[100:103], v[60:63]
ds_read_b64_tr_b16 v[140:141], v21 offset:36864
ds_read_b64_tr_b16 v[142:143], v21 offset:39936
s_add_u32 m0, s37, 0
v_mfma_f32_16x16x32_bf16 v[84:87], v[104:107], v[92:95], v[84:87]
buffer_load_dwordx4 v13, s[24:27], s49 offen  lds
v_lshlrev_b32 v30, 16, v96
v_and_b32 v31, s87, v96
s_waitcnt lgkmcnt(14)
v_mfma_f32_16x16x32_bf16 v[40:43], v[108:111], v[96:99], v[40:43]
ds_read_b64_tr_b16 v[144:145], v22 offset:36864
v_fmac_f32 v27, v30, v30
v_fmac_f32 v27, v31, v31
v_mfma_f32_16x16x32_bf16 v[64:67], v[108:111], v[100:103], v[64:67]
ds_read_b64_tr_b16 v[146:147], v22 offset:39936
v_lshlrev_b32 v32, 16, v97
v_and_b32 v33, s87, v97
v_mfma_f32_16x16x32_bf16 v[88:91], v[108:111], v[92:95], v[88:91]
ds_read_b64_tr_b16 v[148:149], v23 offset:36864
v_fmac_f32 v27, v32, v32
v_fmac_f32 v27, v33, v33
s_waitcnt lgkmcnt(15)
v_mfma_f32_16x16x32_bf16 v[44:47], v[112:115], v[96:99], v[44:47]
ds_read_b64_tr_b16 v[150:151], v23 offset:39936
v_lshlrev_b32 v30, 16, v98
s_add_u32 m0, s38, 0
v_mfma_f32_16x16x32_bf16 v[68:71], v[112:115], v[100:103], v[68:71]
buffer_load_dwordx4 v14, s[24:27], s49 offen  lds
s_add_u32 s55, s55, 1
s_cmp_eq_u32 s55, 10
s_cselect_b32 s55, 2, s55
s_lshl_b32 s48, s55, 7
s_mul_i32 s49, s55, 196608
v_and_b32 v31, s87, v98
s_waitcnt lgkmcnt(14)
v_mfma_f32_16x16x32_bf16 v[48:51], v[116:119], v[96:99], v[48:51]
ds_read_b64_tr_b16 v[152:153], v24 offset:36864
v_fmac_f32 v27, v30, v30
v_mfma_f32_16x16x32_bf16 v[72:75], v[116:119], v[100:103], v[72:75]
ds_read_b64_tr_b16 v[154:155], v24 offset:39936
v_fmac_f32 v27, v31, v31
s_waitcnt lgkmcnt(14)
v_mfma_f32_16x16x32_bf16 v[52:55], v[120:123], v[96:99], v[52:55]
ds_read_b64_tr_b16 v[156:157], v25 offset:36864
v_lshlrev_b32 v32, 16, v99
v_mfma_f32_16x16x32_bf16 v[76:79], v[120:123], v[100:103], v[76:79]
ds_read_b64_tr_b16 v[158:159], v25 offset:39936
v_and_b32 v33, s87, v99
s_waitcnt lgkmcnt(14)
v_mfma_f32_16x16x32_bf16 v[56:59], v[124:127], v[96:99], v[56:59]
v_fmac_f32 v27, v32, v32
v_mfma_f32_16x16x32_bf16 v[80:83], v[124:127], v[100:103], v[80:83]
v_fmac_f32 v27, v33, v33
s_waitcnt vmcnt(5)
s_barrier
s_add_u32 m0, s34, 16384
s_waitcnt lgkmcnt(11)
v_mfma_f32_16x16x32_bf16 v[36:39], v[136:139], v[128:131], v[36:39]
ds_read_b64_tr_b16 v[104:105], v20 offset:49152
buffer_load_dwordx4 v10, s[20:23], s48 offen  lds
v_mfma_f32_16x16x32_bf16 v[232:235], v[92:95], v[128:131], v[232:235]
ds_read_b64_tr_b16 v[106:107], v20 offset:52224
ds_read_b128 v[96:99], v16 offset:32768
s_waitcnt lgkmcnt(13)
v_mfma_f32_16x16x32_bf16 v[60:63], v[136:139], v[132:135], v[60:63]
ds_read_b128 v[100:103], v18 offset:32768
ds_read_b64_tr_b16 v[108:109], v21 offset:49152
v_mfma_f32_16x16x32_bf16 v[84:87], v[136:139], v[92:95], v[84:87]
ds_read_b64_tr_b16 v[110:111], v21 offset:52224
ds_read_b64_tr_b16 v[112:113], v22 offset:49152
v_lshlrev_b32 v30, 16, v128
s_waitcnt lgkmcnt(15)
v_mfma_f32_16x16x32_bf16 v[40:43], v[140:143], v[128:131], v[40:43]
ds_read_b64_tr_b16 v[114:115], v22 offset:52224
ds_read_b64_tr_b16 v[116:117], v23 offset:49152
v_and_b32 v31, s87, v128
v_mfma_f32_16x16x32_bf16 v[64:67], v[140:143], v[132:135], v[64:67]
ds_read_b64_tr_b16 v[118:119], v23 offset:52224
ds_read_b64_tr_b16 v[120:121], v24 offset:49152
v_fmac_f32 v27, v30, v30
v_mfma_f32_16x16x32_bf16 v[88:91], v[140:143], v[92:95], v[88:91]
ds_read_b64_tr_b16 v[122:123], v24 offset:52224
ds_read_b64_tr_b16 v[124:125], v25 offset:49152
v_fmac_f32 v27, v31, v31
s_add_u32 m0, s35, 16384
s_waitcnt lgkmcnt(15)
v_mfma_f32_16x16x32_bf16 v[44:47], v[144:147], v[128:131], v[44:47]
buffer_load_dwordx4 v11, s[20:23], s48 offen  lds
ds_read_b64_tr_b16 v[126:127], v25 offset:52224
v_lshlrev_b32 v32, 16, v129
v_mfma_f32_16x16x32_bf16 v[68:71], v[144:147], v[132:135], v[68:71]
ds_read_b64_tr_b16 v[180:181], v172 offset:0
ds_read_b64_tr_b16 v[182:183], v172 offset:20480
v_and_b32 v33, s87, v129
s_waitcnt lgkmcnt(15)
v_mfma_f32_16x16x32_bf16 v[48:51], v[148:151], v[128:131], v[48:51]
ds_read_b64_tr_b16 v[184:185], v172 offset:8
ds_read_b64_tr_b16 v[186:187], v172 offset:20488
v_fmac_f32 v27, v32, v32
v_mfma_f32_16x16x32_bf16 v[72:75], v[148:151], v[132:135], v[72:75]
ds_read_b64_tr_b16 v[188:189], v172 offset:64
ds_read_b64_tr_b16 v[190:191], v172 offset:20544
v_fmac_f32 v27, v33, v33
s_waitcnt lgkmcnt(15)
v_mfma_f32_16x16x32_bf16 v[52:55], v[152:155], v[128:131], v[52:55]
ds_read_b64_tr_b16 v[192:193], v172 offset:72
ds_read_b64_tr_b16 v[194:195], v172 offset:20552
v_lshlrev_b32 v30, 16, v130
v_mfma_f32_16x16x32_bf16 v[76:79], v[152:155], v[132:135], v[76:79]
ds_read_b64_tr_b16 v[196:197], v173 offset:128
ds_read_b64_tr_b16 v[198:199], v173 offset:20608
v_and_b32 v31, s87, v130
s_waitcnt lgkmcnt(15)
v_mfma_f32_16x16x32_bf16 v[56:59], v[156:159], v[128:131], v[56:59]
v_fmac_f32 v27, v30, v30
v_fmac_f32 v27, v31, v31
v_lshlrev_b32 v32, 16, v131
v_mfma_f32_16x16x32_bf16 v[80:83], v[156:159], v[132:135], v[80:83]
v_and_b32 v33, s87, v131
v_fmac_f32 v27, v32, v32
v_fmac_f32 v27, v33, v33
ds_read_b64_tr_b16 v[136:137], v20 offset:61440
s_add_u32 m0, s36, 24576
s_waitcnt lgkmcnt(15)
v_mfma_f32_16x16x32_bf16 v[36:39], v[104:107], v[96:99], v[36:39]
ds_read_b64_tr_b16 v[138:139], v20 offset:64512
buffer_load_dwordx4 v12, s[24:27], s49 offen  lds
s_add_u32 s28, s69, 0
s_mov_b64 exec, s[100:101]
s_waitcnt lgkmcnt(10)
buffer_store_dwordx4 v[180:183], v171, s[44:47], s28 offen sc1
s_mov_b64 exec, -1
s_nop 1
v_mfma_f32_16x16x32_bf16 v[232:235], v[92:95], v[96:99], v[232:235]
ds_read_b128 v[128:131], v17 offset:32768
ds_read_b128 v[132:135], v19 offset:32768
v_mfma_f32_16x16x32_bf16 v[60:63], v[104:107], v[100:103], v[60:63]
ds_read_b64_tr_b16 v[140:141], v21 offset:61440
ds_read_b64_tr_b16 v[142:143], v21 offset:64512
s_add_u32 m0, s37, 24576
v_mfma_f32_16x16x32_bf16 v[84:87], v[104:107], v[92:95], v[84:87]
buffer_load_dwordx4 v13, s[24:27], s49 offen  lds
v_lshlrev_b32 v30, 16, v96
v_and_b32 v31, s87, v96
v_mfma_f32_16x16x32_bf16 v[40:43], v[108:111], v[96:99], v[40:43]
ds_read_b64_tr_b16 v[144:145], v22 offset:61440
v_fmac_f32 v27, v30, v30
v_fmac_f32 v27, v31, v31
v_mfma_f32_16x16x32_bf16 v[64:67], v[108:111], v[100:103], v[64:67]
ds_read_b64_tr_b16 v[146:147], v22 offset:64512
v_lshlrev_b32 v32, 16, v97
v_and_b32 v33, s87, v97
s_add_u32 s28, s69, 1024
s_mov_b64 exec, s[100:101]
s_waitcnt lgkmcnt(14)
buffer_store_dwordx4 v[184:187], v171, s[44:47], s28 offen sc1
s_mov_b64 exec, -1
s_nop 1
v_mfma_f32_16x16x32_bf16 v[88:91], v[108:111], v[92:95], v[88:91]
ds_read_b64_tr_b16 v[148:149], v23 offset:61440
v_fmac_f32 v27, v32, v32
v_fmac_f32 v27, v33, v33
v_mfma_f32_16x16x32_bf16 v[44:47], v[112:115], v[96:99], v[44:47]
ds_read_b64_tr_b16 v[150:151], v23 offset:64512
v_lshlrev_b32 v30, 16, v98
s_add_u32 m0, s38, 24576
v_mfma_f32_16x16x32_bf16 v[68:71], v[112:115], v[100:103], v[68:71]
buffer_load_dwordx4 v14, s[24:27], s49 offen  lds
s_add_u32 s55, s55, 1
s_cmp_eq_u32 s55, 10
s_cselect_b32 s55, 2, s55
s_lshl_b32 s48, s55, 7
s_mul_i32 s49, s55, 196608
v_and_b32 v31, s87, v98
v_mfma_f32_16x16x32_bf16 v[48:51], v[116:119], v[96:99], v[48:51]
ds_read_b64_tr_b16 v[152:153], v24 offset:61440
v_fmac_f32 v27, v30, v30
v_mfma_f32_16x16x32_bf16 v[72:75], v[116:119], v[100:103], v[72:75]
ds_read_b64_tr_b16 v[154:155], v24 offset:64512
v_fmac_f32 v27, v31, v31
s_add_u32 s28, s69, 2048
s_mov_b64 exec, s[100:101]
s_waitcnt lgkmcnt(15)
buffer_store_dwordx4 v[188:191], v171, s[44:47], s28 offen sc1
s_mov_b64 exec, -1
s_nop 1
v_mfma_f32_16x16x32_bf16 v[52:55], v[120:123], v[96:99], v[52:55]
ds_read_b64_tr_b16 v[156:157], v25 offset:61440
v_lshlrev_b32 v32, 16, v99
v_mfma_f32_16x16x32_bf16 v[76:79], v[120:123], v[100:103], v[76:79]
ds_read_b64_tr_b16 v[158:159], v25 offset:64512
v_and_b32 v33, s87, v99
v_mfma_f32_16x16x32_bf16 v[56:59], v[124:127], v[96:99], v[56:59]
v_fmac_f32 v27, v32, v32
v_mfma_f32_16x16x32_bf16 v[80:83], v[124:127], v[100:103], v[80:83]
v_fmac_f32 v27, v33, v33
s_waitcnt vmcnt(8)
s_barrier
s_add_u32 m0, s34, 32768
s_waitcnt lgkmcnt(11)
v_mfma_f32_16x16x32_bf16 v[36:39], v[136:139], v[128:131], v[36:39]
ds_read_b64_tr_b16 v[104:105], v20 offset:0
buffer_load_dwordx4 v10, s[20:23], s48 offen  lds
s_add_u32 s28, s69, 3072
s_mov_b64 exec, s[100:101]
buffer_store_dwordx4 v[192:195], v171, s[44:47], s28 offen sc1
s_mov_b64 exec, -1
s_nop 1
v_mfma_f32_16x16x32_bf16 v[232:235], v[92:95], v[128:131], v[232:235]
ds_read_b64_tr_b16 v[106:107], v20 offset:3072
ds_read_b128 v[96:99], v16 offset:0
s_waitcnt lgkmcnt(13)
v_mfma_f32_16x16x32_bf16 v[60:63], v[136:139], v[132:135], v[60:63]
ds_read_b128 v[100:103], v18 offset:0
ds_read_b64_tr_b16 v[108:109], v21 offset:0
v_mfma_f32_16x16x32_bf16 v[84:87], v[136:139], v[92:95], v[84:87]
ds_read_b64_tr_b16 v[110:111], v21 offset:3072
v_lshlrev_b32 v30, 16, v128
v_and_b32 v31, s87, v128
s_waitcnt lgkmcnt(14)
v_mfma_f32_16x16x32_bf16 v[40:43], v[140:143], v[128:131], v[40:43]
ds_read_b64_tr_b16 v[112:113], v22 offset:0
v_fmac_f32 v27, v30, v30
v_fmac_f32 v27, v31, v31
v_mfma_f32_16x16x32_bf16 v[64:67], v[140:143], v[132:135], v[64:67]
ds_read_b64_tr_b16 v[114:115], v22 offset:3072
v_lshlrev_b32 v32, 16, v129
v_and_b32 v33, s87, v129
s_add_u32 m0, s35, 32768
v_mfma_f32_16x16x32_bf16 v[88:91], v[140:143], v[92:95], v[88:91]
buffer_load_dwordx4 v11, s[20:23], s48 offen  lds
v_fmac_f32 v27, v32, v32
v_fmac_f32 v27, v33, v33
s_waitcnt lgkmcnt(14)
v_mfma_f32_16x16x32_bf16 v[44:47], v[144:147], v[128:131], v[44:47]
ds_read_b64_tr_b16 v[116:117], v23 offset:0
v_lshlrev_b32 v30, 16, v130
s_add_u32 s28, s69, 4096
s_mov_b64 exec, s[100:101]
buffer_store_dwordx4 v[196:199], v171, s[44:47], s28 offen sc1
s_mov_b64 exec, -1
s_nop 1
v_mfma_f32_16x16x32_bf16 v[68:71], v[144:147], v[132:135], v[68:71]
ds_read_b64_tr_b16 v[118:119], v23 offset:3072
v_and_b32 v31, s87, v130
s_waitcnt lgkmcnt(14)
v_mfma_f32_16x16x32_bf16 v[48:51], v[148:151], v[128:131], v[48:51]
ds_read_b64_tr_b16 v[120:121], v24 offset:0
v_fmac_f32 v27, v30, v30
v_mfma_f32_16x16x32_bf16 v[72:75], v[148:151], v[132:135], v[72:75]
ds_read_b64_tr_b16 v[122:123], v24 offset:3072
v_fmac_f32 v27, v31, v31
s_waitcnt lgkmcnt(14)
v_mfma_f32_16x16x32_bf16 v[52:55], v[152:155], v[128:131], v[52:55]
ds_read_b64_tr_b16 v[124:125], v25 offset:0
v_lshlrev_b32 v32, 16, v131
v_mfma_f32_16x16x32_bf16 v[76:79], v[152:155], v[132:135], v[76:79]
ds_read_b64_tr_b16 v[126:127], v25 offset:3072
v_and_b32 v33, s87, v131
s_waitcnt lgkmcnt(14)
v_mfma_f32_16x16x32_bf16 v[56:59], v[156:159], v[128:131], v[56:59]
v_fmac_f32 v27, v32, v32
v_mfma_f32_16x16x32_bf16 v[80:83], v[156:159], v[132:135], v[80:83]
v_fmac_f32 v27, v33, v33
ds_read_b64_tr_b16 v[136:137], v20 offset:12288
s_add_u32 m0, s36, 49152
s_waitcnt lgkmcnt(12)
v_mfma_f32_16x16x32_bf16 v[36:39], v[104:107], v[96:99], v[36:39]
ds_read_b64_tr_b16 v[138:139], v20 offset:15360
buffer_load_dwordx4 v12, s[24:27], s49 offen  lds
v_mfma_f32_16x16x32_bf16 v[232:235], v[92:95], v[96:99], v[232:235]
ds_read_b128 v[128:131], v17 offset:0
ds_read_b128 v[132:135], v19 offset:0
s_waitcnt lgkmcnt(14)
v_mfma_f32_16x16x32_bf16 v[60:63], v[104:107], v[100:103], v[60:63]
ds_read_b64_tr_b16 v[140:141], v21 offset:12288
ds_read_b64_tr_b16 v[142:143], v21 offset:15360
s_add_u32 m0, s37, 49152
v_mfma_f32_16x16x32_bf16 v[84:87], v[104:107], v[92:95], v[84:87]
buffer_load_dwordx4 v13, s[24:27], s49 offen  lds
v_lshlrev_b32 v30, 16, v96
v_and_b32 v31, s87, v96
s_waitcnt lgkmcnt(14)
v_mfma_f32_16x16x32_bf16 v[40:43], v[108:111], v[96:99], v[40:43]
ds_read_b64_tr_b16 v[144:145], v22 offset:12288
v_fmac_f32 v27, v30, v30
v_fmac_f32 v27, v31, v31
v_mfma_f32_16x16x32_bf16 v[64:67], v[108:111], v[100:103], v[64:67]
ds_read_b64_tr_b16 v[146:147], v22 offset:15360
v_lshlrev_b32 v32, 16, v97
v_and_b32 v33, s87, v97
v_mfma_f32_16x16x32_bf16 v[88:91], v[108:111], v[92:95], v[88:91]
ds_read_b64_tr_b16 v[148:149], v23 offset:12288
v_fmac_f32 v27, v32, v32
v_fmac_f32 v27, v33, v33
s_waitcnt lgkmcnt(15)
v_mfma_f32_16x16x32_bf16 v[44:47], v[112:115], v[96:99], v[44:47]
ds_read_b64_tr_b16 v[150:151], v23 offset:15360
v_lshlrev_b32 v30, 16, v98
s_add_u32 m0, s38, 49152
v_mfma_f32_16x16x32_bf16 v[68:71], v[112:115], v[100:103], v[68:71]
buffer_load_dwordx4 v14, s[24:27], s49 offen  lds
s_add_u32 s55, s55, 1
s_cmp_eq_u32 s55, 10
s_cselect_b32 s55, 2, s55
s_lshl_b32 s48, s55, 7
s_mul_i32 s49, s55, 196608
v_and_b32 v31, s87, v98
s_waitcnt lgkmcnt(14)
v_mfma_f32_16x16x32_bf16 v[48:51], v[116:119], v[96:99], v[48:51]
ds_read_b64_tr_b16 v[152:153], v24 offset:12288
v_fmac_f32 v27, v30, v30
v_mfma_f32_16x16x32_bf16 v[72:75], v[116:119], v[100:103], v[72:75]
ds_read_b64_tr_b16 v[154:155], v24 offset:15360
v_fmac_f32 v27, v31, v31
s_waitcnt lgkmcnt(14)
v_mfma_f32_16x16x32_bf16 v[52:55], v[120:123], v[96:99], v[52:55]
ds_read_b64_tr_b16 v[156:157], v25 offset:12288
v_lshlrev_b32 v32, 16, v99
v_mfma_f32_16x16x32_bf16 v[76:79], v[120:123], v[100:103], v[76:79]
ds_read_b64_tr_b16 v[158:159], v25 offset:15360
v_and_b32 v33, s87, v99
s_waitcnt lgkmcnt(14)
v_mfma_f32_16x16x32_bf16 v[56:59], v[124:127], v[96:99], v[56:59]
v_fmac_f32 v27, v32, v32
v_mfma_f32_16x16x32_bf16 v[80:83], v[124:127], v[100:103], v[80:83]
v_fmac_f32 v27, v33, v33
s_waitcnt vmcnt(8)
s_barrier
s_add_u32 m0, s34, 0
s_waitcnt lgkmcnt(11)
v_mfma_f32_16x16x32_bf16 v[36:39], v[136:139], v[128:131], v[36:39]
ds_read_b64_tr_b16 v[104:105], v20 offset:24576
buffer_load_dwordx4 v10, s[20:23], s48 offen  lds
v_mfma_f32_16x16x32_bf16 v[232:235], v[92:95], v[128:131], v[232:235]
ds_read_b64_tr_b16 v[106:107], v20 offset:27648
ds_read_b128 v[96:99], v16 offset:16384
s_waitcnt lgkmcnt(13)
v_mfma_f32_16x16x32_bf16 v[60:63], v[136:139], v[132:135], v[60:63]
ds_read_b128 v[100:103], v18 offset:16384
ds_read_b64_tr_b16 v[108:109], v21 offset:24576
v_mfma_f32_16x16x32_bf16 v[84:87], v[136:139], v[92:95], v[84:87]
ds_read_b64_tr_b16 v[110:111], v21 offset:27648
v_lshlrev_b32 v30, 16, v128
v_and_b32 v31, s87, v128
s_waitcnt lgkmcnt(14)
v_mfma_f32_16x16x32_bf16 v[40:43], v[140:143], v[128:131], v[40:43]
ds_read_b64_tr_b16 v[112:113], v22 offset:24576
v_fmac_f32 v27, v30, v30
v_fmac_f32 v27, v31, v31
v_mfma_f32_16x16x32_bf16 v[64:67], v[140:143], v[132:135], v[64:67]
ds_read_b64_tr_b16 v[114:115], v22 offset:27648
v_lshlrev_b32 v32, 16, v129
v_and_b32 v33, s87, v129
s_add_u32 m0, s35, 0
v_mfma_f32_16x16x32_bf16 v[88:91], v[140:143], v[92:95], v[88:91]
buffer_load_dwordx4 v11, s[20:23], s48 offen  lds
v_fmac_f32 v27, v32, v32
v_fmac_f32 v27, v33, v33
s_waitcnt lgkmcnt(14)
v_mfma_f32_16x16x32_bf16 v[44:47], v[144:147], v[128:131], v[44:47]
ds_read_b64_tr_b16 v[116:117], v23 offset:24576
v_lshlrev_b32 v30, 16, v130
v_mfma_f32_16x16x32_bf16 v[68:71], v[144:147], v[132:135], v[68:71]
ds_read_b64_tr_b16 v[118:119], v23 offset:27648
v_and_b32 v31, s87, v130
s_waitcnt lgkmcnt(14)
v_mfma_f32_16x16x32_bf16 v[48:51], v[148:151], v[128:131], v[48:51]
ds_read_b64_tr_b16 v[120:121], v24 offset:24576
v_fmac_f32 v27, v30, v30
v_mfma_f32_16x16x32_bf16 v[72:75], v[148:151], v[132:135], v[72:75]
ds_read_b64_tr_b16 v[122:123], v24 offset:27648
v_fmac_f32 v27, v31, v31
s_waitcnt lgkmcnt(14)
v_mfma_f32_16x16x32_bf16 v[52:55], v[152:155], v[128:131], v[52:55]
ds_read_b64_tr_b16 v[124:125], v25 offset:24576
v_lshlrev_b32 v32, 16, v131
v_mfma_f32_16x16x32_bf16 v[76:79], v[152:155], v[132:135], v[76:79]
ds_read_b64_tr_b16 v[126:127], v25 offset:27648
v_and_b32 v33, s87, v131
s_waitcnt lgkmcnt(14)
v_mfma_f32_16x16x32_bf16 v[56:59], v[156:159], v[128:131], v[56:59]
v_fmac_f32 v27, v32, v32
v_mfma_f32_16x16x32_bf16 v[80:83], v[156:159], v[132:135], v[80:83]
v_fmac_f32 v27, v33, v33
ds_read_b64_tr_b16 v[136:137], v20 offset:36864
s_add_u32 m0, s36, 0
s_waitcnt lgkmcnt(12)
v_mfma_f32_16x16x32_bf16 v[36:39], v[104:107], v[96:99], v[36:39]
ds_read_b64_tr_b16 v[138:139], v20 offset:39936
buffer_load_dwordx4 v12, s[24:27], s49 offen  lds
v_mfma_f32_16x16x32_bf16 v[232:235], v[92:95], v[96:99], v[232:235]
ds_read_b128 v[128:131], v17 offset:16384
ds_read_b128 v[132:135], v19 offset:16384
s_waitcnt lgkmcnt(14)
v_mfma_f32_16x16x32_bf16 v[60:63], v[104:107], v[100:103], v[60:63]
ds_read_b64_tr_b16 v[140:141], v21 offset:36864
ds_read_b64_tr_b16 v[142:143], v21 offset:39936
s_add_u32 m0, s37, 0
v_mfma_f32_16x16x32_bf16 v[84:87], v[104:107], v[92:95], v[84:87]
buffer_load_dwordx4 v13, s[24:27], s49 offen  lds
v_lshlrev_b32 v30, 16, v96
v_and_b32 v31, s87, v96
s_waitcnt lgkmcnt(14)
v_mfma_f32_16x16x32_bf16 v[40:43], v[108:111], v[96:99], v[40:43]
ds_read_b64_tr_b16 v[144:145], v22 offset:36864
v_fmac_f32 v27, v30, v30
v_fmac_f32 v27, v31, v31
v_mfma_f32_16x16x32_bf16 v[64:67], v[108:111], v[100:103], v[64:67]
ds_read_b64_tr_b16 v[146:147], v22 offset:39936
v_lshlrev_b32 v32, 16, v97
v_and_b32 v33, s87, v97
v_mfma_f32_16x16x32_bf16 v[88:91], v[108:111], v[92:95], v[88:91]
ds_read_b64_tr_b16 v[148:149], v23 offset:36864
v_fmac_f32 v27, v32, v32
v_fmac_f32 v27, v33, v33
s_waitcnt lgkmcnt(15)
v_mfma_f32_16x16x32_bf16 v[44:47], v[112:115], v[96:99], v[44:47]
ds_read_b64_tr_b16 v[150:151], v23 offset:39936
v_lshlrev_b32 v30, 16, v98
s_add_u32 m0, s38, 0
v_mfma_f32_16x16x32_bf16 v[68:71], v[112:115], v[100:103], v[68:71]
buffer_load_dwordx4 v14, s[24:27], s49 offen  lds
s_add_u32 s55, s55, 1
s_cmp_eq_u32 s55, 10
s_cselect_b32 s55, 2, s55
s_lshl_b32 s48, s55, 7
s_mul_i32 s49, s55, 196608
v_and_b32 v31, s87, v98
s_waitcnt lgkmcnt(14)
v_mfma_f32_16x16x32_bf16 v[48:51], v[116:119], v[96:99], v[48:51]
ds_read_b64_tr_b16 v[152:153], v24 offset:36864
v_fmac_f32 v27, v30, v30
v_mfma_f32_16x16x32_bf16 v[72:75], v[116:119], v[100:103], v[72:75]
ds_read_b64_tr_b16 v[154:155], v24 offset:39936
v_fmac_f32 v27, v31, v31
s_waitcnt lgkmcnt(14)
v_mfma_f32_16x16x32_bf16 v[52:55], v[120:123], v[96:99], v[52:55]
ds_read_b64_tr_b16 v[156:157], v25 offset:36864
v_lshlrev_b32 v32, 16, v99
v_mfma_f32_16x16x32_bf16 v[76:79], v[120:123], v[100:103], v[76:79]
ds_read_b64_tr_b16 v[158:159], v25 offset:39936
v_and_b32 v33, s87, v99
s_waitcnt lgkmcnt(14)
v_mfma_f32_16x16x32_bf16 v[56:59], v[124:127], v[96:99], v[56:59]
v_fmac_f32 v27, v32, v32
v_mfma_f32_16x16x32_bf16 v[80:83], v[124:127], v[100:103], v[80:83]
v_fmac_f32 v27, v33, v33
s_waitcnt vmcnt(5)
s_barrier
s_waitcnt lgkmcnt(11)
v_mfma_f32_16x16x32_bf16 v[36:39], v[136:139], v[128:131], v[36:39]
ds_read_b64_tr_b16 v[104:105], v20 offset:49152
ds_read_b64_tr_b16 v[106:107], v20 offset:52224
v_mfma_f32_16x16x32_bf16 v[232:235], v[92:95], v[128:131], v[232:235]
ds_read_b128 v[96:99], v16 offset:32768
v_lshlrev_b32 v30, 16, v128
v_and_b32 v31, s87, v128
s_waitcnt lgkmcnt(13)
v_mfma_f32_16x16x32_bf16 v[60:63], v[136:139], v[132:135], v[60:63]
ds_read_b128 v[100:103], v18 offset:32768
v_fmac_f32 v27, v30, v30
v_fmac_f32 v27, v31, v31
v_mfma_f32_16x16x32_bf16 v[84:87], v[136:139], v[92:95], v[84:87]
ds_read_b64_tr_b16 v[108:109], v21 offset:49152
v_lshlrev_b32 v32, 16, v129
s_waitcnt lgkmcnt(13)
v_mfma_f32_16x16x32_bf16 v[40:43], v[140:143], v[128:131], v[40:43]
ds_read_b64_tr_b16 v[110:111], v21 offset:52224
v_and_b32 v33, s87, v129
v_mfma_f32_16x16x32_bf16 v[64:67], v[140:143], v[132:135], v[64:67]
ds_read_b64_tr_b16 v[112:113], v22 offset:49152
v_fmac_f32 v27, v32, v32
v_mfma_f32_16x16x32_bf16 v[88:91], v[140:143], v[92:95], v[88:91]
ds_read_b64_tr_b16 v[114:115], v22 offset:52224
v_fmac_f32 v27, v33, v33
s_waitcnt lgkmcnt(14)
v_mfma_f32_16x16x32_bf16 v[44:47], v[144:147], v[128:131], v[44:47]
ds_read_b64_tr_b16 v[116:117], v23 offset:49152
v_lshlrev_b32 v30, 16, v130
v_mfma_f32_16x16x32_bf16 v[68:71], v[144:147], v[132:135], v[68:71]
ds_read_b64_tr_b16 v[118:119], v23 offset:52224
v_and_b32 v31, s87, v130
s_waitcnt lgkmcnt(14)
v_mfma_f32_16x16x32_bf16 v[48:51], v[148:151], v[128:131], v[48:51]
ds_read_b64_tr_b16 v[120:121], v24 offset:49152
v_fmac_f32 v27, v30, v30
v_mfma_f32_16x16x32_bf16 v[72:75], v[148:151], v[132:135], v[72:75]
ds_read_b64_tr_b16 v[122:123], v24 offset:52224
v_fmac_f32 v27, v31, v31
s_waitcnt lgkmcnt(14)
v_mfma_f32_16x16x32_bf16 v[52:55], v[152:155], v[128:131], v[52:55]
ds_read_b64_tr_b16 v[124:125], v25 offset:49152
v_lshlrev_b32 v32, 16, v131
v_mfma_f32_16x16x32_bf16 v[76:79], v[152:155], v[132:135], v[76:79]
ds_read_b64_tr_b16 v[126:127], v25 offset:52224
v_and_b32 v33, s87, v131
s_waitcnt lgkmcnt(14)
v_mfma_f32_16x16x32_bf16 v[56:59], v[156:159], v[128:131], v[56:59]
v_fmac_f32 v27, v32, v32
v_mfma_f32_16x16x32_bf16 v[80:83], v[156:159], v[132:135], v[80:83]
v_fmac_f32 v27, v33, v33
ds_read_b64_tr_b16 v[136:137], v20 offset:61440
s_waitcnt lgkmcnt(12)
v_mfma_f32_16x16x32_bf16 v[36:39], v[104:107], v[96:99], v[36:39]
ds_read_b64_tr_b16 v[138:139], v20 offset:64512
v_lshlrev_b32 v30, 16, v96
v_and_b32 v31, s87, v96
v_mfma_f32_16x16x32_bf16 v[232:235], v[92:95], v[96:99], v[232:235]
ds_read_b128 v[128:131], v17 offset:32768
v_fmac_f32 v27, v30, v30
s_waitcnt lgkmcnt(13)
v_mfma_f32_16x16x32_bf16 v[60:63], v[104:107], v[100:103], v[60:63]
ds_read_b128 v[132:135], v19 offset:32768
v_fmac_f32 v27, v31, v31
v_mfma_f32_16x16x32_bf16 v[84:87], v[104:107], v[92:95], v[84:87]
ds_read_b64_tr_b16 v[140:141], v21 offset:61440
v_lshlrev_b32 v32, 16, v97
s_waitcnt lgkmcnt(13)
v_mfma_f32_16x16x32_bf16 v[40:43], v[108:111], v[96:99], v[40:43]
ds_read_b64_tr_b16 v[142:143], v21 offset:64512
v_and_b32 v33, s87, v97
v_mfma_f32_16x16x32_bf16 v[64:67], v[108:111], v[100:103], v[64:67]
ds_read_b64_tr_b16 v[144:145], v22 offset:61440
v_fmac_f32 v27, v32, v32
v_mfma_f32_16x16x32_bf16 v[88:91], v[108:111], v[92:95], v[88:91]
ds_read_b64_tr_b16 v[146:147], v22 offset:64512
v_fmac_f32 v27, v33, v33
s_waitcnt lgkmcnt(14)
v_mfma_f32_16x16x32_bf16 v[44:47], v[112:115], v[96:99], v[44:47]
ds_read_b64_tr_b16 v[148:149], v23 offset:61440
v_lshlrev_b32 v30, 16, v98
v_mfma_f32_16x16x32_bf16 v[68:71], v[112:115], v[100:103], v[68:71]
ds_read_b64_tr_b16 v[150:151], v23 offset:64512
v_and_b32 v31, s87, v98
s_waitcnt lgkmcnt(14)
v_mfma_f32_16x16x32_bf16 v[48:51], v[116:119], v[96:99], v[48:51]
ds_read_b64_tr_b16 v[152:153], v24 offset:61440
v_fmac_f32 v27, v30, v30
v_mfma_f32_16x16x32_bf16 v[72:75], v[116:119], v[100:103], v[72:75]
ds_read_b64_tr_b16 v[154:155], v24 offset:64512
v_fmac_f32 v27, v31, v31
s_waitcnt lgkmcnt(14)
v_mfma_f32_16x16x32_bf16 v[52:55], v[120:123], v[96:99], v[52:55]
ds_read_b64_tr_b16 v[156:157], v25 offset:61440
v_lshlrev_b32 v32, 16, v99
v_mfma_f32_16x16x32_bf16 v[76:79], v[120:123], v[100:103], v[76:79]
ds_read_b64_tr_b16 v[158:159], v25 offset:64512
v_and_b32 v33, s87, v99
s_waitcnt lgkmcnt(14)
v_mfma_f32_16x16x32_bf16 v[56:59], v[124:127], v[96:99], v[56:59]
v_fmac_f32 v27, v32, v32
v_mfma_f32_16x16x32_bf16 v[80:83], v[124:127], v[100:103], v[80:83]
v_fmac_f32 v27, v33, v33
s_waitcnt vmcnt(0)
s_barrier
s_cmp_eq_u32 s14, 0
s_cbranch_scc0 pp19
s_cmp_eq_u32 s68, 5
s_cbranch_scc0 pp19
s_mov_b32 s33, 0
ng20:
v_readfirstlane_b32 s52, v252
s_nop 3
s_cmp_lg_u32 s52, 0
s_cbranch_scc1 ng21
s_mov_b32 s28, s84
s_and_b32 s29, s85, 0xffff
s_mov_b32 s30, 256
s_mov_b32 s31, 0x20000
s_sleep 8
v_mov_b32 v255, 0
buffer_load_dword v252, v255, s[28:31], 0 offen sc1
s_waitcnt vmcnt(0)
s_add_u32 s33, s33, 1
s_cmp_lt_u32 s33, 0x20000
s_cbranch_scc1 ng20
ng21:
s_add_u32 s28, s8, 25165824
s_addc_u32 s29, s9, 0
s_and_b32 s29, s29, 0xffff
s_mov_b32 s30, 8192
s_mov_b32 s31, 0x20000
s_lshl_b32 s33, s64, 2
s_add_u32 s33, s33, 4096
v_mov_b32 v254, s33
v_mov_b32 v253, s52
s_mov_b64 exec, 1
buffer_store_dword v253, v254, s[28:31], 0 offen sc1
s_mov_b64 exec, -1
pp19:
s_waitcnt lgkmcnt(11)
s_nop 0
v_mfma_f32_16x16x32_bf16 v[36:39], v[136:139], v[128:131], v[36:39]
ds_read_b64_tr_b16 v[104:105], v20 offset:0
ds_read_b64_tr_b16 v[106:107], v20 offset:3072
v_mfma_f32_16x16x32_bf16 v[232:235], v[92:95], v[128:131], v[232:235]
ds_read_b128 v[96:99], v16 offset:0
v_lshlrev_b32 v30, 16, v128
v_and_b32 v31, s87, v128
s_waitcnt lgkmcnt(13)
v_mfma_f32_16x16x32_bf16 v[60:63], v[136:139], v[132:135], v[60:63]
ds_read_b128 v[100:103], v18 offset:0
v_fmac_f32 v27, v30, v30
v_fmac_f32 v27, v31, v31
v_mfma_f32_16x16x32_bf16 v[84:87], v[136:139], v[92:95], v[84:87]
ds_read_b64_tr_b16 v[108:109], v21 offset:0
v_lshlrev_b32 v32, 16, v129
s_waitcnt lgkmcnt(13)
v_mfma_f32_16x16x32_bf16 v[40:43], v[140:143], v[128:131], v[40:43]
ds_read_b64_tr_b16 v[110:111], v21 offset:3072
v_and_b32 v33, s87, v129
v_mfma_f32_16x16x32_bf16 v[64:67], v[140:143], v[132:135], v[64:67]
ds_read_b64_tr_b16 v[112:113], v22 offset:0
v_fmac_f32 v27, v32, v32
v_mfma_f32_16x16x32_bf16 v[88:91], v[140:143], v[92:95], v[88:91]
ds_read_b64_tr_b16 v[114:115], v22 offset:3072
v_fmac_f32 v27, v33, v33
s_waitcnt lgkmcnt(14)
v_mfma_f32_16x16x32_bf16 v[44:47], v[144:147], v[128:131], v[44:47]
ds_read_b64_tr_b16 v[116:117], v23 offset:0
v_lshlrev_b32 v30, 16, v130
v_mfma_f32_16x16x32_bf16 v[68:71], v[144:147], v[132:135], v[68:71]
ds_read_b64_tr_b16 v[118:119], v23 offset:3072
v_and_b32 v31, s87, v130
s_waitcnt lgkmcnt(14)
v_mfma_f32_16x16x32_bf16 v[48:51], v[148:151], v[128:131], v[48:51]
ds_read_b64_tr_b16 v[120:121], v24 offset:0
v_fmac_f32 v27, v30, v30
v_mfma_f32_16x16x32_bf16 v[72:75], v[148:151], v[132:135], v[72:75]
ds_read_b64_tr_b16 v[122:123], v24 offset:3072
v_fmac_f32 v27, v31, v31
s_waitcnt lgkmcnt(14)
v_mfma_f32_16x16x32_bf16 v[52:55], v[152:155], v[128:131], v[52:55]
ds_read_b64_tr_b16 v[124:125], v25 offset:0
v_lshlrev_b32 v32, 16, v131
v_mfma_f32_16x16x32_bf16 v[76:79], v[152:155], v[132:135], v[76:79]
ds_read_b64_tr_b16 v[126:127], v25 offset:3072
v_and_b32 v33, s87, v131
s_waitcnt lgkmcnt(14)
v_mfma_f32_16x16x32_bf16 v[56:59], v[156:159], v[128:131], v[56:59]
v_fmac_f32 v27, v32, v32
v_mfma_f32_16x16x32_bf16 v[80:83], v[156:159], v[132:135], v[80:83]
v_fmac_f32 v27, v33, v33
ds_read_b64_tr_b16 v[136:137], v20 offset:12288
s_waitcnt lgkmcnt(12)
v_mfma_f32_16x16x32_bf16 v[36:39], v[104:107], v[96:99], v[36:39]
ds_read_b64_tr_b16 v[138:139], v20 offset:15360
v_lshlrev_b32 v30, 16, v96
v_and_b32 v31, s87, v96
v_mfma_f32_16x16x32_bf16 v[232:235], v[92:95], v[96:99], v[232:235]
ds_read_b128 v[128:131], v17 offset:0
v_fmac_f32 v27, v30, v30
s_waitcnt lgkmcnt(13)
v_mfma_f32_16x16x32_bf16 v[60:63], v[104:107], v[100:103], v[60:63]
ds_read_b128 v[132:135], v19 offset:0
v_fmac_f32 v27, v31, v31
v_mfma_f32_16x16x32_bf16 v[84:87], v[104:107], v[92:95], v[84:87]
ds_read_b64_tr_b16 v[140:141], v21 offset:12288
v_lshlrev_b32 v32, 16, v97
s_waitcnt lgkmcnt(13)
v_mfma_f32_16x16x32_bf16 v[40:43], v[108:111], v[96:99], v[40:43]
ds_read_b64_tr_b16 v[142:143], v21 offset:15360
v_and_b32 v33, s87, v97
v_mfma_f32_16x16x32_bf16 v[64:67], v[108:111], v[100:103], v[64:67]
ds_read_b64_tr_b16 v[144:145], v22 offset:12288
v_fmac_f32 v27, v32, v32
v_mfma_f32_16x16x32_bf16 v[88:91], v[108:111], v[92:95], v[88:91]
ds_read_b64_tr_b16 v[146:147], v22 offset:15360
v_fmac_f32 v27, v33, v33
s_waitcnt lgkmcnt(14)
v_mfma_f32_16x16x32_bf16 v[44:47], v[112:115], v[96:99], v[44:47]
ds_read_b64_tr_b16 v[148:149], v23 offset:12288
v_lshlrev_b32 v30, 16, v98
v_mfma_f32_16x16x32_bf16 v[68:71], v[112:115], v[100:103], v[68:71]
ds_read_b64_tr_b16 v[150:151], v23 offset:15360
v_and_b32 v31, s87, v98
s_waitcnt lgkmcnt(14)
v_mfma_f32_16x16x32_bf16 v[48:51], v[116:119], v[96:99], v[48:51]
ds_read_b64_tr_b16 v[152:153], v24 offset:12288
v_fmac_f32 v27, v30, v30
v_mfma_f32_16x16x32_bf16 v[72:75], v[116:119], v[100:103], v[72:75]
ds_read_b64_tr_b16 v[154:155], v24 offset:15360
v_fmac_f32 v27, v31, v31
s_waitcnt lgkmcnt(14)
v_mfma_f32_16x16x32_bf16 v[52:55], v[120:123], v[96:99], v[52:55]
ds_read_b64_tr_b16 v[156:157], v25 offset:12288
v_lshlrev_b32 v32, 16, v99
v_mfma_f32_16x16x32_bf16 v[76:79], v[120:123], v[100:103], v[76:79]
ds_read_b64_tr_b16 v[158:159], v25 offset:15360
v_and_b32 v33, s87, v99
s_waitcnt lgkmcnt(14)
v_mfma_f32_16x16x32_bf16 v[56:59], v[124:127], v[96:99], v[56:59]
v_fmac_f32 v27, v32, v32
v_mfma_f32_16x16x32_bf16 v[80:83], v[124:127], v[100:103], v[80:83]
v_fmac_f32 v27, v33, v33
s_waitcnt lgkmcnt(11)
v_mfma_f32_16x16x32_bf16 v[36:39], v[136:139], v[128:131], v[36:39]
v_lshlrev_b32 v30, 16, v128
v_and_b32 v31, s87, v128
v_fmac_f32 v27, v30, v30
v_mfma_f32_16x16x32_bf16 v[232:235], v[92:95], v[128:131], v[232:235]
v_fmac_f32 v27, v31, v31
v_lshlrev_b32 v32, 16, v129
v_and_b32 v33, s87, v129
s_waitcnt lgkmcnt(10)
v_mfma_f32_16x16x32_bf16 v[60:63], v[136:139], v[132:135], v[60:63]
v_fmac_f32 v27, v32, v32
v_fmac_f32 v27, v33, v33
v_lshlrev_b32 v30, 16, v130
v_mfma_f32_16x16x32_bf16 v[84:87], v[136:139], v[92:95], v[84:87]
v_and_b32 v31, s87, v130
v_fmac_f32 v27, v30, v30
v_fmac_f32 v27, v31, v31
s_waitcnt lgkmcnt(8)
v_mfma_f32_16x16x32_bf16 v[40:43], v[140:143], v[128:131], v[40:43]
v_lshlrev_b32 v32, 16, v131
v_and_b32 v33, s87, v131
v_fmac_f32 v27, v32, v32
v_mfma_f32_16x16x32_bf16 v[64:67], v[140:143], v[132:135], v[64:67]
v_fmac_f32 v27, v33, v33
v_mov_b32 v31, v27
s_nop 1
v_mfma_f32_16x16x32_bf16 v[88:91], v[140:143], v[92:95], v[88:91]
v_permlane32_swap_b32 v31, v27
s_nop 1
v_add_f32 v27, v27, v31
s_waitcnt lgkmcnt(6)
v_mfma_f32_16x16x32_bf16 v[44:47], v[144:147], v[128:131], v[44:47]
v_mov_b32 v31, v27
s_nop 1
v_permlane16_swap_b32 v31, v27
v_mfma_f32_16x16x32_bf16 v[68:71], v[144:147], v[132:135], v[68:71]
s_nop 1
v_add_f32 v27, v27, v31
v_mov_b32 v26, v232
s_waitcnt lgkmcnt(4)
v_mfma_f32_16x16x32_bf16 v[48:51], v[148:151], v[128:131], v[48:51]
v_mul_f32 v26, 0x3acccccd, v26
v_mul_f32 v27, 0x3acccccd, v27
v_fma_f32 v27, -v26, v26, v27
v_mfma_f32_16x16x32_bf16 v[72:75], v[148:151], v[132:135], v[72:75]
v_max_f32 v27, 0, v27
v_cvt_pk_bf16_f32 v26, v26, v26
v_and_b32 v26, s87, v26
s_waitcnt lgkmcnt(2)
v_mfma_f32_16x16x32_bf16 v[52:55], v[152:155], v[128:131], v[52:55]
v_cvt_pk_bf16_f32 v27, v27, v27
v_and_b32 v27, s87, v27
v_add_f32 v27, 0x3727c5ac, v27
v_mfma_f32_16x16x32_bf16 v[76:79], v[152:155], v[132:135], v[76:79]
v_cvt_pk_bf16_f32 v27, v27, v27
v_and_b32 v27, s87, v27
v_sqrt_f32 v27, v27
s_waitcnt lgkmcnt(0)
v_mfma_f32_16x16x32_bf16 v[56:59], v[156:159], v[128:131], v[56:59]
s_nop 0
v_cvt_pk_bf16_f32 v27, v27, v27
v_and_b32 v27, s87, v27
v_mfma_f32_16x16x32_bf16 v[80:83], v[156:159], v[132:135], v[80:83]
v_rcp_f32 v30, v27
s_nop 0
v_mul_f32 v27, v26, v30
v_mov_b32 v26, v30
s_mov_b64 exec, 0xffff
ds_write_b64 v168, v[26:27]
s_mov_b32 exec_lo, 0x00010001
s_mov_b32 exec_hi, 0x00010001
ds_write_b128 v160, v[84:87]
ds_write_b128 v161, v[88:91]
s_mov_b64 exec, -1
s_waitcnt lgkmcnt(0)
s_barrier
ds_read_b64 v[96:97], v168
ds_read_b64 v[98:99], v169
ds_read_b128 v[100:103], v160
ds_read_b128 v[104:107], v161
ds_read_b128 v[108:111], v162
ds_read_b128 v[112:115], v163
ds_read_b128 v[116:119], v164
ds_read_b128 v[120:123], v165
s_waitcnt lgkmcnt(0)
v_pk_mul_f32 v[148:149], v[100:101], v[96:97] op_sel:[0,1] op_sel_hi:[1,1]
v_pk_mul_f32 v[150:151], v[102:103], v[96:97] op_sel:[0,1] op_sel_hi:[1,1]
v_pk_mul_f32 v[152:153], v[104:105], v[96:97] op_sel:[0,1] op_sel_hi:[1,1]
v_pk_mul_f32 v[154:155], v[106:107], v[96:97] op_sel:[0,1] op_sel_hi:[1,1]
v_pk_fma_f32 v[36:37], v[36:37], v[96:97], v[148:149] op_sel_hi:[1,0,1] neg_lo:[0,0,1] neg_hi:[0,0,1]
v_pk_fma_f32 v[38:39], v[38:39], v[96:97], v[150:151] op_sel_hi:[1,0,1] neg_lo:[0,0,1] neg_hi:[0,0,1]
v_pk_fma_f32 v[40:41], v[40:41], v[96:97], v[152:153] op_sel_hi:[1,0,1] neg_lo:[0,0,1] neg_hi:[0,0,1]
v_pk_fma_f32 v[42:43], v[42:43], v[96:97], v[154:155] op_sel_hi:[1,0,1] neg_lo:[0,0,1] neg_hi:[0,0,1]
v_mul_f32 v148, 0xbfb8aa3b, v36
v_mul_f32 v149, 0xbfb8aa3b, v37
v_mul_f32 v150, 0xbfb8aa3b, v38
v_mul_f32 v151, 0xbfb8aa3b, v39
v_mul_f32 v152, 0xbfb8aa3b, v40
v_mul_f32 v153, 0xbfb8aa3b, v41
v_mul_f32 v154, 0xbfb8aa3b, v42
v_mul_f32 v155, 0xbfb8aa3b, v43
v_exp_f32 v148, v148
v_exp_f32 v149, v149
v_exp_f32 v150, v150
v_exp_f32 v151, v151
v_exp_f32 v152, v152
v_exp_f32 v153, v153
v_exp_f32 v154, v154
v_exp_f32 v155, v155
v_add_f32 v148, 1.0, v148
v_add_f32 v149, 1.0, v149
v_add_f32 v150, 1.0, v150
v_add_f32 v151, 1.0, v151
v_add_f32 v152, 1.0, v152
v_add_f32 v153, 1.0, v153
v_add_f32 v154, 1.0, v154
v_add_f32 v155, 1.0, v155
v_rcp_f32 v148, v148
v_rcp_f32 v149, v149
v_rcp_f32 v150, v150
v_rcp_f32 v151, v151
v_rcp_f32 v152, v152
v_rcp_f32 v153, v153
v_rcp_f32 v154, v154
v_rcp_f32 v155, v155
v_mul_f32 v36, v36, v148
v_mul_f32 v37, v37, v149
v_mul_f32 v38, v38, v150
v_mul_f32 v39, v39, v151
v_mul_f32 v40, v40, v152
v_mul_f32 v41, v41, v153
v_mul_f32 v42, v42, v154
v_mul_f32 v43, v43, v155
v_cvt_pk_bf16_f32 v156, v36, v37
v_cvt_pk_bf16_f32 v157, v38, v39
v_cvt_pk_bf16_f32 v158, v40, v41
v_cvt_pk_bf16_f32 v159, v42, v43
s_lshl_b32 s28, s72, 9
s_add_u32 s28, s28, s78
buffer_store_dwordx4 v[156:159], v171, s[80:83], s28 offen sc1
v_pk_mul_f32 v[148:149], v[108:109], v[96:97] op_sel:[0,1] op_sel_hi:[1,1]
v_pk_mul_f32 v[150:151], v[110:111], v[96:97] op_sel:[0,1] op_sel_hi:[1,1]
v_pk_mul_f32 v[152:153], v[112:113], v[96:97] op_sel:[0,1] op_sel_hi:[1,1]
v_pk_mul_f32 v[154:155], v[114:115], v[96:97] op_sel:[0,1] op_sel_hi:[1,1]
v_pk_fma_f32 v[44:45], v[44:45], v[96:97], v[148:149] op_sel_hi:[1,0,1] neg_lo:[0,0,1] neg_hi:[0,0,1]
v_pk_fma_f32 v[46:47], v[46:47], v[96:97], v[150:151] op_sel_hi:[1,0,1] neg_lo:[0,0,1] neg_hi:[0,0,1]
v_pk_fma_f32 v[48:49], v[48:49], v[96:97], v[152:153] op_sel_hi:[1,0,1] neg_lo:[0,0,1] neg_hi:[0,0,1]
v_pk_fma_f32 v[50:51], v[50:51], v[96:97], v[154:155] op_sel_hi:[1,0,1] neg_lo:[0,0,1] neg_hi:[0,0,1]
v_mul_f32 v148, 0xbfb8aa3b, v44
v_mul_f32 v149, 0xbfb8aa3b, v45
v_mul_f32 v150, 0xbfb8aa3b, v46
v_mul_f32 v151, 0xbfb8aa3b, v47
v_mul_f32 v152, 0xbfb8aa3b, v48
v_mul_f32 v153, 0xbfb8aa3b, v49
v_mul_f32 v154, 0xbfb8aa3b, v50
v_mul_f32 v155, 0xbfb8aa3b, v51
v_exp_f32 v148, v148
v_exp_f32 v149, v149
v_exp_f32 v150, v150
v_exp_f32 v151, v151
v_exp_f32 v152, v152
v_exp_f32 v153, v153
v_exp_f32 v154, v154
v_exp_f32 v155, v155
v_add_f32 v148, 1.0, v148
v_add_f32 v149, 1.0, v149
v_add_f32 v150, 1.0, v150
v_add_f32 v151, 1.0, v151
v_add_f32 v152, 1.0, v152
v_add_f32 v153, 1.0, v153
v_add_f32 v154, 1.0, v154
v_add_f32 v155, 1.0, v155
v_rcp_f32 v148, v148
v_rcp_f32 v149, v149
v_rcp_f32 v150, v150
v_rcp_f32 v151, v151
v_rcp_f32 v152, v152
v_rcp_f32 v153, v153
v_rcp_f32 v154, v154
v_rcp_f32 v155, v155
v_mul_f32 v44, v44, v148
v_mul_f32 v45, v45, v149
v_mul_f32 v46, v46, v150
v_mul_f32 v47, v47, v151
v_mul_f32 v48, v48, v152
v_mul_f32 v49, v49, v153
v_mul_f32 v50, v50, v154
v_mul_f32 v51, v51, v155
v_cvt_pk_bf16_f32 v160, v44, v45
v_cvt_pk_bf16_f32 v161, v46, v47
v_cvt_pk_bf16_f32 v162, v48, v49
v_cvt_pk_bf16_f32 v163, v50, v51
s_lshl_b32 s28, s74, 9
s_add_u32 s28, s28, s78
buffer_store_dwordx4 v[160:163], v171, s[80:83], s28 offen sc1
v_pk_mul_f32 v[148:149], v[116:117], v[96:97] op_sel:[0,1] op_sel_hi:[1,1]
v_pk_mul_f32 v[150:151], v[118:119], v[96:97] op_sel:[0,1] op_sel_hi:[1,1]
v_pk_mul_f32 v[152:153], v[120:121], v[96:97] op_sel:[0,1] op_sel_hi:[1,1]
v_pk_mul_f32 v[154:155], v[122:123], v[96:97] op_sel:[0,1] op_sel_hi:[1,1]
v_pk_fma_f32 v[52:53], v[52:53], v[96:97], v[148:149] op_sel_hi:[1,0,1] neg_lo:[0,0,1] neg_hi:[0,0,1]
v_pk_fma_f32 v[54:55], v[54:55], v[96:97], v[150:151] op_sel_hi:[1,0,1] neg_lo:[0,0,1] neg_hi:[0,0,1]
v_pk_fma_f32 v[56:57], v[56:57], v[96:97], v[152:153] op_sel_hi:[1,0,1] neg_lo:[0,0,1] neg_hi:[0,0,1]
v_pk_fma_f32 v[58:59], v[58:59], v[96:97], v[154:155] op_sel_hi:[1,0,1] neg_lo:[0,0,1] neg_hi:[0,0,1]
v_mul_f32 v148, 0xbfb8aa3b, v52
v_mul_f32 v149, 0xbfb8aa3b, v53
v_mul_f32 v150, 0xbfb8aa3b, v54
v_mul_f32 v151, 0xbfb8aa3b, v55
v_mul_f32 v152, 0xbfb8aa3b, v56
v_mul_f32 v153, 0xbfb8aa3b, v57
v_mul_f32 v154, 0xbfb8aa3b, v58
v_mul_f32 v155, 0xbfb8aa3b, v59
v_exp_f32 v148, v148
v_exp_f32 v149, v149
v_exp_f32 v150, v150
v_exp_f32 v151, v151
v_exp_f32 v152, v152
v_exp_f32 v153, v153
v_exp_f32 v154, v154
v_exp_f32 v155, v155
v_add_f32 v148, 1.0, v148
v_add_f32 v149, 1.0, v149
v_add_f32 v150, 1.0, v150
v_add_f32 v151, 1.0, v151
v_add_f32 v152, 1.0, v152
v_add_f32 v153, 1.0, v153
v_add_f32 v154, 1.0, v154
v_add_f32 v155, 1.0, v155
v_rcp_f32 v148, v148
v_rcp_f32 v149, v149
v_rcp_f32 v150, v150
v_rcp_f32 v151, v151
v_rcp_f32 v152, v152
v_rcp_f32 v153, v153
v_rcp_f32 v154, v154
v_rcp_f32 v155, v155
v_mul_f32 v52, v52, v148
v_mul_f32 v53, v53, v149
v_mul_f32 v54, v54, v150
v_mul_f32 v55, v55, v151
v_mul_f32 v56, v56, v152
v_mul_f32 v57, v57, v153
v_mul_f32 v58, v58, v154
v_mul_f32 v59, v59, v155
v_cvt_pk_bf16_f32 v156, v52, v53
v_cvt_pk_bf16_f32 v157, v54, v55
v_cvt_pk_bf16_f32 v158, v56, v57
v_cvt_pk_bf16_f32 v159, v58, v59
s_lshl_b32 s28, s76, 9
s_add_u32 s28, s28, s78
buffer_store_dwordx4 v[156:159], v171, s[80:83], s28 offen sc1
v_pk_mul_f32 v[148:149], v[100:101], v[98:99] op_sel:[0,1] op_sel_hi:[1,1]
v_pk_mul_f32 v[150:151], v[102:103], v[98:99] op_sel:[0,1] op_sel_hi:[1,1]
v_pk_mul_f32 v[152:153], v[104:105], v[98:99] op_sel:[0,1] op_sel_hi:[1,1]
v_pk_mul_f32 v[154:155], v[106:107], v[98:99] op_sel:[0,1] op_sel_hi:[1,1]
v_pk_fma_f32 v[60:61], v[60:61], v[98:99], v[148:149] op_sel_hi:[1,0,1] neg_lo:[0,0,1] neg_hi:[0,0,1]
v_pk_fma_f32 v[62:63], v[62:63], v[98:99], v[150:151] op_sel_hi:[1,0,1] neg_lo:[0,0,1] neg_hi:[0,0,1]
v_pk_fma_f32 v[64:65], v[64:65], v[98:99], v[152:153] op_sel_hi:[1,0,1] neg_lo:[0,0,1] neg_hi:[0,0,1]
v_pk_fma_f32 v[66:67], v[66:67], v[98:99], v[154:155] op_sel_hi:[1,0,1] neg_lo:[0,0,1] neg_hi:[0,0,1]
v_mul_f32 v148, 0xbfb8aa3b, v60
v_mul_f32 v149, 0xbfb8aa3b, v61
v_mul_f32 v150, 0xbfb8aa3b, v62
v_mul_f32 v151, 0xbfb8aa3b, v63
v_mul_f32 v152, 0xbfb8aa3b, v64
v_mul_f32 v153, 0xbfb8aa3b, v65
v_mul_f32 v154, 0xbfb8aa3b, v66
v_mul_f32 v155, 0xbfb8aa3b, v67
v_exp_f32 v148, v148
v_exp_f32 v149, v149
v_exp_f32 v150, v150
v_exp_f32 v151, v151
v_exp_f32 v152, v152
v_exp_f32 v153, v153
v_exp_f32 v154, v154
v_exp_f32 v155, v155
v_add_f32 v148, 1.0, v148
v_add_f32 v149, 1.0, v149
v_add_f32 v150, 1.0, v150
v_add_f32 v151, 1.0, v151
v_add_f32 v152, 1.0, v152
v_add_f32 v153, 1.0, v153
v_add_f32 v154, 1.0, v154
v_add_f32 v155, 1.0, v155
v_rcp_f32 v148, v148
v_rcp_f32 v149, v149
v_rcp_f32 v150, v150
v_rcp_f32 v151, v151
v_rcp_f32 v152, v152
v_rcp_f32 v153, v153
v_rcp_f32 v154, v154
v_rcp_f32 v155, v155
v_mul_f32 v60, v60, v148
v_mul_f32 v61, v61, v149
v_mul_f32 v62, v62, v150
v_mul_f32 v63, v63, v151
v_mul_f32 v64, v64, v152
v_mul_f32 v65, v65, v153
v_mul_f32 v66, v66, v154
v_mul_f32 v67, v67, v155
v_cvt_pk_bf16_f32 v156, v60, v61
v_cvt_pk_bf16_f32 v157, v62, v63
v_cvt_pk_bf16_f32 v158, v64, v65
v_cvt_pk_bf16_f32 v159, v66, v67
s_lshl_b32 s28, s72, 9
s_add_u32 s28, s28, s79
buffer_store_dwordx4 v[156:159], v171, s[80:83], s28 offen sc1
v_pk_mul_f32 v[148:149], v[108:109], v[98:99] op_sel:[0,1] op_sel_hi:[1,1]
v_pk_mul_f32 v[150:151], v[110:111], v[98:99] op_sel:[0,1] op_sel_hi:[1,1]
v_pk_mul_f32 v[152:153], v[112:113], v[98:99] op_sel:[0,1] op_sel_hi:[1,1]
v_pk_mul_f32 v[154:155], v[114:115], v[98:99] op_sel:[0,1] op_sel_hi:[1,1]
v_pk_fma_f32 v[68:69], v[68:69], v[98:99], v[148:149] op_sel_hi:[1,0,1] neg_lo:[0,0,1] neg_hi:[0,0,1]
v_pk_fma_f32 v[70:71], v[70:71], v[98:99], v[150:151] op_sel_hi:[1,0,1] neg_lo:[0,0,1] neg_hi:[0,0,1]
v_pk_fma_f32 v[72:73], v[72:73], v[98:99], v[152:153] op_sel_hi:[1,0,1] neg_lo:[0,0,1] neg_hi:[0,0,1]
v_pk_fma_f32 v[74:75], v[74:75], v[98:99], v[154:155] op_sel_hi:[1,0,1] neg_lo:[0,0,1] neg_hi:[0,0,1]
v_mul_f32 v148, 0xbfb8aa3b, v68
v_mul_f32 v149, 0xbfb8aa3b, v69
v_mul_f32 v150, 0xbfb8aa3b, v70
v_mul_f32 v151, 0xbfb8aa3b, v71
v_mul_f32 v152, 0xbfb8aa3b, v72
v_mul_f32 v153, 0xbfb8aa3b, v73
v_mul_f32 v154, 0xbfb8aa3b, v74
v_mul_f32 v155, 0xbfb8aa3b, v75
v_exp_f32 v148, v148
v_exp_f32 v149, v149
v_exp_f32 v150, v150
v_exp_f32 v151, v151
v_exp_f32 v152, v152
v_exp_f32 v153, v153
v_exp_f32 v154, v154
v_exp_f32 v155, v155
v_add_f32 v148, 1.0, v148
v_add_f32 v149, 1.0, v149
v_add_f32 v150, 1.0, v150
v_add_f32 v151, 1.0, v151
v_add_f32 v152, 1.0, v152
v_add_f32 v153, 1.0, v153
v_add_f32 v154, 1.0, v154
v_add_f32 v155, 1.0, v155
v_rcp_f32 v148, v148
v_rcp_f32 v149, v149
v_rcp_f32 v150, v150
v_rcp_f32 v151, v151
v_rcp_f32 v152, v152
v_rcp_f32 v153, v153
v_rcp_f32 v154, v154
v_rcp_f32 v155, v155
v_mul_f32 v68, v68, v148
v_mul_f32 v69, v69, v149
v_mul_f32 v70, v70, v150
v_mul_f32 v71, v71, v151
v_mul_f32 v72, v72, v152
v_mul_f32 v73, v73, v153
v_mul_f32 v74, v74, v154
v_mul_f32 v75, v75, v155
v_cvt_pk_bf16_f32 v160, v68, v69
v_cvt_pk_bf16_f32 v161, v70, v71
v_cvt_pk_bf16_f32 v162, v72, v73
v_cvt_pk_bf16_f32 v163, v74, v75
s_lshl_b32 s28, s74, 9
s_add_u32 s28, s28, s79
buffer_store_dwordx4 v[160:163], v171, s[80:83], s28 offen sc1
v_pk_mul_f32 v[148:149], v[116:117], v[98:99] op_sel:[0,1] op_sel_hi:[1,1]
v_pk_mul_f32 v[150:151], v[118:119], v[98:99] op_sel:[0,1] op_sel_hi:[1,1]
v_pk_mul_f32 v[152:153], v[120:121], v[98:99] op_sel:[0,1] op_sel_hi:[1,1]
v_pk_mul_f32 v[154:155], v[122:123], v[98:99] op_sel:[0,1] op_sel_hi:[1,1]
v_pk_fma_f32 v[76:77], v[76:77], v[98:99], v[148:149] op_sel_hi:[1,0,1] neg_lo:[0,0,1] neg_hi:[0,0,1]
v_pk_fma_f32 v[78:79], v[78:79], v[98:99], v[150:151] op_sel_hi:[1,0,1] neg_lo:[0,0,1] neg_hi:[0,0,1]
v_pk_fma_f32 v[80:81], v[80:81], v[98:99], v[152:153] op_sel_hi:[1,0,1] neg_lo:[0,0,1] neg_hi:[0,0,1]
v_pk_fma_f32 v[82:83], v[82:83], v[98:99], v[154:155] op_sel_hi:[1,0,1] neg_lo:[0,0,1] neg_hi:[0,0,1]
v_mul_f32 v148, 0xbfb8aa3b, v76
v_mul_f32 v149, 0xbfb8aa3b, v77
v_mul_f32 v150, 0xbfb8aa3b, v78
v_mul_f32 v151, 0xbfb8aa3b, v79
v_mul_f32 v152, 0xbfb8aa3b, v80
v_mul_f32 v153, 0xbfb8aa3b, v81
v_mul_f32 v154, 0xbfb8aa3b, v82
v_mul_f32 v155, 0xbfb8aa3b, v83
v_exp_f32 v148, v148
v_exp_f32 v149, v149
v_exp_f32 v150, v150
v_exp_f32 v151, v151
v_exp_f32 v152, v152
v_exp_f32 v153, v153
v_exp_f32 v154, v154
v_exp_f32 v155, v155
v_add_f32 v148, 1.0, v148
v_add_f32 v149, 1.0, v149
v_add_f32 v150, 1.0, v150
v_add_f32 v151, 1.0, v151
v_add_f32 v152, 1.0, v152
v_add_f32 v153, 1.0, v153
v_add_f32 v154, 1.0, v154
v_add_f32 v155, 1.0, v155
v_rcp_f32 v148, v148
v_rcp_f32 v149, v149
v_rcp_f32 v150, v150
v_rcp_f32 v151, v151
v_rcp_f32 v152, v152
v_rcp_f32 v153, v153
v_rcp_f32 v154, v154
v_rcp_f32 v155, v155
v_mul_f32 v76, v76, v148
v_mul_f32 v77, v77, v149
v_mul_f32 v78, v78, v150
v_mul_f32 v79, v79, v151
v_mul_f32 v80, v80, v152
v_mul_f32 v81, v81, v153
v_mul_f32 v82, v82, v154
v_mul_f32 v83, v83, v155
v_cvt_pk_bf16_f32 v156, v76, v77
v_cvt_pk_bf16_f32 v157, v78, v79
v_cvt_pk_bf16_f32 v158, v80, v81
v_cvt_pk_bf16_f32 v159, v82, v83
s_lshl_b32 s28, s76, 9
s_add_u32 s28, s28, s79
buffer_store_dwordx4 v[156:159], v171, s[80:83], s28 offen sc1
s_waitcnt vmcnt(0)
s_barrier
s_add_u32 s48, s8, 25165824
s_addc_u32 s49, s9, 0
s_and_b32 s49, s49, 0xffff
s_mov_b32 s50, 8192
s_mov_b32 s51, 0x20000
s_cmp_eq_u32 s14, 0
s_cbranch_scc0 fz_pub
s_mov_b32 s33, 0
ng22:
v_readfirstlane_b32 s52, v252
s_nop 3
s_cmp_lg_u32 s52, 0
s_cbranch_scc1 ng23
s_mov_b32 s28, s84
s_and_b32 s29, s85, 0xffff
s_mov_b32 s30, 256
s_mov_b32 s31, 0x20000
s_sleep 8
v_mov_b32 v255, 0
buffer_load_dword v252, v255, s[28:31], 0 offen sc1
s_waitcnt vmcnt(0)
s_add_u32 s33, s33, 1
s_cmp_lt_u32 s33, 0x20000
s_cbranch_scc1 ng22
ng23:
s_lshl_b32 s28, s12, 7
s_lshl_b32 s29, s13, 2
s_add_u32 s28, s28, s29
s_add_u32 s28, s28, 32
v_mov_b32 v20, s28
v_mov_b32 v21, s52
s_mov_b64 exec, 1
buffer_store_dword v21, v20, s[48:51], 0 offen sc1
s_mov_b64 exec, -1
s_add_u32 s28, s8, 25165824
s_addc_u32 s29, s9, 0
s_and_b32 s29, s29, 0xffff
s_mov_b32 s30, 8192
s_mov_b32 s31, 0x20000
v_lshlrev_b32 v255, 2, v0
v_add_u32 v255, 4096, v255
buffer_load_dword v253, v255, s[28:31], 0 offen sc1
v_and_b32 v249, 3, v0
v_lshlrev_b32 v249, 2, v249
v_add_u32 v249, 4352, v249
buffer_load_dword v254, v249, s[28:31], 0 offen sc1
s_waitcnt vmcnt(0)
s_mov_b32 s33, 0
pc24:
v_cmp_ne_u32 vcc, s52, v253
v_cmp_ne_u32 s[54:55], s52, v254
s_nop 3
s_or_b64 vcc, vcc, s[54:55]
s_cmp_eq_u64 vcc, 0
s_cbranch_scc1 pc25
s_sleep 4
s_add_u32 s28, s8, 25165824
s_addc_u32 s29, s9, 0
s_and_b32 s29, s29, 0xffff
s_mov_b32 s30, 8192
s_mov_b32 s31, 0x20000
v_lshlrev_b32 v255, 2, v0
v_add_u32 v255, 4096, v255
buffer_load_dword v253, v255, s[28:31], 0 offen sc1
v_and_b32 v249, 3, v0
v_lshlrev_b32 v249, 2, v249
v_add_u32 v249, 4352, v249
buffer_load_dword v254, v249, s[28:31], 0 offen sc1
s_waitcnt vmcnt(0)
s_add_u32 s33, s33, 1
s_cmp_lt_u32 s33, 0x20000
s_cbranch_scc1 pc24
pc25:
v_mov_b32 v22, 99328
v_mov_b32 v23, s52
ds_write_b32 v22, v23
s_waitcnt lgkmcnt(0)
fz_pub:
s_barrier
s_mov_b32 s53, 0
s_mov_b32 s66, 0
s_and_b32 s10, s2, 7
s_lshr_b32 s11, s2, 3
s_lshr_b32 s12, s10, 1
s_lshl_b32 s12, s12, 3
s_and_b32 s13, s11, 7
s_add_u32 s12, s12, s13
s_and_b32 s13, s10, 1
s_lshl_b32 s13, s13, 2
s_lshr_b32 s15, s11, 3
s_add_u32 s13, s13, s15
v_lshlrev_b32 v2, 4, v0
s_and_b32 s15, s14, 3
s_lshr_b32 s16, s14, 2
s_lshl_b32 s20, s14, 10
s_lshl_b32 s23, s16, 13
s_add_u32 s20, s20, s23
s_mul_i32 s19, s13, 348160
s_add_u32 s21, s20, 4096
s_add_u32 s22, s20, 8192
s_add_u32 s23, s19, s20
s_add_u32 s24, s19, s21
s_add_u32 s25, s19, s22
s_add_u32 s20, s20, 102400
s_add_u32 s21, s21, 102400
s_add_u32 s22, s22, 102400
s_add_u32 s32, s8, 16777216
s_addc_u32 s33, s9, 0
s_and_b32 s33, s33, 0xffff
s_mov_b32 s34, 2785280
s_mov_b32 s35, 0x20000
s_lshl_b32 s17, s12, 2
s_add_u32 s17, s17, s15
s_mul_i32 s18, s17, 69632
s_lshl_b32 s19, s16, 11
s_add_u32 s18, s18, s19
s_lshl_b32 s26, s14, 11
s_lshr_b32 s38, s12, 1
s_lshl_b32 s38, s38, 7
s_and_b32 s39, s12, 1
s_add_u32 s38, s38, s39
s_lshl_b32 s39, s15, 5
s_add_u32 s38, s38, s39
v_and_b32 v3, 15, v0
v_lshlrev_b32 v3, 1, v3
v_add_u32 v3, s38, v3
v_mul_u32_u24 v3, 1280, v3
v_lshrrev_b32 v4, 4, v0
s_mul_i32 s39, s13, 160
v_add_u32 v3, s39, v3
v_lshlrev_b32 v5, 4, v4
v_add_u32 v5, v3, v5
s_lshl_b32 s39, s16, 6
v_add_u32 v5, s39, v5
v_lshlrev_b32 v6, 3, v4
v_add_u32 v6, v3, v6
v_add_u32 v6, 128, v6
s_mov_b32 s40, s4
s_and_b32 s41, s5, 0xffff
s_mov_b32 s42, 2621440
s_mov_b32 s43, 0x20000
s_mov_b32 s44, s96
s_and_b32 s45, s97, 0xffff
s_mov_b32 s46, 2621440
s_mov_b32 s47, 0x20000
v_add_u32 v14, 102400, v2
s_lshl_b32 s39, s15, 11
v_add_u32 v15, s39, v2
v_lshlrev_b32 v223, 3, v0
v_add_u32 v223, s39, v223
s_lshr_b32 s38, s12, 1
s_lshl_b32 s38, s38, 7
v_and_b32 v21, 7, v0
v_lshlrev_b32 v21, 2, v21
v_add_u32 v21, s38, v21
v_add_u32 v20, 32, v21
s_cmp_eq_u32 s16, 0
s_cbranch_scc0 wp1_f
s_add_u32 m0, s20, 0
s_nop 0
buffer_load_dwordx4 v2, s[32:35], s23 offen sc1 lds
s_add_u32 s23, s23, 20480
s_add_u32 m0, s21, 0
s_nop 0
buffer_load_dwordx4 v2, s[32:35], s24 offen sc1 lds
s_add_u32 s24, s24, 20480
s_add_u32 m0, s22, 0
s_nop 0
buffer_load_dwordx4 v2, s[32:35], s25 offen sc1 lds
s_add_u32 s25, s25, 20480
s_add_u32 m0, s20, 20480
s_nop 0
buffer_load_dwordx4 v2, s[32:35], s23 offen sc1 lds
s_add_u32 s23, s23, 20480
s_add_u32 m0, s21, 20480
s_nop 0
buffer_load_dwordx4 v2, s[32:35], s24 offen sc1 lds
s_add_u32 s24, s24, 20480
s_add_u32 m0, s22, 20480
s_nop 0
buffer_load_dwordx4 v2, s[32:35], s25 offen sc1 lds
s_add_u32 s25, s25, 20480
s_add_u32 m0, s20, 40960
s_nop 0
buffer_load_dwordx4 v2, s[32:35], s23 offen sc1 lds
s_add_u32 s23, s23, 20480
s_add_u32 m0, s21, 40960
s_nop 0
buffer_load_dwordx4 v2, s[32:35], s24 offen sc1 lds
s_add_u32 s24, s24, 20480
s_add_u32 m0, s22, 40960
s_nop 0
buffer_load_dwordx4 v2, s[32:35], s25 offen sc1 lds
s_add_u32 s25, s25, 20480
s_branch wp2_f
wp1_f:
s_add_u32 m0, s20, 0
s_nop 0
buffer_load_dwordx4 v2, s[32:35], s23 offen sc1 lds
s_add_u32 s23, s23, 20480
s_add_u32 m0, s21, 0
s_nop 0
buffer_load_dwordx4 v2, s[32:35], s24 offen sc1 lds
s_add_u32 s24, s24, 20480
s_add_u32 m0, s20, 20480
s_nop 0
buffer_load_dwordx4 v2, s[32:35], s23 offen sc1 lds
s_add_u32 s23, s23, 20480
s_add_u32 m0, s21, 20480
s_nop 0
buffer_load_dwordx4 v2, s[32:35], s24 offen sc1 lds
s_add_u32 s24, s24, 20480
s_add_u32 m0, s20, 40960
s_nop 0
buffer_load_dwordx4 v2, s[32:35], s23 offen sc1 lds
s_add_u32 s23, s23, 20480
s_add_u32 m0, s21, 40960
s_nop 0
buffer_load_dwordx4 v2, s[32:35], s24 offen sc1 lds
s_add_u32 s24, s24, 20480
wp2_f:
p1_end:
s_add_u32 s48, s8, 25165824
s_addc_u32 s49, s9, 0
s_and_b32 s49, s49, 0xffff
s_mov_b32 s50, 8192
s_mov_b32 s51, 0x20000
s_barrier
v_mov_b32 v22, 99328
ds_read_b32 v23, v22
s_waitcnt lgkmcnt(0)
v_readfirstlane_b32 s52, v23
s_mov_b32 s28, s8
s_and_b32 s29, s9, 0xffff
s_mov_b32 s30, 8912896
s_mov_b32 s31, 0x20000
s_cmp_eq_u32 s16, 0
s_cbranch_scc0 p2_path1
s_cmp_eq_u32 s14, 0
s_cbranch_scc0 fz_go_c0
s_mov_b32 s39, 0
fz_poll_c0:
buffer_load_dword v24, v20, s[48:51], 0 offen sc1
s_waitcnt vmcnt(0)
v_cmp_ne_u32 vcc, s52, v24
s_nop 4
s_cmp_eq_u64 vcc, 0
s_cbranch_scc1 fz_go_c0
s_sleep 2
s_add_u32 s39, s39, 1
s_cmp_lt_u32 s39, 0x20000
s_cbranch_scc1 fz_poll_c0
fz_go_c0:
s_barrier
s_add_u32 m0, s26, 0
s_nop 0
buffer_load_dwordx4 v2, s[28:31], s18 offen sc1 lds
buffer_load_dwordx4 v2, s[28:31], s18 offen offset:1024 sc1 lds
s_add_u32 s18, s18, 4096
s_add_u32 m0, s26, 16384
s_nop 0
buffer_load_dwordx4 v2, s[28:31], s18 offen sc1 lds
buffer_load_dwordx4 v2, s[28:31], s18 offen offset:1024 sc1 lds
s_add_u32 s18, s18, 4096
s_add_u32 m0, s26, 32768
s_nop 0
buffer_load_dwordx4 v2, s[28:31], s18 offen sc1 lds
buffer_load_dwordx4 v2, s[28:31], s18 offen offset:1024 sc1 lds
s_add_u32 s18, s18, 4096
s_waitcnt vmcnt(4)
s_barrier
s_cmp_eq_u32 s53, 1
s_cselect_b64 exec, -1, 0
buffer_store_dwordx4 v[36:39], v2, s[80:83], s70 offen sc1
buffer_store_dwordx4 v[40:43], v2, s[80:83], s70 offen offset:1024 sc1
buffer_store_dwordx2 v[44:45], v224, s[80:83], s71 offen sc1
s_mov_b64 exec, -1
buffer_load_dwordx4 v[8:11], v5, s[40:43], 0 offen
buffer_load_dwordx2 v[12:13], v6, s[40:43], 0 offen
ds_read_b128 v[40:43], v15 offset:0
ds_read_b128 v[56:59], v14 offset:0
ds_read_b128 v[60:63], v14 offset:1024
ds_read_b128 v[64:67], v14 offset:4096
ds_read_b128 v[44:47], v15 offset:1024
ds_read_b128 v[68:71], v14 offset:5120
ds_read_b128 v[72:75], v14 offset:6144
ds_read_b128 v[76:79], v14 offset:9216
ds_read_b128 v[48:51], v15 offset:8192
ds_read_b128 v[80:83], v14 offset:10240
ds_read_b128 v[84:87], v14 offset:11264
ds_read_b128 v[88:91], v14 offset:14336
ds_read_b128 v[52:55], v15 offset:9216
ds_read_b128 v[92:95], v14 offset:15360
ds_read_b128 v[96:99], v14 offset:16384
ds_read_b128 v[100:103], v14 offset:19456
s_waitcnt vmcnt(7)
s_barrier
s_add_u32 m0, s26, 0
s_waitcnt lgkmcnt(14)
v_mfma_f32_16x16x32_bf16 v[28:31], v[56:59], v[40:43], 0
buffer_load_dwordx4 v2, s[28:31], s18 offen sc1 lds
buffer_load_dwordx4 v2, s[28:31], s18 offen offset:1024 sc1 lds
s_add_u32 s18, s18, 4096
ds_read_b128 v[104:107], v15 offset:16384
s_waitcnt lgkmcnt(14)
v_mfma_f32_16x16x32_bf16 v[32:35], v[60:63], v[40:43], 0
ds_read_b128 v[120:123], v14 offset:20480
ds_read_b128 v[124:127], v14 offset:21504
s_waitcnt lgkmcnt(15)
v_mfma_f32_16x16x32_bf16 v[36:39], v[64:67], v[40:43], 0
ds_read_b128 v[128:131], v14 offset:24576
s_add_u32 m0, s20, 0
s_waitcnt lgkmcnt(14)
v_mfma_f32_16x16x32_bf16 v[28:31], v[68:71], v[44:47], v[28:31]
buffer_load_dwordx4 v2, s[32:35], s23 offen sc1 lds
s_add_u32 s23, s23, 20480
ds_read_b128 v[108:111], v15 offset:17408
s_waitcnt lgkmcnt(14)
v_mfma_f32_16x16x32_bf16 v[32:35], v[72:75], v[44:47], v[32:35]
ds_read_b128 v[132:135], v14 offset:25600
ds_read_b128 v[136:139], v14 offset:26624
s_waitcnt lgkmcnt(15)
v_mfma_f32_16x16x32_bf16 v[36:39], v[76:79], v[44:47], v[36:39]
ds_read_b128 v[140:143], v14 offset:29696
s_add_u32 m0, s21, 0
s_waitcnt lgkmcnt(14)
v_mfma_f32_16x16x32_bf16 v[28:31], v[80:83], v[48:51], v[28:31]
buffer_load_dwordx4 v2, s[32:35], s24 offen sc1 lds
s_add_u32 s24, s24, 20480
ds_read_b128 v[112:115], v15 offset:24576
s_waitcnt lgkmcnt(14)
v_mfma_f32_16x16x32_bf16 v[32:35], v[84:87], v[48:51], v[32:35]
ds_read_b128 v[144:147], v14 offset:30720
ds_read_b128 v[148:151], v14 offset:31744
s_waitcnt lgkmcnt(15)
v_mfma_f32_16x16x32_bf16 v[36:39], v[88:91], v[48:51], v[36:39]
ds_read_b128 v[152:155], v14 offset:34816
s_add_u32 m0, s22, 0
s_waitcnt lgkmcnt(14)
v_mfma_f32_16x16x32_bf16 v[28:31], v[92:95], v[52:55], v[28:31]
buffer_load_dwordx4 v2, s[32:35], s25 offen sc1 lds
s_add_u32 s25, s25, 20480
ds_read_b128 v[116:119], v15 offset:25600
s_waitcnt lgkmcnt(14)
v_mfma_f32_16x16x32_bf16 v[32:35], v[96:99], v[52:55], v[32:35]
ds_read_b128 v[156:159], v14 offset:35840
ds_read_b128 v[160:163], v14 offset:36864
s_waitcnt lgkmcnt(15)
v_mfma_f32_16x16x32_bf16 v[36:39], v[100:103], v[52:55], v[36:39]
ds_read_b128 v[164:167], v14 offset:39936
s_waitcnt vmcnt(10)
s_barrier
s_add_u32 m0, s26, 16384
s_waitcnt lgkmcnt(14)
v_mfma_f32_16x16x32_bf16 v[28:31], v[120:123], v[104:107], v[28:31]
buffer_load_dwordx4 v2, s[28:31], s18 offen sc1 lds
buffer_load_dwordx4 v2, s[28:31], s18 offen offset:1024 sc1 lds
s_add_u32 s18, s18, 4096
ds_read_b128 v[40:43], v15 offset:32768
s_waitcnt lgkmcnt(14)
v_mfma_f32_16x16x32_bf16 v[32:35], v[124:127], v[104:107], v[32:35]
ds_read_b128 v[56:59], v14 offset:40960
ds_read_b128 v[60:63], v14 offset:41984
s_waitcnt lgkmcnt(15)
v_mfma_f32_16x16x32_bf16 v[36:39], v[128:131], v[104:107], v[36:39]
ds_read_b128 v[64:67], v14 offset:45056
s_add_u32 m0, s20, 20480
s_waitcnt lgkmcnt(14)
v_mfma_f32_16x16x32_bf16 v[28:31], v[132:135], v[108:111], v[28:31]
buffer_load_dwordx4 v2, s[32:35], s23 offen sc1 lds
s_add_u32 s23, s23, 20480
ds_read_b128 v[44:47], v15 offset:33792
s_waitcnt lgkmcnt(14)
v_mfma_f32_16x16x32_bf16 v[32:35], v[136:139], v[108:111], v[32:35]
ds_read_b128 v[68:71], v14 offset:46080
ds_read_b128 v[72:75], v14 offset:47104
s_waitcnt lgkmcnt(15)
v_mfma_f32_16x16x32_bf16 v[36:39], v[140:143], v[108:111], v[36:39]
ds_read_b128 v[76:79], v14 offset:50176
s_add_u32 m0, s21, 20480
s_waitcnt lgkmcnt(14)
v_mfma_f32_16x16x32_bf16 v[28:31], v[144:147], v[112:115], v[28:31]
buffer_load_dwordx4 v2, s[32:35], s24 offen sc1 lds
s_add_u32 s24, s24, 20480
ds_read_b128 v[48:51], v15 offset:40960
s_waitcnt lgkmcnt(14)
v_mfma_f32_16x16x32_bf16 v[32:35], v[148:151], v[112:115], v[32:35]
ds_read_b128 v[80:83], v14 offset:51200
ds_read_b128 v[84:87], v14 offset:52224
s_waitcnt lgkmcnt(15)
v_mfma_f32_16x16x32_bf16 v[36:39], v[152:155], v[112:115], v[36:39]
ds_read_b128 v[88:91], v14 offset:55296
s_add_u32 m0, s22, 20480
s_waitcnt lgkmcnt(14)
v_mfma_f32_16x16x32_bf16 v[28:31], v[156:159], v[116:119], v[28:31]
buffer_load_dwordx4 v2, s[32:35], s25 offen sc1 lds
s_add_u32 s25, s25, 20480
ds_read_b128 v[52:55], v15 offset:41984
s_waitcnt lgkmcnt(14)
v_mfma_f32_16x16x32_bf16 v[32:35], v[160:163], v[116:119], v[32:35]
ds_read_b128 v[92:95], v14 offset:56320
ds_read_b128 v[96:99], v14 offset:57344
s_waitcnt lgkmcnt(15)
v_mfma_f32_16x16x32_bf16 v[36:39], v[164:167], v[116:119], v[36:39]
ds_read_b128 v[100:103], v14 offset:60416
s_waitcnt vmcnt(5)
s_barrier
s_cmp_eq_u32 s53, 1
s_cbranch_scc0 fz_np_c0
s_cmp_eq_u32 s14, 0
s_cbranch_scc0 fz_np_c0
v_mov_b32 v22, s66
v_mov_b32 v23, s52
s_mov_b64 exec, 1
buffer_store_dword v23, v22, s[48:51], 0 offen sc1
s_mov_b64 exec, -1
fz_np_c0:
s_add_u32 m0, s26, 32768
s_waitcnt lgkmcnt(14)
v_mfma_f32_16x16x32_bf16 v[28:31], v[56:59], v[40:43], v[28:31]
buffer_load_dwordx4 v2, s[28:31], s18 offen sc1 lds
buffer_load_dwordx4 v2, s[28:31], s18 offen offset:1024 sc1 lds
s_add_u32 s18, s18, 4096
ds_read_b128 v[104:107], v15 offset:0
s_waitcnt lgkmcnt(14)
v_mfma_f32_16x16x32_bf16 v[32:35], v[60:63], v[40:43], v[32:35]
ds_read_b128 v[120:123], v14 offset:0
ds_read_b128 v[124:127], v14 offset:1024
s_waitcnt lgkmcnt(15)
v_mfma_f32_16x16x32_bf16 v[36:39], v[64:67], v[40:43], v[36:39]
ds_read_b128 v[128:131], v14 offset:4096
s_add_u32 m0, s20, 40960
s_waitcnt lgkmcnt(14)
v_mfma_f32_16x16x32_bf16 v[28:31], v[68:71], v[44:47], v[28:31]
buffer_load_dwordx4 v2, s[32:35], s23 offen sc1 lds
s_add_u32 s23, s23, 20480
ds_read_b128 v[108:111], v15 offset:1024
s_waitcnt lgkmcnt(14)
v_mfma_f32_16x16x32_bf16 v[32:35], v[72:75], v[44:47], v[32:35]
ds_read_b128 v[132:135], v14 offset:5120
ds_read_b128 v[136:139], v14 offset:6144
s_waitcnt lgkmcnt(15)
v_mfma_f32_16x16x32_bf16 v[36:39], v[76:79], v[44:47], v[36:39]
ds_read_b128 v[140:143], v14 offset:9216
s_add_u32 m0, s21, 40960
s_waitcnt lgkmcnt(14)
v_mfma_f32_16x16x32_bf16 v[28:31], v[80:83], v[48:51], v[28:31]
buffer_load_dwordx4 v2, s[32:35], s24 offen sc1 lds
s_add_u32 s24, s24, 20480
ds_read_b128 v[112:115], v15 offset:8192
s_waitcnt lgkmcnt(14)
v_mfma_f32_16x16x32_bf16 v[32:35], v[84:87], v[48:51], v[32:35]
ds_read_b128 v[144:147], v14 offset:10240
ds_read_b128 v[148:151], v14 offset:11264
s_waitcnt lgkmcnt(15)
v_mfma_f32_16x16x32_bf16 v[36:39], v[88:91], v[48:51], v[36:39]
ds_read_b128 v[152:155], v14 offset:14336
s_add_u32 m0, s22, 40960
s_waitcnt lgkmcnt(14)
v_mfma_f32_16x16x32_bf16 v[28:31], v[92:95], v[52:55], v[28:31]
buffer_load_dwordx4 v2, s[32:35], s25 offen sc1 lds
s_add_u32 s25, s25, 20480
ds_read_b128 v[116:119], v15 offset:9216
s_waitcnt lgkmcnt(14)
v_mfma_f32_16x16x32_bf16 v[32:35], v[96:99], v[52:55], v[32:35]
ds_read_b128 v[156:159], v14 offset:15360
ds_read_b128 v[160:163], v14 offset:16384
s_waitcnt lgkmcnt(15)
v_mfma_f32_16x16x32_bf16 v[36:39], v[100:103], v[52:55], v[36:39]
ds_read_b128 v[164:167], v14 offset:19456
s_waitcnt vmcnt(5)
s_barrier
s_add_u32 m0, s26, 0
s_waitcnt lgkmcnt(14)
v_mfma_f32_16x16x32_bf16 v[28:31], v[120:123], v[104:107], v[28:31]
buffer_load_dwordx4 v2, s[28:31], s18 offen sc1 lds
buffer_load_dwordx4 v2, s[28:31], s18 offen offset:1024 sc1 lds
s_add_u32 s18, s18, 4096
ds_read_b128 v[40:43], v15 offset:16384
s_waitcnt lgkmcnt(14)
v_mfma_f32_16x16x32_bf16 v[32:35], v[124:127], v[104:107], v[32:35]
ds_read_b128 v[56:59], v14 offset:20480
ds_read_b128 v[60:63], v14 offset:21504
s_waitcnt lgkmcnt(15)
v_mfma_f32_16x16x32_bf16 v[36:39], v[128:131], v[104:107], v[36:39]
ds_read_b128 v[64:67], v14 offset:24576
s_add_u32 m0, s20, 0
s_waitcnt lgkmcnt(14)
v_mfma_f32_16x16x32_bf16 v[28:31], v[132:135], v[108:111], v[28:31]
buffer_load_dwordx4 v2, s[32:35], s23 offen sc1 lds
s_add_u32 s23, s23, 20480
ds_read_b128 v[44:47], v15 offset:17408
s_waitcnt lgkmcnt(14)
v_mfma_f32_16x16x32_bf16 v[32:35], v[136:139], v[108:111], v[32:35]
ds_read_b128 v[68:71], v14 offset:25600
ds_read_b128 v[72:75], v14 offset:26624
s_waitcnt lgkmcnt(15)
v_mfma_f32_16x16x32_bf16 v[36:39], v[140:143], v[108:111], v[36:39]
ds_read_b128 v[76:79], v14 offset:29696
s_add_u32 m0, s21, 0
s_waitcnt lgkmcnt(14)
v_mfma_f32_16x16x32_bf16 v[28:31], v[144:147], v[112:115], v[28:31]
buffer_load_dwordx4 v2, s[32:35], s24 offen sc1 lds
s_add_u32 s24, s24, 20480
ds_read_b128 v[48:51], v15 offset:24576
s_waitcnt lgkmcnt(14)
v_mfma_f32_16x16x32_bf16 v[32:35], v[148:151], v[112:115], v[32:35]
ds_read_b128 v[80:83], v14 offset:30720
ds_read_b128 v[84:87], v14 offset:31744
s_waitcnt lgkmcnt(15)
v_mfma_f32_16x16x32_bf16 v[36:39], v[152:155], v[112:115], v[36:39]
ds_read_b128 v[88:91], v14 offset:34816
s_add_u32 m0, s22, 0
s_waitcnt lgkmcnt(14)
v_mfma_f32_16x16x32_bf16 v[28:31], v[156:159], v[116:119], v[28:31]
buffer_load_dwordx4 v2, s[32:35], s25 offen sc1 lds
s_add_u32 s25, s25, 20480
ds_read_b128 v[52:55], v15 offset:25600
s_waitcnt lgkmcnt(14)
v_mfma_f32_16x16x32_bf16 v[32:35], v[160:163], v[116:119], v[32:35]
ds_read_b128 v[92:95], v14 offset:35840
ds_read_b128 v[96:99], v14 offset:36864
s_waitcnt lgkmcnt(15)
v_mfma_f32_16x16x32_bf16 v[36:39], v[164:167], v[116:119], v[36:39]
ds_read_b128 v[100:103], v14 offset:39936
s_waitcnt vmcnt(5)
s_barrier
s_add_u32 m0, s26, 16384
s_waitcnt lgkmcnt(14)
v_mfma_f32_16x16x32_bf16 v[28:31], v[56:59], v[40:43], v[28:31]
buffer_load_dwordx4 v2, s[28:31], s18 offen sc1 lds
buffer_load_dwordx4 v2, s[28:31], s18 offen offset:1024 sc1 lds
s_add_u32 s18, s18, 4096
ds_read_b128 v[104:107], v15 offset:32768
s_waitcnt lgkmcnt(14)
v_mfma_f32_16x16x32_bf16 v[32:35], v[60:63], v[40:43], v[32:35]
ds_read_b128 v[120:123], v14 offset:40960
ds_read_b128 v[124:127], v14 offset:41984
s_waitcnt lgkmcnt(15)
v_mfma_f32_16x16x32_bf16 v[36:39], v[64:67], v[40:43], v[36:39]
ds_read_b128 v[128:131], v14 offset:45056
s_add_u32 m0, s20, 20480
s_waitcnt lgkmcnt(14)
v_mfma_f32_16x16x32_bf16 v[28:31], v[68:71], v[44:47], v[28:31]
buffer_load_dwordx4 v2, s[32:35], s23 offen sc1 lds
s_add_u32 s23, s23, 20480
ds_read_b128 v[108:111], v15 offset:33792
s_waitcnt lgkmcnt(14)
v_mfma_f32_16x16x32_bf16 v[32:35], v[72:75], v[44:47], v[32:35]
ds_read_b128 v[132:135], v14 offset:46080
ds_read_b128 v[136:139], v14 offset:47104
s_waitcnt lgkmcnt(15)
v_mfma_f32_16x16x32_bf16 v[36:39], v[76:79], v[44:47], v[36:39]
ds_read_b128 v[140:143], v14 offset:50176
s_add_u32 m0, s21, 20480
s_waitcnt lgkmcnt(14)
v_mfma_f32_16x16x32_bf16 v[28:31], v[80:83], v[48:51], v[28:31]
buffer_load_dwordx4 v2, s[32:35], s24 offen sc1 lds
s_add_u32 s24, s24, 20480
ds_read_b128 v[112:115], v15 offset:40960
s_waitcnt lgkmcnt(14)
v_mfma_f32_16x16x32_bf16 v[32:35], v[84:87], v[48:51], v[32:35]
ds_read_b128 v[144:147], v14 offset:51200
ds_read_b128 v[148:151], v14 offset:52224
s_waitcnt lgkmcnt(15)
v_mfma_f32_16x16x32_bf16 v[36:39], v[88:91], v[48:51], v[36:39]
ds_read_b128 v[152:155], v14 offset:55296
s_add_u32 m0, s22, 20480
s_waitcnt lgkmcnt(14)
v_mfma_f32_16x16x32_bf16 v[28:31], v[92:95], v[52:55], v[28:31]
buffer_load_dwordx4 v2, s[32:35], s25 offen sc1 lds
s_add_u32 s25, s25, 20480
ds_read_b128 v[116:119], v15 offset:41984
s_waitcnt lgkmcnt(14)
v_mfma_f32_16x16x32_bf16 v[32:35], v[96:99], v[52:55], v[32:35]
ds_read_b128 v[156:159], v14 offset:56320
ds_read_b128 v[160:163], v14 offset:57344
s_waitcnt lgkmcnt(15)
v_mfma_f32_16x16x32_bf16 v[36:39], v[100:103], v[52:55], v[36:39]
ds_read_b128 v[164:167], v14 offset:60416
s_waitcnt vmcnt(5)
s_barrier
s_add_u32 m0, s26, 32768
s_waitcnt lgkmcnt(14)
v_mfma_f32_16x16x32_bf16 v[28:31], v[120:123], v[104:107], v[28:31]
buffer_load_dwordx4 v2, s[28:31], s18 offen sc1 lds
buffer_load_dwordx4 v2, s[28:31], s18 offen offset:1024 sc1 lds
s_add_u32 s18, s18, 4096
ds_read_b128 v[40:43], v15 offset:0
s_waitcnt lgkmcnt(14)
v_mfma_f32_16x16x32_bf16 v[32:35], v[124:127], v[104:107], v[32:35]
ds_read_b128 v[56:59], v14 offset:0
ds_read_b128 v[60:63], v14 offset:1024
s_waitcnt lgkmcnt(15)
v_mfma_f32_16x16x32_bf16 v[36:39], v[128:131], v[104:107], v[36:39]
ds_read_b128 v[64:67], v14 offset:4096
s_add_u32 m0, s20, 40960
s_waitcnt lgkmcnt(14)
v_mfma_f32_16x16x32_bf16 v[28:31], v[132:135], v[108:111], v[28:31]
buffer_load_dwordx4 v2, s[32:35], s23 offen sc1 lds
s_add_u32 s23, s23, 20480
ds_read_b128 v[44:47], v15 offset:1024
s_waitcnt lgkmcnt(14)
v_mfma_f32_16x16x32_bf16 v[32:35], v[136:139], v[108:111], v[32:35]
ds_read_b128 v[68:71], v14 offset:5120
ds_read_b128 v[72:75], v14 offset:6144
s_waitcnt lgkmcnt(15)
v_mfma_f32_16x16x32_bf16 v[36:39], v[140:143], v[108:111], v[36:39]
ds_read_b128 v[76:79], v14 offset:9216
s_add_u32 m0, s21, 40960
s_waitcnt lgkmcnt(14)
v_mfma_f32_16x16x32_bf16 v[28:31], v[144:147], v[112:115], v[28:31]
buffer_load_dwordx4 v2, s[32:35], s24 offen sc1 lds
s_add_u32 s24, s24, 20480
ds_read_b128 v[48:51], v15 offset:8192
s_waitcnt lgkmcnt(14)
v_mfma_f32_16x16x32_bf16 v[32:35], v[148:151], v[112:115], v[32:35]
ds_read_b128 v[80:83], v14 offset:10240
ds_read_b128 v[84:87], v14 offset:11264
s_waitcnt lgkmcnt(15)
v_mfma_f32_16x16x32_bf16 v[36:39], v[152:155], v[112:115], v[36:39]
ds_read_b128 v[88:91], v14 offset:14336
s_add_u32 m0, s22, 40960
s_waitcnt lgkmcnt(14)
v_mfma_f32_16x16x32_bf16 v[28:31], v[156:159], v[116:119], v[28:31]
buffer_load_dwordx4 v2, s[32:35], s25 offen sc1 lds
s_add_u32 s25, s25, 20480
ds_read_b128 v[52:55], v15 offset:9216
s_waitcnt lgkmcnt(14)
v_mfma_f32_16x16x32_bf16 v[32:35], v[160:163], v[116:119], v[32:35]
ds_read_b128 v[92:95], v14 offset:15360
ds_read_b128 v[96:99], v14 offset:16384
s_waitcnt lgkmcnt(15)
v_mfma_f32_16x16x32_bf16 v[36:39], v[164:167], v[116:119], v[36:39]
ds_read_b128 v[100:103], v14 offset:19456
s_waitcnt vmcnt(5)
s_barrier
s_add_u32 m0, s26, 0
s_waitcnt lgkmcnt(14)
v_mfma_f32_16x16x32_bf16 v[28:31], v[56:59], v[40:43], v[28:31]
buffer_load_dwordx4 v2, s[28:31], s18 offen sc1 lds
buffer_load_dwordx4 v2, s[28:31], s18 offen offset:1024 sc1 lds
s_add_u32 s18, s18, 4096
ds_read_b128 v[104:107], v15 offset:16384
s_waitcnt lgkmcnt(14)
v_mfma_f32_16x16x32_bf16 v[32:35], v[60:63], v[40:43], v[32:35]
ds_read_b128 v[120:123], v14 offset:20480
ds_read_b128 v[124:127], v14 offset:21504
s_waitcnt lgkmcnt(15)
v_mfma_f32_16x16x32_bf16 v[36:39], v[64:67], v[40:43], v[36:39]
ds_read_b128 v[128:131], v14 offset:24576
s_add_u32 m0, s20, 0
s_waitcnt lgkmcnt(14)
v_mfma_f32_16x16x32_bf16 v[28:31], v[68:71], v[44:47], v[28:31]
buffer_load_dwordx4 v2, s[32:35], s23 offen sc1 lds
s_add_u32 s23, s23, 20480
ds_read_b128 v[108:111], v15 offset:17408
s_waitcnt lgkmcnt(14)
v_mfma_f32_16x16x32_bf16 v[32:35], v[72:75], v[44:47], v[32:35]
ds_read_b128 v[132:135], v14 offset:25600
ds_read_b128 v[136:139], v14 offset:26624
s_waitcnt lgkmcnt(15)
v_mfma_f32_16x16x32_bf16 v[36:39], v[76:79], v[44:47], v[36:39]
ds_read_b128 v[140:143], v14 offset:29696
s_add_u32 m0, s21, 0
s_waitcnt lgkmcnt(14)
v_mfma_f32_16x16x32_bf16 v[28:31], v[80:83], v[48:51], v[28:31]
buffer_load_dwordx4 v2, s[32:35], s24 offen sc1 lds
s_add_u32 s24, s24, 20480
ds_read_b128 v[112:115], v15 offset:24576
s_waitcnt lgkmcnt(14)
v_mfma_f32_16x16x32_bf16 v[32:35], v[84:87], v[48:51], v[32:35]
ds_read_b128 v[144:147], v14 offset:30720
ds_read_b128 v[148:151], v14 offset:31744
s_waitcnt lgkmcnt(15)
v_mfma_f32_16x16x32_bf16 v[36:39], v[88:91], v[48:51], v[36:39]
ds_read_b128 v[152:155], v14 offset:34816
s_add_u32 m0, s22, 0
s_waitcnt lgkmcnt(14)
v_mfma_f32_16x16x32_bf16 v[28:31], v[92:95], v[52:55], v[28:31]
buffer_load_dwordx4 v2, s[32:35], s25 offen sc1 lds
s_add_u32 s25, s25, 20480
ds_read_b128 v[116:119], v15 offset:25600
s_waitcnt lgkmcnt(14)
v_mfma_f32_16x16x32_bf16 v[32:35], v[96:99], v[52:55], v[32:35]
ds_read_b128 v[156:159], v14 offset:35840
ds_read_b128 v[160:163], v14 offset:36864
s_waitcnt lgkmcnt(15)
v_mfma_f32_16x16x32_bf16 v[36:39], v[100:103], v[52:55], v[36:39]
ds_read_b128 v[164:167], v14 offset:39936
s_waitcnt vmcnt(5)
s_barrier
s_add_u32 m0, s26, 16384
s_waitcnt lgkmcnt(14)
v_mfma_f32_16x16x32_bf16 v[28:31], v[120:123], v[104:107], v[28:31]
buffer_load_dwordx4 v2, s[28:31], s18 offen sc1 lds
buffer_load_dwordx4 v2, s[28:31], s18 offen offset:1024 sc1 lds
s_add_u32 s18, s18, 4096
ds_read_b128 v[40:43], v15 offset:32768
s_waitcnt lgkmcnt(14)
v_mfma_f32_16x16x32_bf16 v[32:35], v[124:127], v[104:107], v[32:35]
ds_read_b128 v[56:59], v14 offset:40960
ds_read_b128 v[60:63], v14 offset:41984
s_waitcnt lgkmcnt(15)
v_mfma_f32_16x16x32_bf16 v[36:39], v[128:131], v[104:107], v[36:39]
ds_read_b128 v[64:67], v14 offset:45056
s_add_u32 m0, s20, 20480
s_waitcnt lgkmcnt(14)
v_mfma_f32_16x16x32_bf16 v[28:31], v[132:135], v[108:111], v[28:31]
buffer_load_dwordx4 v2, s[32:35], s23 offen sc1 lds
s_add_u32 s23, s23, 20480
ds_read_b128 v[44:47], v15 offset:33792
s_waitcnt lgkmcnt(14)
v_mfma_f32_16x16x32_bf16 v[32:35], v[136:139], v[108:111], v[32:35]
ds_read_b128 v[68:71], v14 offset:46080
ds_read_b128 v[72:75], v14 offset:47104
s_waitcnt lgkmcnt(15)
v_mfma_f32_16x16x32_bf16 v[36:39], v[140:143], v[108:111], v[36:39]
ds_read_b128 v[76:79], v14 offset:50176
s_add_u32 m0, s21, 20480
s_waitcnt lgkmcnt(14)
v_mfma_f32_16x16x32_bf16 v[28:31], v[144:147], v[112:115], v[28:31]
buffer_load_dwordx4 v2, s[32:35], s24 offen sc1 lds
s_add_u32 s24, s24, 20480
ds_read_b128 v[48:51], v15 offset:40960
s_waitcnt lgkmcnt(14)
v_mfma_f32_16x16x32_bf16 v[32:35], v[148:151], v[112:115], v[32:35]
ds_read_b128 v[80:83], v14 offset:51200
ds_read_b128 v[84:87], v14 offset:52224
s_waitcnt lgkmcnt(15)
v_mfma_f32_16x16x32_bf16 v[36:39], v[152:155], v[112:115], v[36:39]
ds_read_b128 v[88:91], v14 offset:55296
s_add_u32 m0, s22, 20480
s_waitcnt lgkmcnt(14)
v_mfma_f32_16x16x32_bf16 v[28:31], v[156:159], v[116:119], v[28:31]
buffer_load_dwordx4 v2, s[32:35], s25 offen sc1 lds
s_add_u32 s25, s25, 20480
ds_read_b128 v[52:55], v15 offset:41984
s_waitcnt lgkmcnt(14)
v_mfma_f32_16x16x32_bf16 v[32:35], v[160:163], v[116:119], v[32:35]
ds_read_b128 v[92:95], v14 offset:56320
ds_read_b128 v[96:99], v14 offset:57344
s_waitcnt lgkmcnt(15)
v_mfma_f32_16x16x32_bf16 v[36:39], v[164:167], v[116:119], v[36:39]
ds_read_b128 v[100:103], v14 offset:60416
buffer_load_dword v24, v21, s[48:51], 0 offen sc1
s_waitcnt vmcnt(6)
s_barrier
s_add_u32 m0, s26, 32768
s_waitcnt lgkmcnt(14)
v_mfma_f32_16x16x32_bf16 v[28:31], v[56:59], v[40:43], v[28:31]
buffer_load_dwordx4 v2, s[28:31], s18 offen sc1 lds
buffer_load_dwordx4 v2, s[28:31], s18 offen offset:1024 sc1 lds
s_add_u32 s18, s18, 4096
ds_read_b128 v[104:107], v15 offset:0
s_waitcnt lgkmcnt(14)
v_mfma_f32_16x16x32_bf16 v[32:35], v[60:63], v[40:43], v[32:35]
ds_read_b128 v[120:123], v14 offset:0
ds_read_b128 v[124:127], v14 offset:1024
s_waitcnt lgkmcnt(15)
v_mfma_f32_16x16x32_bf16 v[36:39], v[64:67], v[40:43], v[36:39]
ds_read_b128 v[128:131], v14 offset:4096
s_add_u32 m0, s20, 40960
s_waitcnt lgkmcnt(14)
v_mfma_f32_16x16x32_bf16 v[28:31], v[68:71], v[44:47], v[28:31]
buffer_load_dwordx4 v2, s[32:35], s23 offen sc1 lds
s_add_u32 s23, s23, 20480
ds_read_b128 v[108:111], v15 offset:1024
s_waitcnt lgkmcnt(14)
v_mfma_f32_16x16x32_bf16 v[32:35], v[72:75], v[44:47], v[32:35]
ds_read_b128 v[132:135], v14 offset:5120
ds_read_b128 v[136:139], v14 offset:6144
s_waitcnt lgkmcnt(15)
v_mfma_f32_16x16x32_bf16 v[36:39], v[76:79], v[44:47], v[36:39]
ds_read_b128 v[140:143], v14 offset:9216
s_add_u32 m0, s21, 40960
s_waitcnt lgkmcnt(14)
v_mfma_f32_16x16x32_bf16 v[28:31], v[80:83], v[48:51], v[28:31]
buffer_load_dwordx4 v2, s[32:35], s24 offen sc1 lds
s_add_u32 s24, s24, 20480
ds_read_b128 v[112:115], v15 offset:8192
s_waitcnt lgkmcnt(14)
v_mfma_f32_16x16x32_bf16 v[32:35], v[84:87], v[48:51], v[32:35]
ds_read_b128 v[144:147], v14 offset:10240
ds_read_b128 v[148:151], v14 offset:11264
s_waitcnt lgkmcnt(15)
v_mfma_f32_16x16x32_bf16 v[36:39], v[88:91], v[48:51], v[36:39]
ds_read_b128 v[152:155], v14 offset:14336
s_add_u32 m0, s22, 40960
s_waitcnt lgkmcnt(14)
v_mfma_f32_16x16x32_bf16 v[28:31], v[92:95], v[52:55], v[28:31]
buffer_load_dwordx4 v2, s[32:35], s25 offen sc1 lds
s_add_u32 s25, s25, 20480
ds_read_b128 v[116:119], v15 offset:9216
s_waitcnt lgkmcnt(14)
v_mfma_f32_16x16x32_bf16 v[32:35], v[96:99], v[52:55], v[32:35]
ds_read_b128 v[156:159], v14 offset:15360
ds_read_b128 v[160:163], v14 offset:16384
s_waitcnt lgkmcnt(15)
v_mfma_f32_16x16x32_bf16 v[36:39], v[100:103], v[52:55], v[36:39]
ds_read_b128 v[164:167], v14 offset:19456
s_waitcnt vmcnt(6)
s_barrier
s_waitcnt vmcnt(5)
v_cmp_ne_u32 vcc, s52, v24
s_nop 4
s_cmp_eq_u64 vcc, 0
s_cbranch_scc1 fz_ok_c0
s_mov_b32 s39, 0
fz_pl_c0:
s_sleep 4
buffer_load_dword v24, v21, s[48:51], 0 offen sc1
s_waitcnt vmcnt(0)
v_cmp_ne_u32 vcc, s52, v24
s_nop 4
s_cmp_eq_u64 vcc, 0
s_cbranch_scc1 fz_ok_c0
s_add_u32 s39, s39, 1
s_cmp_lt_u32 s39, 0x20000
s_cbranch_scc1 fz_pl_c0
fz_ok_c0:
s_add_u32 m0, s26, 0
s_waitcnt lgkmcnt(14)
v_mfma_f32_16x16x32_bf16 v[28:31], v[120:123], v[104:107], v[28:31]
buffer_load_dwordx4 v2, s[28:31], s18 offen sc1 lds
buffer_load_dwordx4 v2, s[28:31], s18 offen offset:1024 sc1 lds
s_add_u32 s18, s18, 4096
ds_read_b128 v[40:43], v15 offset:16384
s_waitcnt lgkmcnt(14)
v_mfma_f32_16x16x32_bf16 v[32:35], v[124:127], v[104:107], v[32:35]
ds_read_b128 v[56:59], v14 offset:20480
ds_read_b128 v[60:63], v14 offset:21504
s_waitcnt lgkmcnt(15)
v_mfma_f32_16x16x32_bf16 v[36:39], v[128:131], v[104:107], v[36:39]
ds_read_b128 v[64:67], v14 offset:24576
s_add_u32 m0, s20, 0
s_waitcnt lgkmcnt(14)
v_mfma_f32_16x16x32_bf16 v[28:31], v[132:135], v[108:111], v[28:31]
buffer_load_dwordx4 v2, s[32:35], s23 offen sc1 lds
s_add_u32 s23, s23, 20480
ds_read_b128 v[44:47], v15 offset:17408
s_waitcnt lgkmcnt(14)
v_mfma_f32_16x16x32_bf16 v[32:35], v[136:139], v[108:111], v[32:35]
ds_read_b128 v[68:71], v14 offset:25600
ds_read_b128 v[72:75], v14 offset:26624
s_waitcnt lgkmcnt(15)
v_mfma_f32_16x16x32_bf16 v[36:39], v[140:143], v[108:111], v[36:39]
ds_read_b128 v[76:79], v14 offset:29696
s_add_u32 m0, s21, 0
s_waitcnt lgkmcnt(14)
v_mfma_f32_16x16x32_bf16 v[28:31], v[144:147], v[112:115], v[28:31]
buffer_load_dwordx4 v2, s[32:35], s24 offen sc1 lds
s_add_u32 s24, s24, 20480
ds_read_b128 v[48:51], v15 offset:24576
s_waitcnt lgkmcnt(14)
v_mfma_f32_16x16x32_bf16 v[32:35], v[148:151], v[112:115], v[32:35]
ds_read_b128 v[80:83], v14 offset:30720
ds_read_b128 v[84:87], v14 offset:31744
s_waitcnt lgkmcnt(15)
v_mfma_f32_16x16x32_bf16 v[36:39], v[152:155], v[112:115], v[36:39]
ds_read_b128 v[88:91], v14 offset:34816
s_add_u32 m0, s22, 0
s_waitcnt lgkmcnt(14)
v_mfma_f32_16x16x32_bf16 v[28:31], v[156:159], v[116:119], v[28:31]
buffer_load_dwordx4 v2, s[32:35], s25 offen sc1 lds
s_add_u32 s25, s25, 20480
ds_read_b128 v[52:55], v15 offset:25600
s_waitcnt lgkmcnt(14)
v_mfma_f32_16x16x32_bf16 v[32:35], v[160:163], v[116:119], v[32:35]
ds_read_b128 v[92:95], v14 offset:35840
ds_read_b128 v[96:99], v14 offset:36864
s_waitcnt lgkmcnt(15)
v_mfma_f32_16x16x32_bf16 v[36:39], v[164:167], v[116:119], v[36:39]
ds_read_b128 v[100:103], v14 offset:39936
s_waitcnt vmcnt(5)
s_barrier
s_add_u32 m0, s26, 16384
s_waitcnt lgkmcnt(14)
v_mfma_f32_16x16x32_bf16 v[28:31], v[56:59], v[40:43], v[28:31]
buffer_load_dwordx4 v2, s[28:31], s18 offen sc1 lds
buffer_load_dwordx4 v2, s[28:31], s18 offen offset:1024 sc1 lds
s_add_u32 s18, s18, 4096
ds_read_b128 v[104:107], v15 offset:32768
s_waitcnt lgkmcnt(14)
v_mfma_f32_16x16x32_bf16 v[32:35], v[60:63], v[40:43], v[32:35]
ds_read_b128 v[120:123], v14 offset:40960
ds_read_b128 v[124:127], v14 offset:41984
s_waitcnt lgkmcnt(15)
v_mfma_f32_16x16x32_bf16 v[36:39], v[64:67], v[40:43], v[36:39]
ds_read_b128 v[128:131], v14 offset:45056
s_add_u32 m0, s20, 20480
s_waitcnt lgkmcnt(14)
v_mfma_f32_16x16x32_bf16 v[28:31], v[68:71], v[44:47], v[28:31]
buffer_load_dwordx4 v2, s[32:35], s23 offen sc1 lds
s_add_u32 s23, s23, 20480
ds_read_b128 v[108:111], v15 offset:33792
s_waitcnt lgkmcnt(14)
v_mfma_f32_16x16x32_bf16 v[32:35], v[72:75], v[44:47], v[32:35]
ds_read_b128 v[132:135], v14 offset:46080
ds_read_b128 v[136:139], v14 offset:47104
s_waitcnt lgkmcnt(15)
v_mfma_f32_16x16x32_bf16 v[36:39], v[76:79], v[44:47], v[36:39]
ds_read_b128 v[140:143], v14 offset:50176
s_add_u32 m0, s21, 20480
s_waitcnt lgkmcnt(14)
v_mfma_f32_16x16x32_bf16 v[28:31], v[80:83], v[48:51], v[28:31]
buffer_load_dwordx4 v2, s[32:35], s24 offen sc1 lds
s_add_u32 s24, s24, 20480
ds_read_b128 v[112:115], v15 offset:40960
s_waitcnt lgkmcnt(14)
v_mfma_f32_16x16x32_bf16 v[32:35], v[84:87], v[48:51], v[32:35]
ds_read_b128 v[144:147], v14 offset:51200
ds_read_b128 v[148:151], v14 offset:52224
s_waitcnt lgkmcnt(15)
v_mfma_f32_16x16x32_bf16 v[36:39], v[88:91], v[48:51], v[36:39]
ds_read_b128 v[152:155], v14 offset:55296
s_add_u32 m0, s22, 20480
s_waitcnt lgkmcnt(14)
v_mfma_f32_16x16x32_bf16 v[28:31], v[92:95], v[52:55], v[28:31]
buffer_load_dwordx4 v2, s[32:35], s25 offen sc1 lds
s_add_u32 s25, s25, 20480
ds_read_b128 v[116:119], v15 offset:41984
s_waitcnt lgkmcnt(14)
v_mfma_f32_16x16x32_bf16 v[32:35], v[96:99], v[52:55], v[32:35]
ds_read_b128 v[156:159], v14 offset:56320
ds_read_b128 v[160:163], v14 offset:57344
s_waitcnt lgkmcnt(15)
v_mfma_f32_16x16x32_bf16 v[36:39], v[100:103], v[52:55], v[36:39]
ds_read_b128 v[164:167], v14 offset:60416
s_waitcnt vmcnt(5)
s_barrier
s_add_u32 m0, s26, 32768
s_waitcnt lgkmcnt(14)
v_mfma_f32_16x16x32_bf16 v[28:31], v[120:123], v[104:107], v[28:31]
buffer_load_dwordx4 v2, s[28:31], s18 offen sc1 lds
buffer_load_dwordx4 v2, s[28:31], s18 offen offset:1024 sc1 lds
s_add_u32 s18, s18, 4096
ds_read_b128 v[40:43], v15 offset:0
s_waitcnt lgkmcnt(14)
v_mfma_f32_16x16x32_bf16 v[32:35], v[124:127], v[104:107], v[32:35]
ds_read_b128 v[56:59], v14 offset:0
ds_read_b128 v[60:63], v14 offset:1024
s_waitcnt lgkmcnt(15)
v_mfma_f32_16x16x32_bf16 v[36:39], v[128:131], v[104:107], v[36:39]
ds_read_b128 v[64:67], v14 offset:4096
s_add_u32 m0, s20, 40960
s_waitcnt lgkmcnt(14)
v_mfma_f32_16x16x32_bf16 v[28:31], v[132:135], v[108:111], v[28:31]
buffer_load_dwordx4 v2, s[32:35], s23 offen sc1 lds
s_add_u32 s23, s23, 20480
ds_read_b128 v[44:47], v15 offset:1024
s_waitcnt lgkmcnt(14)
v_mfma_f32_16x16x32_bf16 v[32:35], v[136:139], v[108:111], v[32:35]
ds_read_b128 v[68:71], v14 offset:5120
ds_read_b128 v[72:75], v14 offset:6144
s_waitcnt lgkmcnt(15)
v_mfma_f32_16x16x32_bf16 v[36:39], v[140:143], v[108:111], v[36:39]
ds_read_b128 v[76:79], v14 offset:9216
s_add_u32 m0, s21, 40960
s_waitcnt lgkmcnt(14)
v_mfma_f32_16x16x32_bf16 v[28:31], v[144:147], v[112:115], v[28:31]
buffer_load_dwordx4 v2, s[32:35], s24 offen sc1 lds
s_add_u32 s24, s24, 20480
ds_read_b128 v[48:51], v15 offset:8192
s_waitcnt lgkmcnt(14)
v_mfma_f32_16x16x32_bf16 v[32:35], v[148:151], v[112:115], v[32:35]
ds_read_b128 v[80:83], v14 offset:10240
ds_read_b128 v[84:87], v14 offset:11264
s_waitcnt lgkmcnt(15)
v_mfma_f32_16x16x32_bf16 v[36:39], v[152:155], v[112:115], v[36:39]
ds_read_b128 v[88:91], v14 offset:14336
s_add_u32 m0, s22, 40960
s_waitcnt lgkmcnt(14)
v_mfma_f32_16x16x32_bf16 v[28:31], v[156:159], v[116:119], v[28:31]
buffer_load_dwordx4 v2, s[32:35], s25 offen sc1 lds
s_add_u32 s25, s25, 20480
ds_read_b128 v[52:55], v15 offset:9216
s_waitcnt lgkmcnt(14)
v_mfma_f32_16x16x32_bf16 v[32:35], v[160:163], v[116:119], v[32:35]
ds_read_b128 v[92:95], v14 offset:15360
ds_read_b128 v[96:99], v14 offset:16384
s_waitcnt lgkmcnt(15)
v_mfma_f32_16x16x32_bf16 v[36:39], v[164:167], v[116:119], v[36:39]
ds_read_b128 v[100:103], v14 offset:19456
s_waitcnt vmcnt(5)
s_barrier
s_add_u32 m0, s26, 0
s_waitcnt lgkmcnt(14)
v_mfma_f32_16x16x32_bf16 v[16:19], v[56:59], v[40:43], 0
buffer_load_dwordx4 v2, s[28:31], s18 offen sc1 lds
buffer_load_dwordx4 v2, s[28:31], s18 offen offset:1024 sc1 lds
s_add_u32 s18, s18, 4096
ds_read_b64 v[104:105], v223 offset:16384
s_waitcnt lgkmcnt(14)
v_mfma_f32_16x16x32_bf16 v[20:23], v[60:63], v[40:43], 0
ds_read_b64 v[106:107], v223 offset:16896
ds_read_b128 v[120:123], v14 offset:20480
s_add_u32 m0, s20, 0
s_waitcnt lgkmcnt(15)
v_mfma_f32_16x16x32_bf16 v[24:27], v[64:67], v[40:43], 0
ds_read_b128 v[124:127], v14 offset:21504
buffer_load_dwordx4 v2, s[32:35], s23 offen sc1 lds
s_add_u32 s23, s23, 20480
s_waitcnt lgkmcnt(14)
v_mfma_f32_16x16x32_bf16 v[16:19], v[68:71], v[44:47], v[16:19]
ds_read_b128 v[128:131], v14 offset:24576
s_waitcnt lgkmcnt(14)
v_mfma_f32_16x16x32_bf16 v[20:23], v[72:75], v[44:47], v[20:23]
ds_read_b128 v[108:111], v15 offset:17408
ds_read_b128 v[132:135], v14 offset:25600
s_add_u32 m0, s21, 0
s_waitcnt lgkmcnt(15)
v_mfma_f32_16x16x32_bf16 v[24:27], v[76:79], v[44:47], v[24:27]
ds_read_b128 v[136:139], v14 offset:26624
buffer_load_dwordx4 v2, s[32:35], s24 offen sc1 lds
s_add_u32 s24, s24, 20480
s_waitcnt lgkmcnt(14)
v_mfma_f32_16x16x32_bf16 v[16:19], v[80:83], v[48:51], v[16:19]
ds_read_b128 v[140:143], v14 offset:29696
ds_read_b128 v[112:115], v15 offset:24576
s_waitcnt lgkmcnt(15)
v_mfma_f32_16x16x32_bf16 v[20:23], v[84:87], v[48:51], v[20:23]
ds_read_b128 v[144:147], v14 offset:30720
s_add_u32 m0, s22, 0
s_waitcnt lgkmcnt(15)
v_mfma_f32_16x16x32_bf16 v[24:27], v[88:91], v[48:51], v[24:27]
ds_read_b128 v[148:151], v14 offset:31744
buffer_load_dwordx4 v2, s[32:35], s25 offen sc1 lds
s_add_u32 s25, s25, 20480
s_waitcnt lgkmcnt(14)
v_mfma_f32_16x16x32_bf16 v[16:19], v[92:95], v[52:55], v[16:19]
ds_read_b128 v[152:155], v14 offset:34816
ds_read_b128 v[116:119], v15 offset:25600
s_waitcnt lgkmcnt(15)
v_mfma_f32_16x16x32_bf16 v[20:23], v[96:99], v[52:55], v[20:23]
ds_read_b128 v[156:159], v14 offset:35840
ds_read_b128 v[160:163], v14 offset:36864
s_waitcnt lgkmcnt(15)
v_mfma_f32_16x16x32_bf16 v[24:27], v[100:103], v[52:55], v[24:27]
ds_read_b128 v[164:167], v14 offset:39936
s_waitcnt vmcnt(5)
s_barrier
s_add_u32 m0, s26, 16384
s_waitcnt lgkmcnt(14)
v_mfma_f32_16x16x32_bf16 v[16:19], v[120:123], v[104:107], v[16:19]
buffer_load_dwordx4 v2, s[28:31], s18 offen sc1 lds
buffer_load_dwordx4 v2, s[28:31], s18 offen offset:1024 sc1 lds
s_add_u32 s18, s18, 4096
ds_read_b128 v[40:43], v15 offset:32768
s_waitcnt lgkmcnt(14)
v_mfma_f32_16x16x32_bf16 v[20:23], v[124:127], v[104:107], v[20:23]
ds_read_b128 v[56:59], v14 offset:40960
ds_read_b128 v[60:63], v14 offset:41984
s_add_u32 m0, s20, 20480
s_waitcnt lgkmcnt(15)
v_mfma_f32_16x16x32_bf16 v[24:27], v[128:131], v[104:107], v[24:27]
ds_read_b128 v[64:67], v14 offset:45056
buffer_load_dwordx4 v2, s[32:35], s23 offen sc1 lds
s_add_u32 s23, s23, 20480
s_waitcnt lgkmcnt(14)
v_mfma_f32_16x16x32_bf16 v[16:19], v[132:135], v[108:111], v[16:19]
ds_read_b64 v[44:45], v223 offset:33792
s_waitcnt lgkmcnt(14)
v_mfma_f32_16x16x32_bf16 v[20:23], v[136:139], v[108:111], v[20:23]
ds_read_b64 v[46:47], v223 offset:34304
ds_read_b128 v[68:71], v14 offset:46080
s_add_u32 m0, s21, 20480
s_waitcnt lgkmcnt(15)
v_mfma_f32_16x16x32_bf16 v[24:27], v[140:143], v[108:111], v[24:27]
ds_read_b128 v[72:75], v14 offset:47104
buffer_load_dwordx4 v2, s[32:35], s24 offen sc1 lds
s_add_u32 s24, s24, 20480
s_waitcnt lgkmcnt(14)
v_mfma_f32_16x16x32_bf16 v[16:19], v[144:147], v[112:115], v[16:19]
ds_read_b128 v[76:79], v14 offset:50176
ds_read_b128 v[48:51], v15 offset:40960
s_waitcnt lgkmcnt(15)
v_mfma_f32_16x16x32_bf16 v[20:23], v[148:151], v[112:115], v[20:23]
ds_read_b128 v[80:83], v14 offset:51200
s_add_u32 m0, s22, 20480
s_waitcnt lgkmcnt(15)
v_mfma_f32_16x16x32_bf16 v[24:27], v[152:155], v[112:115], v[24:27]
ds_read_b128 v[84:87], v14 offset:52224
buffer_load_dwordx4 v2, s[32:35], s25 offen sc1 lds
s_add_u32 s25, s25, 20480
s_waitcnt lgkmcnt(14)
v_mfma_f32_16x16x32_bf16 v[16:19], v[156:159], v[116:119], v[16:19]
ds_read_b128 v[88:91], v14 offset:55296
ds_read_b128 v[52:55], v15 offset:41984
s_waitcnt lgkmcnt(15)
v_mfma_f32_16x16x32_bf16 v[20:23], v[160:163], v[116:119], v[20:23]
ds_read_b128 v[92:95], v14 offset:56320
ds_read_b128 v[96:99], v14 offset:57344
s_waitcnt lgkmcnt(15)
v_mfma_f32_16x16x32_bf16 v[24:27], v[164:167], v[116:119], v[24:27]
ds_read_b128 v[100:103], v14 offset:60416
s_waitcnt vmcnt(5)
s_barrier
s_waitcnt lgkmcnt(15)
v_mfma_f32_16x16x32_bf16 v[16:19], v[56:59], v[40:43], v[16:19]
ds_read_b128 v[104:107], v15 offset:0
ds_read_b128 v[120:123], v14 offset:0
s_waitcnt lgkmcnt(15)
v_mfma_f32_16x16x32_bf16 v[20:23], v[60:63], v[40:43], v[20:23]
ds_read_b128 v[124:127], v14 offset:1024
s_waitcnt lgkmcnt(15)
v_mfma_f32_16x16x32_bf16 v[24:27], v[64:67], v[40:43], v[24:27]
ds_read_b128 v[128:131], v14 offset:4096
ds_read_b128 v[108:111], v15 offset:1024
s_waitcnt lgkmcnt(15)
v_mfma_f32_16x16x32_bf16 v[16:19], v[68:71], v[44:47], v[16:19]
ds_read_b128 v[132:135], v14 offset:5120
s_waitcnt lgkmcnt(15)
v_mfma_f32_16x16x32_bf16 v[20:23], v[72:75], v[44:47], v[20:23]
ds_read_b128 v[136:139], v14 offset:6144
ds_read_b128 v[140:143], v14 offset:9216
s_waitcnt lgkmcnt(15)
v_mfma_f32_16x16x32_bf16 v[24:27], v[76:79], v[44:47], v[24:27]
ds_read_b64 v[112:113], v223 offset:8192
s_waitcnt lgkmcnt(15)
v_mfma_f32_16x16x32_bf16 v[16:19], v[80:83], v[48:51], v[16:19]
ds_read_b64 v[114:115], v223 offset:8704
s_waitcnt lgkmcnt(15)
v_mfma_f32_16x16x32_bf16 v[20:23], v[84:87], v[48:51], v[20:23]
ds_read_b128 v[144:147], v14 offset:10240
ds_read_b128 v[148:151], v14 offset:11264
s_waitcnt lgkmcnt(15)
v_mfma_f32_16x16x32_bf16 v[24:27], v[88:91], v[48:51], v[24:27]
ds_read_b128 v[152:155], v14 offset:14336
s_waitcnt lgkmcnt(15)
v_mfma_f32_16x16x32_bf16 v[16:19], v[92:95], v[52:55], v[16:19]
ds_read_b128 v[116:119], v15 offset:9216
ds_read_b128 v[156:159], v14 offset:15360
s_waitcnt lgkmcnt(15)
v_mfma_f32_16x16x32_bf16 v[20:23], v[96:99], v[52:55], v[20:23]
ds_read_b128 v[160:163], v14 offset:16384
s_waitcnt lgkmcnt(15)
v_mfma_f32_16x16x32_bf16 v[24:27], v[100:103], v[52:55], v[24:27]
ds_read_b128 v[164:167], v14 offset:19456
s_waitcnt vmcnt(0)
s_barrier
s_waitcnt lgkmcnt(15)
v_mfma_f32_16x16x32_bf16 v[16:19], v[120:123], v[104:107], v[16:19]
ds_read_b128 v[40:43], v15 offset:16384
ds_read_b128 v[56:59], v14 offset:20480
s_waitcnt lgkmcnt(15)
v_mfma_f32_16x16x32_bf16 v[20:23], v[124:127], v[104:107], v[20:23]
ds_read_b128 v[60:63], v14 offset:21504
s_waitcnt lgkmcnt(15)
v_mfma_f32_16x16x32_bf16 v[24:27], v[128:131], v[104:107], v[24:27]
ds_read_b128 v[64:67], v14 offset:24576
ds_read_b128 v[44:47], v15 offset:17408
s_waitcnt lgkmcnt(15)
v_mfma_f32_16x16x32_bf16 v[16:19], v[132:135], v[108:111], v[16:19]
ds_read_b128 v[68:71], v14 offset:25600
s_waitcnt lgkmcnt(15)
v_mfma_f32_16x16x32_bf16 v[20:23], v[136:139], v[108:111], v[20:23]
ds_read_b128 v[72:75], v14 offset:26624
ds_read_b128 v[76:79], v14 offset:29696
s_waitcnt lgkmcnt(15)
v_mfma_f32_16x16x32_bf16 v[24:27], v[140:143], v[108:111], v[24:27]
ds_read_b128 v[48:51], v15 offset:24576
s_waitcnt lgkmcnt(15)
v_mfma_f32_16x16x32_bf16 v[16:19], v[144:147], v[112:115], v[16:19]
ds_read_b128 v[80:83], v14 offset:30720
s_waitcnt lgkmcnt(15)
v_mfma_f32_16x16x32_bf16 v[20:23], v[148:151], v[112:115], v[20:23]
ds_read_b128 v[84:87], v14 offset:31744
ds_read_b128 v[88:91], v14 offset:34816
s_waitcnt lgkmcnt(15)
v_mfma_f32_16x16x32_bf16 v[24:27], v[152:155], v[112:115], v[24:27]
ds_read_b64 v[52:53], v223 offset:25600
s_waitcnt lgkmcnt(15)
v_mfma_f32_16x16x32_bf16 v[16:19], v[156:159], v[116:119], v[16:19]
ds_read_b64 v[54:55], v223 offset:26112
ds_read_b128 v[92:95], v14 offset:35840
s_waitcnt lgkmcnt(15)
v_mfma_f32_16x16x32_bf16 v[20:23], v[160:163], v[116:119], v[20:23]
ds_read_b128 v[96:99], v14 offset:36864
s_waitcnt lgkmcnt(15)
v_mfma_f32_16x16x32_bf16 v[24:27], v[164:167], v[116:119], v[24:27]
ds_read_b128 v[100:103], v14 offset:39936
s_waitcnt lgkmcnt(15)
v_mfma_f32_16x16x32_bf16 v[16:19], v[56:59], v[40:43], v[16:19]
s_waitcnt lgkmcnt(14)
v_mfma_f32_16x16x32_bf16 v[20:23], v[60:63], v[40:43], v[20:23]
s_waitcnt lgkmcnt(13)
v_mfma_f32_16x16x32_bf16 v[24:27], v[64:67], v[40:43], v[24:27]
s_waitcnt lgkmcnt(11)
v_mfma_f32_16x16x32_bf16 v[16:19], v[68:71], v[44:47], v[16:19]
s_waitcnt lgkmcnt(10)
v_mfma_f32_16x16x32_bf16 v[20:23], v[72:75], v[44:47], v[20:23]
s_waitcnt lgkmcnt(9)
v_mfma_f32_16x16x32_bf16 v[24:27], v[76:79], v[44:47], v[24:27]
s_waitcnt lgkmcnt(7)
v_mfma_f32_16x16x32_bf16 v[16:19], v[80:83], v[48:51], v[16:19]
s_waitcnt lgkmcnt(6)
v_mfma_f32_16x16x32_bf16 v[20:23], v[84:87], v[48:51], v[20:23]
s_waitcnt lgkmcnt(5)
v_mfma_f32_16x16x32_bf16 v[24:27], v[88:91], v[48:51], v[24:27]
s_waitcnt lgkmcnt(2)
v_mfma_f32_16x16x32_bf16 v[16:19], v[92:95], v[52:55], v[16:19]
s_waitcnt lgkmcnt(1)
v_mfma_f32_16x16x32_bf16 v[20:23], v[96:99], v[52:55], v[20:23]
s_waitcnt lgkmcnt(0)
v_mfma_f32_16x16x32_bf16 v[24:27], v[100:103], v[52:55], v[24:27]
v_mul_f32 v40, 0xbfb8aa3b, v28
v_mul_f32 v41, 0xbfb8aa3b, v29
v_mul_f32 v42, 0xbfb8aa3b, v30
v_mul_f32 v43, 0xbfb8aa3b, v31
v_mul_f32 v44, 0xbfb8aa3b, v32
v_mul_f32 v45, 0xbfb8aa3b, v33
v_mul_f32 v46, 0xbfb8aa3b, v34
v_mul_f32 v47, 0xbfb8aa3b, v35
v_mul_f32 v48, 0xbfb8aa3b, v36
v_mul_f32 v49, 0xbfb8aa3b, v37
v_mul_f32 v50, 0xbfb8aa3b, v38
v_mul_f32 v51, 0xbfb8aa3b, v39
v_exp_f32 v40, v40
v_exp_f32 v41, v41
v_exp_f32 v42, v42
v_exp_f32 v43, v43
v_exp_f32 v44, v44
v_exp_f32 v45, v45
v_exp_f32 v46, v46
v_exp_f32 v47, v47
v_exp_f32 v48, v48
v_exp_f32 v49, v49
v_exp_f32 v50, v50
v_exp_f32 v51, v51
v_mul_f32 v28, v28, v16
v_mul_f32 v29, v29, v17
v_mul_f32 v30, v30, v18
v_mul_f32 v31, v31, v19
v_mul_f32 v32, v32, v20
v_mul_f32 v33, v33, v21
v_mul_f32 v34, v34, v22
v_mul_f32 v35, v35, v23
v_mul_f32 v36, v36, v24
v_mul_f32 v37, v37, v25
v_mul_f32 v38, v38, v26
v_mul_f32 v39, v39, v27
v_lshlrev_b32 v56, 16, v8
v_and_b32 v57, 0xffff0000, v8
v_lshlrev_b32 v58, 16, v9
v_and_b32 v59, 0xffff0000, v9
v_lshlrev_b32 v60, 16, v10
v_and_b32 v61, 0xffff0000, v10
v_lshlrev_b32 v62, 16, v11
v_and_b32 v63, 0xffff0000, v11
v_lshlrev_b32 v64, 16, v12
v_and_b32 v65, 0xffff0000, v12
v_lshlrev_b32 v66, 16, v13
v_and_b32 v67, 0xffff0000, v13
v_add_f32 v40, 1.0, v40
v_add_f32 v41, 1.0, v41
v_add_f32 v42, 1.0, v42
v_add_f32 v43, 1.0, v43
v_add_f32 v44, 1.0, v44
v_add_f32 v45, 1.0, v45
v_add_f32 v46, 1.0, v46
v_add_f32 v47, 1.0, v47
v_add_f32 v48, 1.0, v48
v_add_f32 v49, 1.0, v49
v_add_f32 v50, 1.0, v50
v_add_f32 v51, 1.0, v51
v_rcp_f32 v40, v40
v_rcp_f32 v41, v41
v_rcp_f32 v42, v42
v_rcp_f32 v43, v43
v_rcp_f32 v44, v44
v_rcp_f32 v45, v45
v_rcp_f32 v46, v46
v_rcp_f32 v47, v47
v_rcp_f32 v48, v48
v_rcp_f32 v49, v49
v_rcp_f32 v50, v50
v_rcp_f32 v51, v51
v_fmac_f32 v56, v28, v40
v_fmac_f32 v57, v29, v41
v_fmac_f32 v58, v30, v42
v_fmac_f32 v59, v31, v43
v_fmac_f32 v60, v32, v44
v_fmac_f32 v61, v33, v45
v_fmac_f32 v62, v34, v46
v_fmac_f32 v63, v35, v47
v_fmac_f32 v64, v36, v48
v_fmac_f32 v65, v37, v49
v_fmac_f32 v66, v38, v50
v_fmac_f32 v67, v39, v51
v_cvt_pk_bf16_f32 v8, v56, v57
v_cvt_pk_bf16_f32 v9, v58, v59
v_cvt_pk_bf16_f32 v10, v60, v61
v_cvt_pk_bf16_f32 v11, v62, v63
v_cvt_pk_bf16_f32 v12, v64, v65
v_cvt_pk_bf16_f32 v13, v66, v67
buffer_store_dwordx4 v[8:11], v5, s[44:47], 0 offen
buffer_store_dwordx2 v[12:13], v6, s[44:47], 0 offen
s_branch p2_end
p2_path1:
s_cmp_eq_u32 s14, 0
s_cbranch_scc0 fz_go_c1
s_mov_b32 s39, 0
fz_poll_c1:
buffer_load_dword v24, v20, s[48:51], 0 offen sc1
s_waitcnt vmcnt(0)
v_cmp_ne_u32 vcc, s52, v24
s_nop 4
s_cmp_eq_u64 vcc, 0
s_cbranch_scc1 fz_go_c1
s_sleep 2
s_add_u32 s39, s39, 1
s_cmp_lt_u32 s39, 0x20000
s_cbranch_scc1 fz_poll_c1
fz_go_c1:
s_barrier
s_add_u32 m0, s26, 0
s_nop 0
buffer_load_dwordx4 v2, s[28:31], s18 offen sc1 lds
buffer_load_dwordx4 v2, s[28:31], s18 offen offset:1024 sc1 lds
s_add_u32 s18, s18, 4096
s_add_u32 m0, s26, 16384
s_nop 0
buffer_load_dwordx4 v2, s[28:31], s18 offen sc1 lds
buffer_load_dwordx4 v2, s[28:31], s18 offen offset:1024 sc1 lds
s_add_u32 s18, s18, 4096
s_add_u32 m0, s26, 32768
s_nop 0
buffer_load_dwordx4 v2, s[28:31], s18 offen sc1 lds
buffer_load_dwordx4 v2, s[28:31], s18 offen offset:1024 sc1 lds
s_add_u32 s18, s18, 4096
s_waitcnt vmcnt(4)
s_barrier
s_cmp_eq_u32 s53, 1
s_cselect_b64 exec, -1, 0
buffer_store_dwordx4 v[36:39], v2, s[80:83], s70 offen sc1
buffer_store_dwordx4 v[40:43], v2, s[80:83], s70 offen offset:1024 sc1
buffer_store_dwordx2 v[44:45], v224, s[80:83], s71 offen sc1
s_mov_b64 exec, -1
buffer_load_dwordx4 v[8:11], v5, s[40:43], 0 offen
buffer_load_dwordx2 v[12:13], v6, s[40:43], 0 offen
ds_read_b128 v[40:43], v15 offset:0
ds_read_b128 v[56:59], v14 offset:2048
ds_read_b128 v[60:63], v14 offset:3072
ds_read_b128 v[44:47], v15 offset:1024
ds_read_b128 v[64:67], v14 offset:7168
ds_read_b128 v[68:71], v14 offset:8192
ds_read_b128 v[48:51], v15 offset:8192
ds_read_b128 v[72:75], v14 offset:12288
ds_read_b128 v[76:79], v14 offset:13312
ds_read_b128 v[52:55], v15 offset:9216
ds_read_b128 v[80:83], v14 offset:17408
ds_read_b128 v[84:87], v14 offset:18432
s_waitcnt vmcnt(7)
s_barrier
s_add_u32 m0, s26, 0
s_waitcnt lgkmcnt(10)
v_mfma_f32_16x16x32_bf16 v[28:31], v[56:59], v[40:43], 0
buffer_load_dwordx4 v2, s[28:31], s18 offen sc1 lds
buffer_load_dwordx4 v2, s[28:31], s18 offen offset:1024 sc1 lds
s_add_u32 s18, s18, 4096
ds_read_b128 v[104:107], v15 offset:16384
s_waitcnt lgkmcnt(10)
v_mfma_f32_16x16x32_bf16 v[32:35], v[60:63], v[40:43], 0
ds_read_b128 v[120:123], v14 offset:22528
ds_read_b128 v[124:127], v14 offset:23552
s_add_u32 m0, s20, 0
s_waitcnt lgkmcnt(10)
v_mfma_f32_16x16x32_bf16 v[28:31], v[64:67], v[44:47], v[28:31]
ds_read_b128 v[108:111], v15 offset:17408
buffer_load_dwordx4 v2, s[32:35], s23 offen sc1 lds
s_add_u32 s23, s23, 20480
s_waitcnt lgkmcnt(10)
v_mfma_f32_16x16x32_bf16 v[32:35], v[68:71], v[44:47], v[32:35]
ds_read_b128 v[128:131], v14 offset:27648
ds_read_b128 v[132:135], v14 offset:28672
s_waitcnt lgkmcnt(10)
v_mfma_f32_16x16x32_bf16 v[28:31], v[72:75], v[48:51], v[28:31]
ds_read_b128 v[112:115], v15 offset:24576
ds_read_b128 v[136:139], v14 offset:32768
s_add_u32 m0, s21, 0
s_waitcnt lgkmcnt(11)
v_mfma_f32_16x16x32_bf16 v[32:35], v[76:79], v[48:51], v[32:35]
buffer_load_dwordx4 v2, s[32:35], s24 offen sc1 lds
s_add_u32 s24, s24, 20480
ds_read_b128 v[140:143], v14 offset:33792
s_waitcnt lgkmcnt(10)
v_mfma_f32_16x16x32_bf16 v[28:31], v[80:83], v[52:55], v[28:31]
ds_read_b128 v[116:119], v15 offset:25600
ds_read_b128 v[144:147], v14 offset:37888
s_waitcnt lgkmcnt(11)
v_mfma_f32_16x16x32_bf16 v[32:35], v[84:87], v[52:55], v[32:35]
ds_read_b128 v[148:151], v14 offset:38912
s_waitcnt vmcnt(9)
s_barrier
s_add_u32 m0, s26, 16384
s_waitcnt lgkmcnt(10)
v_mfma_f32_16x16x32_bf16 v[28:31], v[120:123], v[104:107], v[28:31]
buffer_load_dwordx4 v2, s[28:31], s18 offen sc1 lds
buffer_load_dwordx4 v2, s[28:31], s18 offen offset:1024 sc1 lds
s_add_u32 s18, s18, 4096
ds_read_b128 v[40:43], v15 offset:32768
s_waitcnt lgkmcnt(10)
v_mfma_f32_16x16x32_bf16 v[32:35], v[124:127], v[104:107], v[32:35]
ds_read_b128 v[56:59], v14 offset:43008
ds_read_b128 v[60:63], v14 offset:44032
s_add_u32 m0, s20, 20480
s_waitcnt lgkmcnt(10)
v_mfma_f32_16x16x32_bf16 v[28:31], v[128:131], v[108:111], v[28:31]
ds_read_b128 v[44:47], v15 offset:33792
buffer_load_dwordx4 v2, s[32:35], s23 offen sc1 lds
s_add_u32 s23, s23, 20480
s_waitcnt lgkmcnt(10)
v_mfma_f32_16x16x32_bf16 v[32:35], v[132:135], v[108:111], v[32:35]
ds_read_b128 v[64:67], v14 offset:48128
ds_read_b128 v[68:71], v14 offset:49152
s_waitcnt lgkmcnt(10)
v_mfma_f32_16x16x32_bf16 v[28:31], v[136:139], v[112:115], v[28:31]
ds_read_b128 v[48:51], v15 offset:40960
ds_read_b128 v[72:75], v14 offset:53248
s_add_u32 m0, s21, 20480
s_waitcnt lgkmcnt(11)
v_mfma_f32_16x16x32_bf16 v[32:35], v[140:143], v[112:115], v[32:35]
buffer_load_dwordx4 v2, s[32:35], s24 offen sc1 lds
s_add_u32 s24, s24, 20480
ds_read_b128 v[76:79], v14 offset:54272
s_waitcnt lgkmcnt(10)
v_mfma_f32_16x16x32_bf16 v[28:31], v[144:147], v[116:119], v[28:31]
ds_read_b128 v[52:55], v15 offset:41984
ds_read_b128 v[80:83], v14 offset:58368
s_waitcnt lgkmcnt(11)
v_mfma_f32_16x16x32_bf16 v[32:35], v[148:151], v[116:119], v[32:35]
ds_read_b128 v[84:87], v14 offset:59392
s_waitcnt vmcnt(4)
s_barrier
s_cmp_eq_u32 s53, 1
s_cbranch_scc0 fz_np_c1
s_cmp_eq_u32 s14, 0
s_cbranch_scc0 fz_np_c1
v_mov_b32 v22, s66
v_mov_b32 v23, s52
s_mov_b64 exec, 1
buffer_store_dword v23, v22, s[48:51], 0 offen sc1
s_mov_b64 exec, -1
fz_np_c1:
s_add_u32 m0, s26, 32768
s_waitcnt lgkmcnt(10)
v_mfma_f32_16x16x32_bf16 v[28:31], v[56:59], v[40:43], v[28:31]
buffer_load_dwordx4 v2, s[28:31], s18 offen sc1 lds
buffer_load_dwordx4 v2, s[28:31], s18 offen offset:1024 sc1 lds
s_add_u32 s18, s18, 4096
ds_read_b128 v[104:107], v15 offset:0
s_waitcnt lgkmcnt(10)
v_mfma_f32_16x16x32_bf16 v[32:35], v[60:63], v[40:43], v[32:35]
ds_read_b128 v[120:123], v14 offset:2048
ds_read_b128 v[124:127], v14 offset:3072
s_add_u32 m0, s20, 40960
s_waitcnt lgkmcnt(10)
v_mfma_f32_16x16x32_bf16 v[28:31], v[64:67], v[44:47], v[28:31]
ds_read_b128 v[108:111], v15 offset:1024
buffer_load_dwordx4 v2, s[32:35], s23 offen sc1 lds
s_add_u32 s23, s23, 20480
s_waitcnt lgkmcnt(10)
v_mfma_f32_16x16x32_bf16 v[32:35], v[68:71], v[44:47], v[32:35]
ds_read_b128 v[128:131], v14 offset:7168
ds_read_b128 v[132:135], v14 offset:8192
s_waitcnt lgkmcnt(10)
v_mfma_f32_16x16x32_bf16 v[28:31], v[72:75], v[48:51], v[28:31]
ds_read_b128 v[112:115], v15 offset:8192
ds_read_b128 v[136:139], v14 offset:12288
s_add_u32 m0, s21, 40960
s_waitcnt lgkmcnt(11)
v_mfma_f32_16x16x32_bf16 v[32:35], v[76:79], v[48:51], v[32:35]
buffer_load_dwordx4 v2, s[32:35], s24 offen sc1 lds
s_add_u32 s24, s24, 20480
ds_read_b128 v[140:143], v14 offset:13312
s_waitcnt lgkmcnt(10)
v_mfma_f32_16x16x32_bf16 v[28:31], v[80:83], v[52:55], v[28:31]
ds_read_b128 v[116:119], v15 offset:9216
ds_read_b128 v[144:147], v14 offset:17408
s_waitcnt lgkmcnt(11)
v_mfma_f32_16x16x32_bf16 v[32:35], v[84:87], v[52:55], v[32:35]
ds_read_b128 v[148:151], v14 offset:18432
s_waitcnt vmcnt(4)
s_barrier
s_add_u32 m0, s26, 0
s_waitcnt lgkmcnt(10)
v_mfma_f32_16x16x32_bf16 v[28:31], v[120:123], v[104:107], v[28:31]
buffer_load_dwordx4 v2, s[28:31], s18 offen sc1 lds
buffer_load_dwordx4 v2, s[28:31], s18 offen offset:1024 sc1 lds
s_add_u32 s18, s18, 4096
ds_read_b128 v[40:43], v15 offset:16384
s_waitcnt lgkmcnt(10)
v_mfma_f32_16x16x32_bf16 v[32:35], v[124:127], v[104:107], v[32:35]
ds_read_b128 v[56:59], v14 offset:22528
ds_read_b128 v[60:63], v14 offset:23552
s_add_u32 m0, s20, 0
s_waitcnt lgkmcnt(10)
v_mfma_f32_16x16x32_bf16 v[28:31], v[128:131], v[108:111], v[28:31]
ds_read_b128 v[44:47], v15 offset:17408
buffer_load_dwordx4 v2, s[32:35], s23 offen sc1 lds
s_add_u32 s23, s23, 20480
s_waitcnt lgkmcnt(10)
v_mfma_f32_16x16x32_bf16 v[32:35], v[132:135], v[108:111], v[32:35]
ds_read_b128 v[64:67], v14 offset:27648
ds_read_b128 v[68:71], v14 offset:28672
s_waitcnt lgkmcnt(10)
v_mfma_f32_16x16x32_bf16 v[28:31], v[136:139], v[112:115], v[28:31]
ds_read_b128 v[48:51], v15 offset:24576
ds_read_b128 v[72:75], v14 offset:32768
s_add_u32 m0, s21, 0
s_waitcnt lgkmcnt(11)
v_mfma_f32_16x16x32_bf16 v[32:35], v[140:143], v[112:115], v[32:35]
buffer_load_dwordx4 v2, s[32:35], s24 offen sc1 lds
s_add_u32 s24, s24, 20480
ds_read_b128 v[76:79], v14 offset:33792
s_waitcnt lgkmcnt(10)
v_mfma_f32_16x16x32_bf16 v[28:31], v[144:147], v[116:119], v[28:31]
ds_read_b128 v[52:55], v15 offset:25600
ds_read_b128 v[80:83], v14 offset:37888
s_waitcnt lgkmcnt(11)
v_mfma_f32_16x16x32_bf16 v[32:35], v[148:151], v[116:119], v[32:35]
ds_read_b128 v[84:87], v14 offset:38912
s_waitcnt vmcnt(4)
s_barrier
s_add_u32 m0, s26, 16384
s_waitcnt lgkmcnt(10)
v_mfma_f32_16x16x32_bf16 v[28:31], v[56:59], v[40:43], v[28:31]
buffer_load_dwordx4 v2, s[28:31], s18 offen sc1 lds
buffer_load_dwordx4 v2, s[28:31], s18 offen offset:1024 sc1 lds
s_add_u32 s18, s18, 4096
ds_read_b128 v[104:107], v15 offset:32768
s_waitcnt lgkmcnt(10)
v_mfma_f32_16x16x32_bf16 v[32:35], v[60:63], v[40:43], v[32:35]
ds_read_b128 v[120:123], v14 offset:43008
ds_read_b128 v[124:127], v14 offset:44032
s_add_u32 m0, s20, 20480
s_waitcnt lgkmcnt(10)
v_mfma_f32_16x16x32_bf16 v[28:31], v[64:67], v[44:47], v[28:31]
ds_read_b128 v[108:111], v15 offset:33792
buffer_load_dwordx4 v2, s[32:35], s23 offen sc1 lds
s_add_u32 s23, s23, 20480
s_waitcnt lgkmcnt(10)
v_mfma_f32_16x16x32_bf16 v[32:35], v[68:71], v[44:47], v[32:35]
ds_read_b128 v[128:131], v14 offset:48128
ds_read_b128 v[132:135], v14 offset:49152
s_waitcnt lgkmcnt(10)
v_mfma_f32_16x16x32_bf16 v[28:31], v[72:75], v[48:51], v[28:31]
ds_read_b128 v[112:115], v15 offset:40960
ds_read_b128 v[136:139], v14 offset:53248
s_add_u32 m0, s21, 20480
s_waitcnt lgkmcnt(11)
v_mfma_f32_16x16x32_bf16 v[32:35], v[76:79], v[48:51], v[32:35]
buffer_load_dwordx4 v2, s[32:35], s24 offen sc1 lds
s_add_u32 s24, s24, 20480
ds_read_b128 v[140:143], v14 offset:54272
s_waitcnt lgkmcnt(10)
v_mfma_f32_16x16x32_bf16 v[28:31], v[80:83], v[52:55], v[28:31]
ds_read_b128 v[116:119], v15 offset:41984
ds_read_b128 v[144:147], v14 offset:58368
s_waitcnt lgkmcnt(11)
v_mfma_f32_16x16x32_bf16 v[32:35], v[84:87], v[52:55], v[32:35]
ds_read_b128 v[148:151], v14 offset:59392
s_waitcnt vmcnt(4)
s_barrier
s_add_u32 m0, s26, 32768
s_waitcnt lgkmcnt(10)
v_mfma_f32_16x16x32_bf16 v[28:31], v[120:123], v[104:107], v[28:31]
buffer_load_dwordx4 v2, s[28:31], s18 offen sc1 lds
buffer_load_dwordx4 v2, s[28:31], s18 offen offset:1024 sc1 lds
s_add_u32 s18, s18, 4096
ds_read_b128 v[40:43], v15 offset:0
s_waitcnt lgkmcnt(10)
v_mfma_f32_16x16x32_bf16 v[32:35], v[124:127], v[104:107], v[32:35]
ds_read_b128 v[56:59], v14 offset:2048
ds_read_b128 v[60:63], v14 offset:3072
s_add_u32 m0, s20, 40960
s_waitcnt lgkmcnt(10)
v_mfma_f32_16x16x32_bf16 v[28:31], v[128:131], v[108:111], v[28:31]
ds_read_b128 v[44:47], v15 offset:1024
buffer_load_dwordx4 v2, s[32:35], s23 offen sc1 lds
s_add_u32 s23, s23, 20480
s_waitcnt lgkmcnt(10)
v_mfma_f32_16x16x32_bf16 v[32:35], v[132:135], v[108:111], v[32:35]
ds_read_b128 v[64:67], v14 offset:7168
ds_read_b128 v[68:71], v14 offset:8192
s_waitcnt lgkmcnt(10)
v_mfma_f32_16x16x32_bf16 v[28:31], v[136:139], v[112:115], v[28:31]
ds_read_b128 v[48:51], v15 offset:8192
ds_read_b128 v[72:75], v14 offset:12288
s_add_u32 m0, s21, 40960
s_waitcnt lgkmcnt(11)
v_mfma_f32_16x16x32_bf16 v[32:35], v[140:143], v[112:115], v[32:35]
buffer_load_dwordx4 v2, s[32:35], s24 offen sc1 lds
s_add_u32 s24, s24, 20480
ds_read_b128 v[76:79], v14 offset:13312
s_waitcnt lgkmcnt(10)
v_mfma_f32_16x16x32_bf16 v[28:31], v[144:147], v[116:119], v[28:31]
ds_read_b128 v[52:55], v15 offset:9216
ds_read_b128 v[80:83], v14 offset:17408
s_waitcnt lgkmcnt(11)
v_mfma_f32_16x16x32_bf16 v[32:35], v[148:151], v[116:119], v[32:35]
ds_read_b128 v[84:87], v14 offset:18432
s_waitcnt vmcnt(4)
s_barrier
s_add_u32 m0, s26, 0
s_waitcnt lgkmcnt(10)
v_mfma_f32_16x16x32_bf16 v[28:31], v[56:59], v[40:43], v[28:31]
buffer_load_dwordx4 v2, s[28:31], s18 offen sc1 lds
buffer_load_dwordx4 v2, s[28:31], s18 offen offset:1024 sc1 lds
s_add_u32 s18, s18, 4096
ds_read_b128 v[104:107], v15 offset:16384
s_waitcnt lgkmcnt(10)
v_mfma_f32_16x16x32_bf16 v[32:35], v[60:63], v[40:43], v[32:35]
ds_read_b128 v[120:123], v14 offset:22528
ds_read_b128 v[124:127], v14 offset:23552
s_add_u32 m0, s20, 0
s_waitcnt lgkmcnt(10)
v_mfma_f32_16x16x32_bf16 v[28:31], v[64:67], v[44:47], v[28:31]
ds_read_b128 v[108:111], v15 offset:17408
buffer_load_dwordx4 v2, s[32:35], s23 offen sc1 lds
s_add_u32 s23, s23, 20480
s_waitcnt lgkmcnt(10)
v_mfma_f32_16x16x32_bf16 v[32:35], v[68:71], v[44:47], v[32:35]
ds_read_b128 v[128:131], v14 offset:27648
ds_read_b128 v[132:135], v14 offset:28672
s_waitcnt lgkmcnt(10)
v_mfma_f32_16x16x32_bf16 v[28:31], v[72:75], v[48:51], v[28:31]
ds_read_b128 v[112:115], v15 offset:24576
ds_read_b128 v[136:139], v14 offset:32768
s_add_u32 m0, s21, 0
s_waitcnt lgkmcnt(11)
v_mfma_f32_16x16x32_bf16 v[32:35], v[76:79], v[48:51], v[32:35]
buffer_load_dwordx4 v2, s[32:35], s24 offen sc1 lds
s_add_u32 s24, s24, 20480
ds_read_b128 v[140:143], v14 offset:33792
s_waitcnt lgkmcnt(10)
v_mfma_f32_16x16x32_bf16 v[28:31], v[80:83], v[52:55], v[28:31]
ds_read_b128 v[116:119], v15 offset:25600
ds_read_b128 v[144:147], v14 offset:37888
s_waitcnt lgkmcnt(11)
v_mfma_f32_16x16x32_bf16 v[32:35], v[84:87], v[52:55], v[32:35]
ds_read_b128 v[148:151], v14 offset:38912
s_waitcnt vmcnt(4)
s_barrier
s_add_u32 m0, s26, 16384
s_waitcnt lgkmcnt(10)
v_mfma_f32_16x16x32_bf16 v[28:31], v[120:123], v[104:107], v[28:31]
buffer_load_dwordx4 v2, s[28:31], s18 offen sc1 lds
buffer_load_dwordx4 v2, s[28:31], s18 offen offset:1024 sc1 lds
s_add_u32 s18, s18, 4096
ds_read_b128 v[40:43], v15 offset:32768
s_waitcnt lgkmcnt(10)
v_mfma_f32_16x16x32_bf16 v[32:35], v[124:127], v[104:107], v[32:35]
ds_read_b128 v[56:59], v14 offset:43008
ds_read_b128 v[60:63], v14 offset:44032
s_add_u32 m0, s20, 20480
s_waitcnt lgkmcnt(10)
v_mfma_f32_16x16x32_bf16 v[28:31], v[128:131], v[108:111], v[28:31]
ds_read_b128 v[44:47], v15 offset:33792
buffer_load_dwordx4 v2, s[32:35], s23 offen sc1 lds
s_add_u32 s23, s23, 20480
s_waitcnt lgkmcnt(10)
v_mfma_f32_16x16x32_bf16 v[32:35], v[132:135], v[108:111], v[32:35]
ds_read_b128 v[64:67], v14 offset:48128
ds_read_b128 v[68:71], v14 offset:49152
s_waitcnt lgkmcnt(10)
v_mfma_f32_16x16x32_bf16 v[28:31], v[136:139], v[112:115], v[28:31]
ds_read_b128 v[48:51], v15 offset:40960
ds_read_b128 v[72:75], v14 offset:53248
s_add_u32 m0, s21, 20480
s_waitcnt lgkmcnt(11)
v_mfma_f32_16x16x32_bf16 v[32:35], v[140:143], v[112:115], v[32:35]
buffer_load_dwordx4 v2, s[32:35], s24 offen sc1 lds
s_add_u32 s24, s24, 20480
ds_read_b128 v[76:79], v14 offset:54272
s_waitcnt lgkmcnt(10)
v_mfma_f32_16x16x32_bf16 v[28:31], v[144:147], v[116:119], v[28:31]
ds_read_b128 v[52:55], v15 offset:41984
ds_read_b128 v[80:83], v14 offset:58368
s_waitcnt lgkmcnt(11)
v_mfma_f32_16x16x32_bf16 v[32:35], v[148:151], v[116:119], v[32:35]
ds_read_b128 v[84:87], v14 offset:59392
buffer_load_dword v24, v21, s[48:51], 0 offen sc1
s_waitcnt vmcnt(5)
s_barrier
s_add_u32 m0, s26, 32768
s_waitcnt lgkmcnt(10)
v_mfma_f32_16x16x32_bf16 v[28:31], v[56:59], v[40:43], v[28:31]
buffer_load_dwordx4 v2, s[28:31], s18 offen sc1 lds
buffer_load_dwordx4 v2, s[28:31], s18 offen offset:1024 sc1 lds
s_add_u32 s18, s18, 4096
ds_read_b128 v[104:107], v15 offset:0
s_waitcnt lgkmcnt(10)
v_mfma_f32_16x16x32_bf16 v[32:35], v[60:63], v[40:43], v[32:35]
ds_read_b128 v[120:123], v14 offset:2048
ds_read_b128 v[124:127], v14 offset:3072
s_add_u32 m0, s20, 40960
s_waitcnt lgkmcnt(10)
v_mfma_f32_16x16x32_bf16 v[28:31], v[64:67], v[44:47], v[28:31]
ds_read_b128 v[108:111], v15 offset:1024
buffer_load_dwordx4 v2, s[32:35], s23 offen sc1 lds
s_add_u32 s23, s23, 20480
s_waitcnt lgkmcnt(10)
v_mfma_f32_16x16x32_bf16 v[32:35], v[68:71], v[44:47], v[32:35]
ds_read_b128 v[128:131], v14 offset:7168
ds_read_b128 v[132:135], v14 offset:8192
s_waitcnt lgkmcnt(10)
v_mfma_f32_16x16x32_bf16 v[28:31], v[72:75], v[48:51], v[28:31]
ds_read_b128 v[112:115], v15 offset:8192
ds_read_b128 v[136:139], v14 offset:12288
s_add_u32 m0, s21, 40960
s_waitcnt lgkmcnt(11)
v_mfma_f32_16x16x32_bf16 v[32:35], v[76:79], v[48:51], v[32:35]
buffer_load_dwordx4 v2, s[32:35], s24 offen sc1 lds
s_add_u32 s24, s24, 20480
ds_read_b128 v[140:143], v14 offset:13312
s_waitcnt lgkmcnt(10)
v_mfma_f32_16x16x32_bf16 v[28:31], v[80:83], v[52:55], v[28:31]
ds_read_b128 v[116:119], v15 offset:9216
ds_read_b128 v[144:147], v14 offset:17408
s_waitcnt lgkmcnt(11)
v_mfma_f32_16x16x32_bf16 v[32:35], v[84:87], v[52:55], v[32:35]
ds_read_b128 v[148:151], v14 offset:18432
s_waitcnt vmcnt(5)
s_barrier
s_waitcnt vmcnt(4)
v_cmp_ne_u32 vcc, s52, v24
s_nop 4
s_cmp_eq_u64 vcc, 0
s_cbranch_scc1 fz_ok_c1
s_mov_b32 s39, 0
fz_pl_c1:
s_sleep 4
buffer_load_dword v24, v21, s[48:51], 0 offen sc1
s_waitcnt vmcnt(0)
v_cmp_ne_u32 vcc, s52, v24
s_nop 4
s_cmp_eq_u64 vcc, 0
s_cbranch_scc1 fz_ok_c1
s_add_u32 s39, s39, 1
s_cmp_lt_u32 s39, 0x20000
s_cbranch_scc1 fz_pl_c1
fz_ok_c1:
s_add_u32 m0, s26, 0
s_waitcnt lgkmcnt(10)
v_mfma_f32_16x16x32_bf16 v[28:31], v[120:123], v[104:107], v[28:31]
buffer_load_dwordx4 v2, s[28:31], s18 offen sc1 lds
buffer_load_dwordx4 v2, s[28:31], s18 offen offset:1024 sc1 lds
s_add_u32 s18, s18, 4096
ds_read_b128 v[40:43], v15 offset:16384
s_waitcnt lgkmcnt(10)
v_mfma_f32_16x16x32_bf16 v[32:35], v[124:127], v[104:107], v[32:35]
ds_read_b128 v[56:59], v14 offset:22528
ds_read_b128 v[60:63], v14 offset:23552
s_add_u32 m0, s20, 0
s_waitcnt lgkmcnt(10)
v_mfma_f32_16x16x32_bf16 v[28:31], v[128:131], v[108:111], v[28:31]
ds_read_b128 v[44:47], v15 offset:17408
buffer_load_dwordx4 v2, s[32:35], s23 offen sc1 lds
s_add_u32 s23, s23, 20480
s_waitcnt lgkmcnt(10)
v_mfma_f32_16x16x32_bf16 v[32:35], v[132:135], v[108:111], v[32:35]
ds_read_b128 v[64:67], v14 offset:27648
ds_read_b128 v[68:71], v14 offset:28672
s_waitcnt lgkmcnt(10)
v_mfma_f32_16x16x32_bf16 v[28:31], v[136:139], v[112:115], v[28:31]
ds_read_b128 v[48:51], v15 offset:24576
ds_read_b128 v[72:75], v14 offset:32768
s_add_u32 m0, s21, 0
s_waitcnt lgkmcnt(11)
v_mfma_f32_16x16x32_bf16 v[32:35], v[140:143], v[112:115], v[32:35]
buffer_load_dwordx4 v2, s[32:35], s24 offen sc1 lds
s_add_u32 s24, s24, 20480
ds_read_b128 v[76:79], v14 offset:33792
s_waitcnt lgkmcnt(10)
v_mfma_f32_16x16x32_bf16 v[28:31], v[144:147], v[116:119], v[28:31]
ds_read_b128 v[52:55], v15 offset:25600
ds_read_b128 v[80:83], v14 offset:37888
s_waitcnt lgkmcnt(11)
v_mfma_f32_16x16x32_bf16 v[32:35], v[148:151], v[116:119], v[32:35]
ds_read_b128 v[84:87], v14 offset:38912
s_waitcnt vmcnt(4)
s_barrier
s_add_u32 m0, s26, 16384
s_waitcnt lgkmcnt(10)
v_mfma_f32_16x16x32_bf16 v[28:31], v[56:59], v[40:43], v[28:31]
buffer_load_dwordx4 v2, s[28:31], s18 offen sc1 lds
buffer_load_dwordx4 v2, s[28:31], s18 offen offset:1024 sc1 lds
s_add_u32 s18, s18, 4096
ds_read_b128 v[104:107], v15 offset:32768
s_waitcnt lgkmcnt(10)
v_mfma_f32_16x16x32_bf16 v[32:35], v[60:63], v[40:43], v[32:35]
ds_read_b128 v[120:123], v14 offset:43008
ds_read_b128 v[124:127], v14 offset:44032
s_add_u32 m0, s20, 20480
s_waitcnt lgkmcnt(10)
v_mfma_f32_16x16x32_bf16 v[28:31], v[64:67], v[44:47], v[28:31]
ds_read_b128 v[108:111], v15 offset:33792
buffer_load_dwordx4 v2, s[32:35], s23 offen sc1 lds
s_add_u32 s23, s23, 20480
s_waitcnt lgkmcnt(10)
v_mfma_f32_16x16x32_bf16 v[32:35], v[68:71], v[44:47], v[32:35]
ds_read_b128 v[128:131], v14 offset:48128
ds_read_b128 v[132:135], v14 offset:49152
s_waitcnt lgkmcnt(10)
v_mfma_f32_16x16x32_bf16 v[28:31], v[72:75], v[48:51], v[28:31]
ds_read_b128 v[112:115], v15 offset:40960
ds_read_b128 v[136:139], v14 offset:53248
s_add_u32 m0, s21, 20480
s_waitcnt lgkmcnt(11)
v_mfma_f32_16x16x32_bf16 v[32:35], v[76:79], v[48:51], v[32:35]
buffer_load_dwordx4 v2, s[32:35], s24 offen sc1 lds
s_add_u32 s24, s24, 20480
ds_read_b128 v[140:143], v14 offset:54272
s_waitcnt lgkmcnt(10)
v_mfma_f32_16x16x32_bf16 v[28:31], v[80:83], v[52:55], v[28:31]
ds_read_b128 v[116:119], v15 offset:41984
ds_read_b128 v[144:147], v14 offset:58368
s_waitcnt lgkmcnt(11)
v_mfma_f32_16x16x32_bf16 v[32:35], v[84:87], v[52:55], v[32:35]
ds_read_b128 v[148:151], v14 offset:59392
s_waitcnt vmcnt(4)
s_barrier
s_add_u32 m0, s26, 32768
s_waitcnt lgkmcnt(10)
v_mfma_f32_16x16x32_bf16 v[28:31], v[120:123], v[104:107], v[28:31]
buffer_load_dwordx4 v2, s[28:31], s18 offen sc1 lds
buffer_load_dwordx4 v2, s[28:31], s18 offen offset:1024 sc1 lds
s_add_u32 s18, s18, 4096
ds_read_b128 v[40:43], v15 offset:0
s_waitcnt lgkmcnt(10)
v_mfma_f32_16x16x32_bf16 v[32:35], v[124:127], v[104:107], v[32:35]
ds_read_b128 v[56:59], v14 offset:2048
ds_read_b128 v[60:63], v14 offset:3072
s_add_u32 m0, s20, 40960
s_waitcnt lgkmcnt(10)
v_mfma_f32_16x16x32_bf16 v[28:31], v[128:131], v[108:111], v[28:31]
ds_read_b128 v[44:47], v15 offset:1024
buffer_load_dwordx4 v2, s[32:35], s23 offen sc1 lds
s_add_u32 s23, s23, 20480
s_waitcnt lgkmcnt(10)
v_mfma_f32_16x16x32_bf16 v[32:35], v[132:135], v[108:111], v[32:35]
ds_read_b128 v[64:67], v14 offset:7168
ds_read_b128 v[68:71], v14 offset:8192
s_waitcnt lgkmcnt(10)
v_mfma_f32_16x16x32_bf16 v[28:31], v[136:139], v[112:115], v[28:31]
ds_read_b128 v[48:51], v15 offset:8192
ds_read_b128 v[72:75], v14 offset:12288
s_add_u32 m0, s21, 40960
s_waitcnt lgkmcnt(11)
v_mfma_f32_16x16x32_bf16 v[32:35], v[140:143], v[112:115], v[32:35]
buffer_load_dwordx4 v2, s[32:35], s24 offen sc1 lds
s_add_u32 s24, s24, 20480
ds_read_b128 v[76:79], v14 offset:13312
s_waitcnt lgkmcnt(10)
v_mfma_f32_16x16x32_bf16 v[28:31], v[144:147], v[116:119], v[28:31]
ds_read_b128 v[52:55], v15 offset:9216
ds_read_b128 v[80:83], v14 offset:17408
s_waitcnt lgkmcnt(11)
v_mfma_f32_16x16x32_bf16 v[32:35], v[148:151], v[116:119], v[32:35]
ds_read_b128 v[84:87], v14 offset:18432
s_waitcnt vmcnt(4)
s_barrier
s_add_u32 m0, s26, 0
s_waitcnt lgkmcnt(10)
v_mfma_f32_16x16x32_bf16 v[16:19], v[56:59], v[40:43], 0
buffer_load_dwordx4 v2, s[28:31], s18 offen sc1 lds
buffer_load_dwordx4 v2, s[28:31], s18 offen offset:1024 sc1 lds
s_add_u32 s18, s18, 4096
ds_read_b64 v[104:105], v223 offset:16384
s_waitcnt lgkmcnt(10)
v_mfma_f32_16x16x32_bf16 v[20:23], v[60:63], v[40:43], 0
ds_read_b64 v[106:107], v223 offset:16896
ds_read_b128 v[120:123], v14 offset:22528
s_add_u32 m0, s20, 0
s_waitcnt lgkmcnt(10)
v_mfma_f32_16x16x32_bf16 v[16:19], v[64:67], v[44:47], v[16:19]
ds_read_b128 v[124:127], v14 offset:23552
buffer_load_dwordx4 v2, s[32:35], s23 offen sc1 lds
s_add_u32 s23, s23, 20480
s_waitcnt lgkmcnt(10)
v_mfma_f32_16x16x32_bf16 v[20:23], v[68:71], v[44:47], v[20:23]
ds_read_b128 v[108:111], v15 offset:17408
ds_read_b128 v[128:131], v14 offset:27648
s_waitcnt lgkmcnt(10)
v_mfma_f32_16x16x32_bf16 v[16:19], v[72:75], v[48:51], v[16:19]
ds_read_b128 v[132:135], v14 offset:28672
ds_read_b128 v[112:115], v15 offset:24576
s_add_u32 m0, s21, 0
s_waitcnt lgkmcnt(11)
v_mfma_f32_16x16x32_bf16 v[20:23], v[76:79], v[48:51], v[20:23]
buffer_load_dwordx4 v2, s[32:35], s24 offen sc1 lds
s_add_u32 s24, s24, 20480
ds_read_b128 v[136:139], v14 offset:32768
s_waitcnt lgkmcnt(10)
v_mfma_f32_16x16x32_bf16 v[16:19], v[80:83], v[52:55], v[16:19]
ds_read_b128 v[140:143], v14 offset:33792
ds_read_b128 v[116:119], v15 offset:25600
s_waitcnt lgkmcnt(11)
v_mfma_f32_16x16x32_bf16 v[20:23], v[84:87], v[52:55], v[20:23]
ds_read_b128 v[144:147], v14 offset:37888
ds_read_b128 v[148:151], v14 offset:38912
s_waitcnt vmcnt(4)
s_barrier
s_add_u32 m0, s26, 16384
s_waitcnt lgkmcnt(10)
v_mfma_f32_16x16x32_bf16 v[16:19], v[120:123], v[104:107], v[16:19]
buffer_load_dwordx4 v2, s[28:31], s18 offen sc1 lds
buffer_load_dwordx4 v2, s[28:31], s18 offen offset:1024 sc1 lds
s_add_u32 s18, s18, 4096
ds_read_b128 v[40:43], v15 offset:32768
s_waitcnt lgkmcnt(10)
v_mfma_f32_16x16x32_bf16 v[20:23], v[124:127], v[104:107], v[20:23]
ds_read_b128 v[56:59], v14 offset:43008
ds_read_b128 v[60:63], v14 offset:44032
s_add_u32 m0, s20, 20480
s_waitcnt lgkmcnt(10)
v_mfma_f32_16x16x32_bf16 v[16:19], v[128:131], v[108:111], v[16:19]
ds_read_b64 v[44:45], v223 offset:33792
buffer_load_dwordx4 v2, s[32:35], s23 offen sc1 lds
s_add_u32 s23, s23, 20480
s_waitcnt lgkmcnt(10)
v_mfma_f32_16x16x32_bf16 v[20:23], v[132:135], v[108:111], v[20:23]
ds_read_b64 v[46:47], v223 offset:34304
ds_read_b128 v[64:67], v14 offset:48128
s_waitcnt lgkmcnt(10)
v_mfma_f32_16x16x32_bf16 v[16:19], v[136:139], v[112:115], v[16:19]
ds_read_b128 v[68:71], v14 offset:49152
ds_read_b128 v[48:51], v15 offset:40960
s_add_u32 m0, s21, 20480
s_waitcnt lgkmcnt(11)
v_mfma_f32_16x16x32_bf16 v[20:23], v[140:143], v[112:115], v[20:23]
buffer_load_dwordx4 v2, s[32:35], s24 offen sc1 lds
s_add_u32 s24, s24, 20480
ds_read_b128 v[72:75], v14 offset:53248
s_waitcnt lgkmcnt(10)
v_mfma_f32_16x16x32_bf16 v[16:19], v[144:147], v[116:119], v[16:19]
ds_read_b128 v[76:79], v14 offset:54272
ds_read_b128 v[52:55], v15 offset:41984
s_waitcnt lgkmcnt(11)
v_mfma_f32_16x16x32_bf16 v[20:23], v[148:151], v[116:119], v[20:23]
ds_read_b128 v[80:83], v14 offset:58368
ds_read_b128 v[84:87], v14 offset:59392
s_waitcnt vmcnt(4)
s_barrier
s_waitcnt lgkmcnt(11)
v_mfma_f32_16x16x32_bf16 v[16:19], v[56:59], v[40:43], v[16:19]
ds_read_b128 v[104:107], v15 offset:0
ds_read_b128 v[120:123], v14 offset:2048
s_waitcnt lgkmcnt(12)
v_mfma_f32_16x16x32_bf16 v[20:23], v[60:63], v[40:43], v[20:23]
ds_read_b128 v[124:127], v14 offset:3072
ds_read_b128 v[108:111], v15 offset:1024
s_waitcnt lgkmcnt(11)
v_mfma_f32_16x16x32_bf16 v[16:19], v[64:67], v[44:47], v[16:19]
ds_read_b128 v[128:131], v14 offset:7168
s_waitcnt lgkmcnt(11)
v_mfma_f32_16x16x32_bf16 v[20:23], v[68:71], v[44:47], v[20:23]
ds_read_b128 v[132:135], v14 offset:8192
ds_read_b64 v[112:113], v223 offset:8192
s_waitcnt lgkmcnt(11)
v_mfma_f32_16x16x32_bf16 v[16:19], v[72:75], v[48:51], v[16:19]
ds_read_b64 v[114:115], v223 offset:8704
ds_read_b128 v[136:139], v14 offset:12288
s_waitcnt lgkmcnt(12)
v_mfma_f32_16x16x32_bf16 v[20:23], v[76:79], v[48:51], v[20:23]
ds_read_b128 v[140:143], v14 offset:13312
s_waitcnt lgkmcnt(11)
v_mfma_f32_16x16x32_bf16 v[16:19], v[80:83], v[52:55], v[16:19]
ds_read_b128 v[116:119], v15 offset:9216
ds_read_b128 v[144:147], v14 offset:17408
s_waitcnt lgkmcnt(12)
v_mfma_f32_16x16x32_bf16 v[20:23], v[84:87], v[52:55], v[20:23]
ds_read_b128 v[148:151], v14 offset:18432
s_waitcnt vmcnt(0)
s_barrier
s_waitcnt lgkmcnt(11)
v_mfma_f32_16x16x32_bf16 v[16:19], v[120:123], v[104:107], v[16:19]
ds_read_b128 v[40:43], v15 offset:16384
ds_read_b128 v[56:59], v14 offset:22528
s_waitcnt lgkmcnt(12)
v_mfma_f32_16x16x32_bf16 v[20:23], v[124:127], v[104:107], v[20:23]
ds_read_b128 v[60:63], v14 offset:23552
ds_read_b128 v[44:47], v15 offset:17408
s_waitcnt lgkmcnt(12)
v_mfma_f32_16x16x32_bf16 v[16:19], v[128:131], v[108:111], v[16:19]
ds_read_b128 v[64:67], v14 offset:27648
s_waitcnt lgkmcnt(12)
v_mfma_f32_16x16x32_bf16 v[20:23], v[132:135], v[108:111], v[20:23]
ds_read_b128 v[68:71], v14 offset:28672
ds_read_b128 v[48:51], v15 offset:24576
s_waitcnt lgkmcnt(11)
v_mfma_f32_16x16x32_bf16 v[16:19], v[136:139], v[112:115], v[16:19]
ds_read_b128 v[72:75], v14 offset:32768
ds_read_b128 v[76:79], v14 offset:33792
s_waitcnt lgkmcnt(12)
v_mfma_f32_16x16x32_bf16 v[20:23], v[140:143], v[112:115], v[20:23]
ds_read_b64 v[52:53], v223 offset:25600
s_waitcnt lgkmcnt(11)
v_mfma_f32_16x16x32_bf16 v[16:19], v[144:147], v[116:119], v[16:19]
ds_read_b64 v[54:55], v223 offset:26112
ds_read_b128 v[80:83], v14 offset:37888
s_waitcnt lgkmcnt(12)
v_mfma_f32_16x16x32_bf16 v[20:23], v[148:151], v[116:119], v[20:23]
ds_read_b128 v[84:87], v14 offset:38912
s_waitcnt lgkmcnt(11)
v_mfma_f32_16x16x32_bf16 v[16:19], v[56:59], v[40:43], v[16:19]
s_waitcnt lgkmcnt(10)
v_mfma_f32_16x16x32_bf16 v[20:23], v[60:63], v[40:43], v[20:23]
s_waitcnt lgkmcnt(8)
v_mfma_f32_16x16x32_bf16 v[16:19], v[64:67], v[44:47], v[16:19]
s_waitcnt lgkmcnt(7)
v_mfma_f32_16x16x32_bf16 v[20:23], v[68:71], v[44:47], v[20:23]
s_waitcnt lgkmcnt(5)
v_mfma_f32_16x16x32_bf16 v[16:19], v[72:75], v[48:51], v[16:19]
s_waitcnt lgkmcnt(4)
v_mfma_f32_16x16x32_bf16 v[20:23], v[76:79], v[48:51], v[20:23]
s_waitcnt lgkmcnt(1)
v_mfma_f32_16x16x32_bf16 v[16:19], v[80:83], v[52:55], v[16:19]
s_waitcnt lgkmcnt(0)
v_mfma_f32_16x16x32_bf16 v[20:23], v[84:87], v[52:55], v[20:23]
v_mul_f32 v40, 0xbfb8aa3b, v28
v_mul_f32 v41, 0xbfb8aa3b, v29
v_mul_f32 v42, 0xbfb8aa3b, v30
v_mul_f32 v43, 0xbfb8aa3b, v31
v_mul_f32 v44, 0xbfb8aa3b, v32
v_mul_f32 v45, 0xbfb8aa3b, v33
v_mul_f32 v46, 0xbfb8aa3b, v34
v_mul_f32 v47, 0xbfb8aa3b, v35
v_exp_f32 v40, v40
v_exp_f32 v41, v41
v_exp_f32 v42, v42
v_exp_f32 v43, v43
v_exp_f32 v44, v44
v_exp_f32 v45, v45
v_exp_f32 v46, v46
v_exp_f32 v47, v47
v_mul_f32 v28, v28, v16
v_mul_f32 v29, v29, v17
v_mul_f32 v30, v30, v18
v_mul_f32 v31, v31, v19
v_mul_f32 v32, v32, v20
v_mul_f32 v33, v33, v21
v_mul_f32 v34, v34, v22
v_mul_f32 v35, v35, v23
v_lshlrev_b32 v56, 16, v8
v_and_b32 v57, 0xffff0000, v8
v_lshlrev_b32 v58, 16, v9
v_and_b32 v59, 0xffff0000, v9
v_lshlrev_b32 v60, 16, v10
v_and_b32 v61, 0xffff0000, v10
v_lshlrev_b32 v62, 16, v11
v_and_b32 v63, 0xffff0000, v11
v_add_f32 v40, 1.0, v40
v_add_f32 v41, 1.0, v41
v_add_f32 v42, 1.0, v42
v_add_f32 v43, 1.0, v43
v_add_f32 v44, 1.0, v44
v_add_f32 v45, 1.0, v45
v_add_f32 v46, 1.0, v46
v_add_f32 v47, 1.0, v47
v_rcp_f32 v40, v40
v_rcp_f32 v41, v41
v_rcp_f32 v42, v42
v_rcp_f32 v43, v43
v_rcp_f32 v44, v44
v_rcp_f32 v45, v45
v_rcp_f32 v46, v46
v_rcp_f32 v47, v47
v_fmac_f32 v56, v28, v40
v_fmac_f32 v57, v29, v41
v_fmac_f32 v58, v30, v42
v_fmac_f32 v59, v31, v43
v_fmac_f32 v60, v32, v44
v_fmac_f32 v61, v33, v45
v_fmac_f32 v62, v34, v46
v_fmac_f32 v63, v35, v47
v_cvt_pk_bf16_f32 v8, v56, v57
v_cvt_pk_bf16_f32 v9, v58, v59
v_cvt_pk_bf16_f32 v10, v60, v61
v_cvt_pk_bf16_f32 v11, v62, v63
buffer_store_dwordx4 v[8:11], v5, s[44:47], 0 offen
p2_end:
p1_done:
s_endpgm
p1_last:
.set KERNEL_BYTES, ((p1_last-recurrent_scan__sliding_local_dilated__dense_activation_silu__prompt_kernel)/1024)*1024
.section .rodata,"a"
.p2align 6
.amdhsa_kernel recurrent_scan__sliding_local_dilated__dense_activation_silu__prompt_kernel
  .amdhsa_next_free_vgpr 256
  .amdhsa_next_free_sgpr 102
  .amdhsa_accum_offset 256
  .amdhsa_group_segment_fixed_size 0
  .amdhsa_kernarg_size 72
  .amdhsa_user_sgpr_count 2
  .amdhsa_user_sgpr_kernarg_segment_ptr 1
  .amdhsa_system_sgpr_workgroup_id_x 1
.end_amdhsa_kernel
```
